```python
import torch

def _softmax(x, axis=-1):
    return torch.softmax(x, dim=axis)
def _gelu(x):
    return torch.nn.functional.gelu(x, approximate="tanh")
def _silu(x):
    return torch.nn.functional.silu(x)
def _sigmoid(x):
    return torch.sigmoid(x)
def _layernorm(x, axis=-1, eps=1e-5):
    m = x.mean(dim=axis, keepdim=True)
    v = x.var(dim=axis, keepdim=True, unbiased=False)
    return (x - m) / torch.sqrt(v + eps)
def _scatter_add(tgt, idx, src, axis=0):
    return tgt.clone().index_add_(axis, idx, src)
def _segment_sum(src, seg, n):
    out = torch.zeros((n,) + src.shape[1:], dtype=src.dtype)
    return out.index_add_(0, seg, src)
def _pad(x, pw):
    flat = tuple(v for pair in reversed(pw) for v in pair)
    return torch.nn.functional.pad(x, flat)

kernel_name = 'sequential_preLN__grouped_kv_mqa__glu_gated_bilinear__prompt'

def setup_inputs():

    _w = (lambda a: (lambda t: t.to(torch.bfloat16) if t.is_floating_point() else t)(torch.as_tensor(a)))
    def _A_setup():
        B, S, D, H = 1, 2048, 640, 32
        Dh = D // H
        return {
            "x": _w((lambda *s: torch.randn(*s, dtype=torch.bfloat16) * 0.05)(B, S, D)),
            "wq": _w((lambda *s: torch.randn(*s, dtype=torch.bfloat16) * 0.05)(D, H * Dh)),
            "wk": _w((lambda *s: torch.randn(*s, dtype=torch.bfloat16) * 0.05)(D, Dh)),
            "wv": _w((lambda *s: torch.randn(*s, dtype=torch.bfloat16) * 0.05)(D, Dh)),
            "wo": _w((lambda *s: torch.randn(*s, dtype=torch.bfloat16) * 0.05)(H * Dh, D)),
        }
    _A_in = _A_setup()

    def _B_setup():
        B, S, D, F = 1, 2048, 640, 1728
        return {
            "x": _w((lambda *s: torch.randn(*s, dtype=torch.bfloat16) * 0.05)(B, S, D)),
            "w_gate": _w((lambda *s: torch.randn(*s, dtype=torch.bfloat16) * 0.8)(D, F) * (D ** -0.5)),
            "w_up": _w((lambda *s: torch.randn(*s, dtype=torch.bfloat16) * 0.8)(D, F) * (D ** -0.5)),
            "w_down": _w((lambda *s: torch.randn(*s, dtype=torch.bfloat16) * 0.8)(F, D) * (F ** -0.5)),
        }
    _B_in = _B_setup()

    return {
        "A_x": _A_in["x"],
        "A_wq": _A_in["wq"],
        "A_wk": _A_in["wk"],
        "A_wv": _A_in["wv"],
        "A_wo": _A_in["wo"],
        "B_x": _B_in["x"],
        "B_w_gate": _B_in["w_gate"],
        "B_w_up": _B_in["w_up"],
        "B_w_down": _B_in["w_down"],
    }

def reference(A_x, A_wq, A_wk, A_wv, A_wo, B_x, B_w_gate, B_w_up, B_w_down):
    def _A_ref(x, wq, wk, wv, wo):
        B, S, D = x.shape
        H = 32
        Dh = D // H
        q = (lambda x, *d: x.permute(*d))((x @ wq).reshape(B, S, H, Dh), 0, 2, 1, 3)
        k = x @ wk
        v = x @ wv
        scores = torch.einsum("bhqd,bkd->bhqk", q, k) * (Dh ** -0.5)
        p = _softmax(scores, axis=-1)
        o = torch.einsum("bhqk,bkd->bhqd", p, v)
        return (lambda x, *d: x.permute(*d))(o, 0, 2, 1, 3).reshape(B, S, H * Dh) @ wo

    def _B_ref(x, w_gate, w_up, w_down):
        g = torch.einsum("bsd,df->bsf", x, w_gate)
        u = torch.einsum("bsd,df->bsf", x, w_up)
        h = g * u
        return torch.einsum("bsf,fd->bsd", h, w_down)

    x = A_x
    h = x + _A_ref(_layernorm(x, axis=-1), A_wq, A_wk, A_wv, A_wo)
    h2 = h + _B_ref(_layernorm(h, axis=-1), B_w_gate, B_w_up, B_w_down)
    return h2
```

```asm
; @launch kernel=k1_kernel grid=(256,1,1) block=(512,1,1) lds=155776
; @launch kernel=k2_kernel grid=(256,1,1) block=(512,1,1) lds=135424
; @launch kernel=k3_kernel grid=(256,1,1) block=(512,1,1) lds=122880
; @launch kernel=k4_kernel grid=(256,1,1) block=(512,1,1) lds=144384
; @launch kernel=k5_kernel grid=(256,1,1) block=(512,1,1) lds=122880
.amdgcn_target "amdgcn-amd-amdhsa--gfx950"
.text
.globl k1_kernel
.p2align 8
.type k1_kernel,@function
k1_kernel:
    s_cmp_ge_u32 s2, 256
    s_cbranch_scc1 L_k1_kernel_end
    s_load_dwordx16 s[64:79], s[0:1], 0
    s_load_dwordx8 s[80:87], s[0:1], 64
    v_and_b32 v1, 63, v0
    v_lshrrev_b32 v2, 6, v0
    s_nop 0
    v_readfirstlane_b32 s32, v2
    s_nop 3
    s_mov_b32 s53, s32
    s_waitcnt lgkmcnt(0)
    s_and_b32 s36, s2, 7
    s_lshr_b32 s37, s2, 3
    s_and_b32 s38, s37, 3
    s_lshl_b32 s36, s36, 2
    s_add_u32 s36, s36, s38
    s_lshl_b32 s33, s36, 6
    s_lshr_b32 s51, s37, 2
    s_mov_b32 s52, s36
    s_mov_b32 s55, s51
    s_mov_b32 s56, s38
    s_mov_b32 s4, s64
    s_mov_b32 s5, s65
    s_mov_b32 s6, 0x280000
    s_mov_b32 s7, 0x20000
    s_mov_b32 s8, s66
    s_mov_b32 s9, s67
    s_mov_b32 s10, 0xc8000
    s_mov_b32 s11, 0x20000
    s_cmp_lt_u32 s51, 4
    s_cselect_b32 s12, s68, s70
    s_cselect_b32 s13, s69, s71
    s_mov_b32 s14, 25600
    s_mov_b32 s15, 0x20000
    s_mov_b32 s20, s86
    s_mov_b32 s21, s87
    s_mov_b32 s22, 0x400000
    s_mov_b32 s23, 0x20000
    s_mul_i32 s34, s51, 160
    s_and_b32 s35, s51, 3
    s_lshl_b32 s35, s35, 3
    s_cmp_ge_u32 s32, 4
    s_cbranch_scc1 L_k1_kernel_prod
    v_and_b32 v22, 15, v1
    v_lshrrev_b32 v23, 4, v1
    v_lshrrev_b32 v24, 1, v22
    v_xor_b32 v23, v23, v24
    v_lshlrev_b32 v23, 4, v23
    s_mul_i32 s36, s32, 2048
    v_lshl_add_u32 v23, v22, 7, v23
    v_add_u32 v2, s36, v23
    v_xor_b32 v5, 64, v2
    v_add_u32 v3, 65536, v2
    v_add_u32 v4, 131072, v2
    v_add_u32 v6, 65536, v5
    v_add_u32 v7, 131072, v5
    v_lshrrev_b32 v22, 5, v1
    v_lshlrev_b32 v22, 4, v22
    v_bfe_u32 v23, v1, 4, 1
    v_lshl_add_u32 v22, v23, 2, v22
    v_bfe_u32 v23, v1, 2, 2
    v_add_u32 v22, v22, v23
    v_mul_u32_u24 v23, 160, v22
    v_and_b32 v24, 3, v1
    v_lshl_add_u32 v8, v24, 3, v23
    v_add_u32 v9, 65536, v8
    v_add_u32 v10, 131072, v8
    v_mul_u32_u24 v23, 16, v22
    v_and_b32 v24, 1, v1
    v_lshl_add_u32 v11, v24, 3, v23
    v_add_u32 v12, 65536, v11
    v_add_u32 v13, 131072, v11
    v_mov_b32 v20, 0x3f803f80
    v_mov_b32 v21, 0x3f803f80
    v_mov_b32 v22, 0x3f803f80
    v_mov_b32 v23, 0x3f803f80
    v_mov_b32 v80, 0
    v_lshlrev_b32 v81, 2, v1
    v_add_u32 v81, 155648, v81
    ds_write_b32 v81, v80
    s_barrier
    ds_read_b128 v[128:131], v2 offset:0
    ds_read_b64_tr_b16 v[80:81], v8 offset:8192
    ds_read_b64_tr_b16 v[82:83], v8 offset:9472
    ds_read_b64_tr_b16 v[84:85], v8 offset:8224
    ds_read_b64_tr_b16 v[86:87], v8 offset:9504
    ds_read_b64_tr_b16 v[88:89], v8 offset:8256
    ds_read_b64_tr_b16 v[90:91], v8 offset:9536
    ds_read_b64_tr_b16 v[92:93], v8 offset:8288
    ds_read_b64_tr_b16 v[94:95], v8 offset:9568
    ds_read_b64_tr_b16 v[96:97], v8 offset:8320
    ds_read_b64_tr_b16 v[98:99], v8 offset:9600
    ds_read_b64_tr_b16 v[100:101], v11 offset:18432
    ds_read_b64_tr_b16 v[102:103], v11 offset:18560
    ds_read_b128 v[132:135], v5 offset:0
    ds_read_b64_tr_b16 v[104:105], v8 offset:13312
    ds_read_b64_tr_b16 v[106:107], v8 offset:14592
    ds_read_b64_tr_b16 v[108:109], v8 offset:13344
    ds_read_b64_tr_b16 v[110:111], v8 offset:14624
    ds_read_b64_tr_b16 v[112:113], v8 offset:13376
    ds_read_b64_tr_b16 v[114:115], v8 offset:14656
    ds_read_b64_tr_b16 v[116:117], v8 offset:13408
    ds_read_b64_tr_b16 v[118:119], v8 offset:14688
    ds_read_b64_tr_b16 v[120:121], v8 offset:13440
    ds_read_b64_tr_b16 v[122:123], v8 offset:14720
    ds_read_b64_tr_b16 v[124:125], v11 offset:18944
    ds_read_b64_tr_b16 v[126:127], v11 offset:19072
    s_waitcnt lgkmcnt(15)
    v_mfma_f32_16x16x32_bf16 v[24:27], v[80:83], v[128:131], 0
    v_mfma_f32_16x16x32_bf16 v[48:51], v[80:83], v[20:23], 0
    v_mfma_f32_16x16x32_bf16 v[72:75], v[20:23], v[128:131], 0
    s_barrier
    ds_read_b128 v[136:139], v2 offset:19456
    ds_read_b64_tr_b16 v[80:81], v8 offset:27648
    ds_read_b64_tr_b16 v[82:83], v8 offset:28928
    v_mfma_f32_16x16x32_bf16 v[28:31], v[84:87], v[128:131], 0
    v_mfma_f32_16x16x32_bf16 v[52:55], v[84:87], v[20:23], 0
    v_mfma_f32_16x16x32_bf16 v[76:79], v[128:131], v[128:131], 0
    ds_read_b64_tr_b16 v[84:85], v8 offset:27680
    ds_read_b64_tr_b16 v[86:87], v8 offset:28960
    v_mfma_f32_16x16x32_bf16 v[32:35], v[88:91], v[128:131], 0
    v_mfma_f32_16x16x32_bf16 v[56:59], v[88:91], v[20:23], 0
    ds_read_b64_tr_b16 v[88:89], v8 offset:27712
    ds_read_b64_tr_b16 v[90:91], v8 offset:28992
    v_mfma_f32_16x16x32_bf16 v[36:39], v[92:95], v[128:131], 0
    v_mfma_f32_16x16x32_bf16 v[60:63], v[92:95], v[20:23], 0
    ds_read_b64_tr_b16 v[92:93], v8 offset:27744
    ds_read_b64_tr_b16 v[94:95], v8 offset:29024
    v_mfma_f32_16x16x32_bf16 v[40:43], v[96:99], v[128:131], 0
    v_mfma_f32_16x16x32_bf16 v[64:67], v[96:99], v[20:23], 0
    ds_read_b64_tr_b16 v[96:97], v8 offset:27776
    ds_read_b64_tr_b16 v[98:99], v8 offset:29056
    s_waitcnt lgkmcnt(15)
    v_mfma_f32_16x16x32_bf16 v[44:47], v[100:103], v[128:131], 0
    v_mfma_f32_16x16x32_bf16 v[68:71], v[100:103], v[20:23], 0
    ds_read_b64_tr_b16 v[100:101], v11 offset:37888
    ds_read_b64_tr_b16 v[102:103], v11 offset:38016
    v_mfma_f32_16x16x32_bf16 v[24:27], v[104:107], v[132:135], v[24:27]
    v_mfma_f32_16x16x32_bf16 v[48:51], v[104:107], v[20:23], v[48:51]
    v_mfma_f32_16x16x32_bf16 v[72:75], v[20:23], v[132:135], v[72:75]
    ds_read_b128 v[128:131], v5 offset:19456
    ds_read_b64_tr_b16 v[104:105], v8 offset:32768
    ds_read_b64_tr_b16 v[106:107], v8 offset:34048
    v_mfma_f32_16x16x32_bf16 v[28:31], v[108:111], v[132:135], v[28:31]
    v_mfma_f32_16x16x32_bf16 v[52:55], v[108:111], v[20:23], v[52:55]
    v_mfma_f32_16x16x32_bf16 v[76:79], v[132:135], v[132:135], v[76:79]
    ds_read_b64_tr_b16 v[108:109], v8 offset:32800
    ds_read_b64_tr_b16 v[110:111], v8 offset:34080
    v_mfma_f32_16x16x32_bf16 v[32:35], v[112:115], v[132:135], v[32:35]
    v_mfma_f32_16x16x32_bf16 v[56:59], v[112:115], v[20:23], v[56:59]
    ds_read_b64_tr_b16 v[112:113], v8 offset:32832
    ds_read_b64_tr_b16 v[114:115], v8 offset:34112
    v_mfma_f32_16x16x32_bf16 v[36:39], v[116:119], v[132:135], v[36:39]
    v_mfma_f32_16x16x32_bf16 v[60:63], v[116:119], v[20:23], v[60:63]
    ds_read_b64_tr_b16 v[116:117], v8 offset:32864
    ds_read_b64_tr_b16 v[118:119], v8 offset:34144
    s_waitcnt lgkmcnt(15)
    v_mfma_f32_16x16x32_bf16 v[40:43], v[120:123], v[132:135], v[40:43]
    v_mfma_f32_16x16x32_bf16 v[64:67], v[120:123], v[20:23], v[64:67]
    ds_read_b64_tr_b16 v[120:121], v8 offset:32896
    ds_read_b64_tr_b16 v[122:123], v8 offset:34176
    v_mfma_f32_16x16x32_bf16 v[44:47], v[124:127], v[132:135], v[44:47]
    v_mfma_f32_16x16x32_bf16 v[68:71], v[124:127], v[20:23], v[68:71]
    ds_read_b64_tr_b16 v[124:125], v11 offset:38400
    ds_read_b64_tr_b16 v[126:127], v11 offset:38528
    v_mfma_f32_16x16x32_bf16 v[24:27], v[80:83], v[136:139], v[24:27]
    v_mfma_f32_16x16x32_bf16 v[48:51], v[80:83], v[20:23], v[48:51]
    v_mfma_f32_16x16x32_bf16 v[72:75], v[20:23], v[136:139], v[72:75]
    s_barrier
    ds_read_b128 v[132:135], v2 offset:38912
    ds_read_b64_tr_b16 v[80:81], v8 offset:47104
    ds_read_b64_tr_b16 v[82:83], v8 offset:48384
    v_mfma_f32_16x16x32_bf16 v[28:31], v[84:87], v[136:139], v[28:31]
    v_mfma_f32_16x16x32_bf16 v[52:55], v[84:87], v[20:23], v[52:55]
    v_mfma_f32_16x16x32_bf16 v[76:79], v[136:139], v[136:139], v[76:79]
    ds_read_b64_tr_b16 v[84:85], v8 offset:47136
    ds_read_b64_tr_b16 v[86:87], v8 offset:48416
    v_mfma_f32_16x16x32_bf16 v[32:35], v[88:91], v[136:139], v[32:35]
    v_mfma_f32_16x16x32_bf16 v[56:59], v[88:91], v[20:23], v[56:59]
    ds_read_b64_tr_b16 v[88:89], v8 offset:47168
    ds_read_b64_tr_b16 v[90:91], v8 offset:48448
    s_waitcnt lgkmcnt(15)
    v_mfma_f32_16x16x32_bf16 v[36:39], v[92:95], v[136:139], v[36:39]
    v_mfma_f32_16x16x32_bf16 v[60:63], v[92:95], v[20:23], v[60:63]
    ds_read_b64_tr_b16 v[92:93], v8 offset:47200
    ds_read_b64_tr_b16 v[94:95], v8 offset:48480
    v_mfma_f32_16x16x32_bf16 v[40:43], v[96:99], v[136:139], v[40:43]
    v_mfma_f32_16x16x32_bf16 v[64:67], v[96:99], v[20:23], v[64:67]
    ds_read_b64_tr_b16 v[96:97], v8 offset:47232
    ds_read_b64_tr_b16 v[98:99], v8 offset:48512
    v_mfma_f32_16x16x32_bf16 v[44:47], v[100:103], v[136:139], v[44:47]
    v_mfma_f32_16x16x32_bf16 v[68:71], v[100:103], v[20:23], v[68:71]
    ds_read_b64_tr_b16 v[100:101], v11 offset:57344
    ds_read_b64_tr_b16 v[102:103], v11 offset:57472
    v_mfma_f32_16x16x32_bf16 v[24:27], v[104:107], v[128:131], v[24:27]
    v_mfma_f32_16x16x32_bf16 v[48:51], v[104:107], v[20:23], v[48:51]
    v_mfma_f32_16x16x32_bf16 v[72:75], v[20:23], v[128:131], v[72:75]
    ds_read_b128 v[136:139], v5 offset:38912
    ds_read_b64_tr_b16 v[104:105], v8 offset:52224
    ds_read_b64_tr_b16 v[106:107], v8 offset:53504
    v_mfma_f32_16x16x32_bf16 v[28:31], v[108:111], v[128:131], v[28:31]
    v_mfma_f32_16x16x32_bf16 v[52:55], v[108:111], v[20:23], v[52:55]
    v_mfma_f32_16x16x32_bf16 v[76:79], v[128:131], v[128:131], v[76:79]
    ds_read_b64_tr_b16 v[108:109], v8 offset:52256
    ds_read_b64_tr_b16 v[110:111], v8 offset:53536
    s_waitcnt lgkmcnt(15)
    v_mfma_f32_16x16x32_bf16 v[32:35], v[112:115], v[128:131], v[32:35]
    v_mfma_f32_16x16x32_bf16 v[56:59], v[112:115], v[20:23], v[56:59]
    ds_read_b64_tr_b16 v[112:113], v8 offset:52288
    ds_read_b64_tr_b16 v[114:115], v8 offset:53568
    v_mfma_f32_16x16x32_bf16 v[36:39], v[116:119], v[128:131], v[36:39]
    v_mfma_f32_16x16x32_bf16 v[60:63], v[116:119], v[20:23], v[60:63]
    ds_read_b64_tr_b16 v[116:117], v8 offset:52320
    ds_read_b64_tr_b16 v[118:119], v8 offset:53600
    v_mfma_f32_16x16x32_bf16 v[40:43], v[120:123], v[128:131], v[40:43]
    v_mfma_f32_16x16x32_bf16 v[64:67], v[120:123], v[20:23], v[64:67]
    ds_read_b64_tr_b16 v[120:121], v8 offset:52352
    ds_read_b64_tr_b16 v[122:123], v8 offset:53632
    v_mfma_f32_16x16x32_bf16 v[44:47], v[124:127], v[128:131], v[44:47]
    v_mfma_f32_16x16x32_bf16 v[68:71], v[124:127], v[20:23], v[68:71]
    ds_read_b64_tr_b16 v[124:125], v11 offset:57856
    ds_read_b64_tr_b16 v[126:127], v11 offset:57984
    v_mfma_f32_16x16x32_bf16 v[24:27], v[80:83], v[132:135], v[24:27]
    v_mfma_f32_16x16x32_bf16 v[48:51], v[80:83], v[20:23], v[48:51]
    v_mfma_f32_16x16x32_bf16 v[72:75], v[20:23], v[132:135], v[72:75]
    s_barrier
    ds_read_b128 v[128:131], v2 offset:58368
    ds_read_b64_tr_b16 v[80:81], v9 offset:1024
    ds_read_b64_tr_b16 v[82:83], v9 offset:2304
    s_waitcnt lgkmcnt(15)
    v_mfma_f32_16x16x32_bf16 v[28:31], v[84:87], v[132:135], v[28:31]
    v_mfma_f32_16x16x32_bf16 v[52:55], v[84:87], v[20:23], v[52:55]
    v_mfma_f32_16x16x32_bf16 v[76:79], v[132:135], v[132:135], v[76:79]
    ds_read_b64_tr_b16 v[84:85], v9 offset:1056
    ds_read_b64_tr_b16 v[86:87], v9 offset:2336
    v_mfma_f32_16x16x32_bf16 v[32:35], v[88:91], v[132:135], v[32:35]
    v_mfma_f32_16x16x32_bf16 v[56:59], v[88:91], v[20:23], v[56:59]
    ds_read_b64_tr_b16 v[88:89], v9 offset:1088
    ds_read_b64_tr_b16 v[90:91], v9 offset:2368
    v_mfma_f32_16x16x32_bf16 v[36:39], v[92:95], v[132:135], v[36:39]
    v_mfma_f32_16x16x32_bf16 v[60:63], v[92:95], v[20:23], v[60:63]
    ds_read_b64_tr_b16 v[92:93], v9 offset:1120
    ds_read_b64_tr_b16 v[94:95], v9 offset:2400
    v_mfma_f32_16x16x32_bf16 v[40:43], v[96:99], v[132:135], v[40:43]
    v_mfma_f32_16x16x32_bf16 v[64:67], v[96:99], v[20:23], v[64:67]
    ds_read_b64_tr_b16 v[96:97], v9 offset:1152
    ds_read_b64_tr_b16 v[98:99], v9 offset:2432
    v_mfma_f32_16x16x32_bf16 v[44:47], v[100:103], v[132:135], v[44:47]
    v_mfma_f32_16x16x32_bf16 v[68:71], v[100:103], v[20:23], v[68:71]
    ds_read_b64_tr_b16 v[100:101], v12 offset:11264
    ds_read_b64_tr_b16 v[102:103], v12 offset:11392
    s_waitcnt lgkmcnt(15)
    v_mfma_f32_16x16x32_bf16 v[24:27], v[104:107], v[136:139], v[24:27]
    v_mfma_f32_16x16x32_bf16 v[48:51], v[104:107], v[20:23], v[48:51]
    v_mfma_f32_16x16x32_bf16 v[72:75], v[20:23], v[136:139], v[72:75]
    ds_read_b128 v[132:135], v5 offset:58368
    ds_read_b64_tr_b16 v[104:105], v9 offset:6144
    ds_read_b64_tr_b16 v[106:107], v9 offset:7424
    v_mfma_f32_16x16x32_bf16 v[28:31], v[108:111], v[136:139], v[28:31]
    v_mfma_f32_16x16x32_bf16 v[52:55], v[108:111], v[20:23], v[52:55]
    v_mfma_f32_16x16x32_bf16 v[76:79], v[136:139], v[136:139], v[76:79]
    ds_read_b64_tr_b16 v[108:109], v9 offset:6176
    ds_read_b64_tr_b16 v[110:111], v9 offset:7456
    v_mfma_f32_16x16x32_bf16 v[32:35], v[112:115], v[136:139], v[32:35]
    v_mfma_f32_16x16x32_bf16 v[56:59], v[112:115], v[20:23], v[56:59]
    ds_read_b64_tr_b16 v[112:113], v9 offset:6208
    ds_read_b64_tr_b16 v[114:115], v9 offset:7488
    v_mfma_f32_16x16x32_bf16 v[36:39], v[116:119], v[136:139], v[36:39]
    v_mfma_f32_16x16x32_bf16 v[60:63], v[116:119], v[20:23], v[60:63]
    ds_read_b64_tr_b16 v[116:117], v9 offset:6240
    ds_read_b64_tr_b16 v[118:119], v9 offset:7520
    v_mfma_f32_16x16x32_bf16 v[40:43], v[120:123], v[136:139], v[40:43]
    v_mfma_f32_16x16x32_bf16 v[64:67], v[120:123], v[20:23], v[64:67]
    ds_read_b64_tr_b16 v[120:121], v9 offset:6272
    ds_read_b64_tr_b16 v[122:123], v9 offset:7552
    s_waitcnt lgkmcnt(15)
    v_mfma_f32_16x16x32_bf16 v[44:47], v[124:127], v[136:139], v[44:47]
    v_mfma_f32_16x16x32_bf16 v[68:71], v[124:127], v[20:23], v[68:71]
    ds_read_b64_tr_b16 v[124:125], v12 offset:11776
    ds_read_b64_tr_b16 v[126:127], v12 offset:11904
    v_mfma_f32_16x16x32_bf16 v[24:27], v[80:83], v[128:131], v[24:27]
    v_mfma_f32_16x16x32_bf16 v[48:51], v[80:83], v[20:23], v[48:51]
    v_mfma_f32_16x16x32_bf16 v[72:75], v[20:23], v[128:131], v[72:75]
    s_barrier
    ds_read_b128 v[136:139], v3 offset:12288
    ds_read_b64_tr_b16 v[80:81], v9 offset:20480
    ds_read_b64_tr_b16 v[82:83], v9 offset:21760
    v_mfma_f32_16x16x32_bf16 v[28:31], v[84:87], v[128:131], v[28:31]
    v_mfma_f32_16x16x32_bf16 v[52:55], v[84:87], v[20:23], v[52:55]
    v_mfma_f32_16x16x32_bf16 v[76:79], v[128:131], v[128:131], v[76:79]
    ds_read_b64_tr_b16 v[84:85], v9 offset:20512
    ds_read_b64_tr_b16 v[86:87], v9 offset:21792
    v_mfma_f32_16x16x32_bf16 v[32:35], v[88:91], v[128:131], v[32:35]
    v_mfma_f32_16x16x32_bf16 v[56:59], v[88:91], v[20:23], v[56:59]
    ds_read_b64_tr_b16 v[88:89], v9 offset:20544
    ds_read_b64_tr_b16 v[90:91], v9 offset:21824
    v_mfma_f32_16x16x32_bf16 v[36:39], v[92:95], v[128:131], v[36:39]
    v_mfma_f32_16x16x32_bf16 v[60:63], v[92:95], v[20:23], v[60:63]
    ds_read_b64_tr_b16 v[92:93], v9 offset:20576
    ds_read_b64_tr_b16 v[94:95], v9 offset:21856
    s_waitcnt lgkmcnt(15)
    v_mfma_f32_16x16x32_bf16 v[40:43], v[96:99], v[128:131], v[40:43]
    v_mfma_f32_16x16x32_bf16 v[64:67], v[96:99], v[20:23], v[64:67]
    ds_read_b64_tr_b16 v[96:97], v9 offset:20608
    ds_read_b64_tr_b16 v[98:99], v9 offset:21888
    v_mfma_f32_16x16x32_bf16 v[44:47], v[100:103], v[128:131], v[44:47]
    v_mfma_f32_16x16x32_bf16 v[68:71], v[100:103], v[20:23], v[68:71]
    ds_read_b64_tr_b16 v[100:101], v12 offset:30720
    ds_read_b64_tr_b16 v[102:103], v12 offset:30848
    v_mfma_f32_16x16x32_bf16 v[24:27], v[104:107], v[132:135], v[24:27]
    v_mfma_f32_16x16x32_bf16 v[48:51], v[104:107], v[20:23], v[48:51]
    v_mfma_f32_16x16x32_bf16 v[72:75], v[20:23], v[132:135], v[72:75]
    ds_read_b128 v[128:131], v6 offset:12288
    ds_read_b64_tr_b16 v[104:105], v9 offset:25600
    ds_read_b64_tr_b16 v[106:107], v9 offset:26880
    v_mfma_f32_16x16x32_bf16 v[28:31], v[108:111], v[132:135], v[28:31]
    v_mfma_f32_16x16x32_bf16 v[52:55], v[108:111], v[20:23], v[52:55]
    v_mfma_f32_16x16x32_bf16 v[76:79], v[132:135], v[132:135], v[76:79]
    ds_read_b64_tr_b16 v[108:109], v9 offset:25632
    ds_read_b64_tr_b16 v[110:111], v9 offset:26912
    v_mfma_f32_16x16x32_bf16 v[32:35], v[112:115], v[132:135], v[32:35]
    v_mfma_f32_16x16x32_bf16 v[56:59], v[112:115], v[20:23], v[56:59]
    ds_read_b64_tr_b16 v[112:113], v9 offset:25664
    ds_read_b64_tr_b16 v[114:115], v9 offset:26944
    s_waitcnt lgkmcnt(15)
    v_mfma_f32_16x16x32_bf16 v[36:39], v[116:119], v[132:135], v[36:39]
    v_mfma_f32_16x16x32_bf16 v[60:63], v[116:119], v[20:23], v[60:63]
    ds_read_b64_tr_b16 v[116:117], v9 offset:25696
    ds_read_b64_tr_b16 v[118:119], v9 offset:26976
    v_mfma_f32_16x16x32_bf16 v[40:43], v[120:123], v[132:135], v[40:43]
    v_mfma_f32_16x16x32_bf16 v[64:67], v[120:123], v[20:23], v[64:67]
    ds_read_b64_tr_b16 v[120:121], v9 offset:25728
    ds_read_b64_tr_b16 v[122:123], v9 offset:27008
    v_mfma_f32_16x16x32_bf16 v[44:47], v[124:127], v[132:135], v[44:47]
    v_mfma_f32_16x16x32_bf16 v[68:71], v[124:127], v[20:23], v[68:71]
    ds_read_b64_tr_b16 v[124:125], v12 offset:31232
    ds_read_b64_tr_b16 v[126:127], v12 offset:31360
    v_mfma_f32_16x16x32_bf16 v[24:27], v[80:83], v[136:139], v[24:27]
    v_mfma_f32_16x16x32_bf16 v[48:51], v[80:83], v[20:23], v[48:51]
    v_mfma_f32_16x16x32_bf16 v[72:75], v[20:23], v[136:139], v[72:75]
    s_barrier
    ds_read_b128 v[132:135], v3 offset:31744
    ds_read_b64_tr_b16 v[80:81], v9 offset:39936
    ds_read_b64_tr_b16 v[82:83], v9 offset:41216
    v_mfma_f32_16x16x32_bf16 v[28:31], v[84:87], v[136:139], v[28:31]
    v_mfma_f32_16x16x32_bf16 v[52:55], v[84:87], v[20:23], v[52:55]
    v_mfma_f32_16x16x32_bf16 v[76:79], v[136:139], v[136:139], v[76:79]
    ds_read_b64_tr_b16 v[84:85], v9 offset:39968
    ds_read_b64_tr_b16 v[86:87], v9 offset:41248
    s_waitcnt lgkmcnt(15)
    v_mfma_f32_16x16x32_bf16 v[32:35], v[88:91], v[136:139], v[32:35]
    v_mfma_f32_16x16x32_bf16 v[56:59], v[88:91], v[20:23], v[56:59]
    ds_read_b64_tr_b16 v[88:89], v9 offset:40000
    ds_read_b64_tr_b16 v[90:91], v9 offset:41280
    v_mfma_f32_16x16x32_bf16 v[36:39], v[92:95], v[136:139], v[36:39]
    v_mfma_f32_16x16x32_bf16 v[60:63], v[92:95], v[20:23], v[60:63]
    ds_read_b64_tr_b16 v[92:93], v9 offset:40032
    ds_read_b64_tr_b16 v[94:95], v9 offset:41312
    v_mfma_f32_16x16x32_bf16 v[40:43], v[96:99], v[136:139], v[40:43]
    v_mfma_f32_16x16x32_bf16 v[64:67], v[96:99], v[20:23], v[64:67]
    ds_read_b64_tr_b16 v[96:97], v9 offset:40064
    ds_read_b64_tr_b16 v[98:99], v9 offset:41344
    v_mfma_f32_16x16x32_bf16 v[44:47], v[100:103], v[136:139], v[44:47]
    v_mfma_f32_16x16x32_bf16 v[68:71], v[100:103], v[20:23], v[68:71]
    ds_read_b64_tr_b16 v[100:101], v12 offset:50176
    ds_read_b64_tr_b16 v[102:103], v12 offset:50304
    v_mfma_f32_16x16x32_bf16 v[24:27], v[104:107], v[128:131], v[24:27]
    v_mfma_f32_16x16x32_bf16 v[48:51], v[104:107], v[20:23], v[48:51]
    v_mfma_f32_16x16x32_bf16 v[72:75], v[20:23], v[128:131], v[72:75]
    ds_read_b128 v[136:139], v6 offset:31744
    ds_read_b64_tr_b16 v[104:105], v9 offset:45056
    ds_read_b64_tr_b16 v[106:107], v9 offset:46336
    s_waitcnt lgkmcnt(15)
    v_mfma_f32_16x16x32_bf16 v[28:31], v[108:111], v[128:131], v[28:31]
    v_mfma_f32_16x16x32_bf16 v[52:55], v[108:111], v[20:23], v[52:55]
    v_mfma_f32_16x16x32_bf16 v[76:79], v[128:131], v[128:131], v[76:79]
    ds_read_b64_tr_b16 v[108:109], v9 offset:45088
    ds_read_b64_tr_b16 v[110:111], v9 offset:46368
    v_mfma_f32_16x16x32_bf16 v[32:35], v[112:115], v[128:131], v[32:35]
    v_mfma_f32_16x16x32_bf16 v[56:59], v[112:115], v[20:23], v[56:59]
    ds_read_b64_tr_b16 v[112:113], v9 offset:45120
    ds_read_b64_tr_b16 v[114:115], v9 offset:46400
    v_mfma_f32_16x16x32_bf16 v[36:39], v[116:119], v[128:131], v[36:39]
    v_mfma_f32_16x16x32_bf16 v[60:63], v[116:119], v[20:23], v[60:63]
    ds_read_b64_tr_b16 v[116:117], v9 offset:45152
    ds_read_b64_tr_b16 v[118:119], v9 offset:46432
    v_mfma_f32_16x16x32_bf16 v[40:43], v[120:123], v[128:131], v[40:43]
    v_mfma_f32_16x16x32_bf16 v[64:67], v[120:123], v[20:23], v[64:67]
    ds_read_b64_tr_b16 v[120:121], v9 offset:45184
    ds_read_b64_tr_b16 v[122:123], v9 offset:46464
    v_mfma_f32_16x16x32_bf16 v[44:47], v[124:127], v[128:131], v[44:47]
    v_mfma_f32_16x16x32_bf16 v[68:71], v[124:127], v[20:23], v[68:71]
    ds_read_b64_tr_b16 v[124:125], v12 offset:50688
    ds_read_b64_tr_b16 v[126:127], v12 offset:50816
    s_waitcnt lgkmcnt(15)
    v_mfma_f32_16x16x32_bf16 v[24:27], v[80:83], v[132:135], v[24:27]
    v_mfma_f32_16x16x32_bf16 v[48:51], v[80:83], v[20:23], v[48:51]
    v_mfma_f32_16x16x32_bf16 v[72:75], v[20:23], v[132:135], v[72:75]
    s_barrier
    ds_read_b128 v[128:131], v3 offset:51200
    ds_read_b64_tr_b16 v[80:81], v9 offset:59392
    ds_read_b64_tr_b16 v[82:83], v9 offset:60672
    v_mfma_f32_16x16x32_bf16 v[28:31], v[84:87], v[132:135], v[28:31]
    v_mfma_f32_16x16x32_bf16 v[52:55], v[84:87], v[20:23], v[52:55]
    v_mfma_f32_16x16x32_bf16 v[76:79], v[132:135], v[132:135], v[76:79]
    ds_read_b64_tr_b16 v[84:85], v9 offset:59424
    ds_read_b64_tr_b16 v[86:87], v9 offset:60704
    v_mfma_f32_16x16x32_bf16 v[32:35], v[88:91], v[132:135], v[32:35]
    v_mfma_f32_16x16x32_bf16 v[56:59], v[88:91], v[20:23], v[56:59]
    ds_read_b64_tr_b16 v[88:89], v9 offset:59456
    ds_read_b64_tr_b16 v[90:91], v9 offset:60736
    v_mfma_f32_16x16x32_bf16 v[36:39], v[92:95], v[132:135], v[36:39]
    v_mfma_f32_16x16x32_bf16 v[60:63], v[92:95], v[20:23], v[60:63]
    ds_read_b64_tr_b16 v[92:93], v9 offset:59488
    ds_read_b64_tr_b16 v[94:95], v9 offset:60768
    v_mfma_f32_16x16x32_bf16 v[40:43], v[96:99], v[132:135], v[40:43]
    v_mfma_f32_16x16x32_bf16 v[64:67], v[96:99], v[20:23], v[64:67]
    ds_read_b64_tr_b16 v[96:97], v9 offset:59520
    ds_read_b64_tr_b16 v[98:99], v9 offset:60800
    s_waitcnt lgkmcnt(15)
    v_mfma_f32_16x16x32_bf16 v[44:47], v[100:103], v[132:135], v[44:47]
    v_mfma_f32_16x16x32_bf16 v[68:71], v[100:103], v[20:23], v[68:71]
    ds_read_b64_tr_b16 v[100:101], v13 offset:4096
    ds_read_b64_tr_b16 v[102:103], v13 offset:4224
    v_mfma_f32_16x16x32_bf16 v[24:27], v[104:107], v[136:139], v[24:27]
    v_mfma_f32_16x16x32_bf16 v[48:51], v[104:107], v[20:23], v[48:51]
    v_mfma_f32_16x16x32_bf16 v[72:75], v[20:23], v[136:139], v[72:75]
    ds_read_b128 v[132:135], v6 offset:51200
    ds_read_b64_tr_b16 v[104:105], v9 offset:64512
    ds_read_b64_tr_b16 v[106:107], v10 offset:256
    v_mfma_f32_16x16x32_bf16 v[28:31], v[108:111], v[136:139], v[28:31]
    v_mfma_f32_16x16x32_bf16 v[52:55], v[108:111], v[20:23], v[52:55]
    v_mfma_f32_16x16x32_bf16 v[76:79], v[136:139], v[136:139], v[76:79]
    ds_read_b64_tr_b16 v[108:109], v9 offset:64544
    ds_read_b64_tr_b16 v[110:111], v10 offset:288
    v_mfma_f32_16x16x32_bf16 v[32:35], v[112:115], v[136:139], v[32:35]
    v_mfma_f32_16x16x32_bf16 v[56:59], v[112:115], v[20:23], v[56:59]
    ds_read_b64_tr_b16 v[112:113], v9 offset:64576
    ds_read_b64_tr_b16 v[114:115], v10 offset:320
    v_mfma_f32_16x16x32_bf16 v[36:39], v[116:119], v[136:139], v[36:39]
    v_mfma_f32_16x16x32_bf16 v[60:63], v[116:119], v[20:23], v[60:63]
    ds_read_b64_tr_b16 v[116:117], v9 offset:64608
    ds_read_b64_tr_b16 v[118:119], v10 offset:352
    s_waitcnt lgkmcnt(15)
    v_mfma_f32_16x16x32_bf16 v[40:43], v[120:123], v[136:139], v[40:43]
    v_mfma_f32_16x16x32_bf16 v[64:67], v[120:123], v[20:23], v[64:67]
    ds_read_b64_tr_b16 v[120:121], v9 offset:64640
    ds_read_b64_tr_b16 v[122:123], v10 offset:384
    v_mfma_f32_16x16x32_bf16 v[44:47], v[124:127], v[136:139], v[44:47]
    v_mfma_f32_16x16x32_bf16 v[68:71], v[124:127], v[20:23], v[68:71]
    ds_read_b64_tr_b16 v[124:125], v13 offset:4608
    ds_read_b64_tr_b16 v[126:127], v13 offset:4736
    v_mfma_f32_16x16x32_bf16 v[24:27], v[80:83], v[128:131], v[24:27]
    v_mfma_f32_16x16x32_bf16 v[48:51], v[80:83], v[20:23], v[48:51]
    v_mfma_f32_16x16x32_bf16 v[72:75], v[20:23], v[128:131], v[72:75]
    s_barrier
    ds_read_b128 v[136:139], v4 offset:5120
    ds_read_b64_tr_b16 v[80:81], v10 offset:13312
    ds_read_b64_tr_b16 v[82:83], v10 offset:14592
    v_mfma_f32_16x16x32_bf16 v[28:31], v[84:87], v[128:131], v[28:31]
    v_mfma_f32_16x16x32_bf16 v[52:55], v[84:87], v[20:23], v[52:55]
    v_mfma_f32_16x16x32_bf16 v[76:79], v[128:131], v[128:131], v[76:79]
    ds_read_b64_tr_b16 v[84:85], v10 offset:13344
    ds_read_b64_tr_b16 v[86:87], v10 offset:14624
    v_mfma_f32_16x16x32_bf16 v[32:35], v[88:91], v[128:131], v[32:35]
    v_mfma_f32_16x16x32_bf16 v[56:59], v[88:91], v[20:23], v[56:59]
    ds_read_b64_tr_b16 v[88:89], v10 offset:13376
    ds_read_b64_tr_b16 v[90:91], v10 offset:14656
    s_waitcnt lgkmcnt(15)
    v_mfma_f32_16x16x32_bf16 v[36:39], v[92:95], v[128:131], v[36:39]
    v_mfma_f32_16x16x32_bf16 v[60:63], v[92:95], v[20:23], v[60:63]
    ds_read_b64_tr_b16 v[92:93], v10 offset:13408
    ds_read_b64_tr_b16 v[94:95], v10 offset:14688
    v_mfma_f32_16x16x32_bf16 v[40:43], v[96:99], v[128:131], v[40:43]
    v_mfma_f32_16x16x32_bf16 v[64:67], v[96:99], v[20:23], v[64:67]
    ds_read_b64_tr_b16 v[96:97], v10 offset:13440
    ds_read_b64_tr_b16 v[98:99], v10 offset:14720
    v_mfma_f32_16x16x32_bf16 v[44:47], v[100:103], v[128:131], v[44:47]
    v_mfma_f32_16x16x32_bf16 v[68:71], v[100:103], v[20:23], v[68:71]
    ds_read_b64_tr_b16 v[100:101], v13 offset:23552
    ds_read_b64_tr_b16 v[102:103], v13 offset:23680
    v_mfma_f32_16x16x32_bf16 v[24:27], v[104:107], v[132:135], v[24:27]
    v_mfma_f32_16x16x32_bf16 v[48:51], v[104:107], v[20:23], v[48:51]
    v_mfma_f32_16x16x32_bf16 v[72:75], v[20:23], v[132:135], v[72:75]
    ds_read_b128 v[128:131], v7 offset:5120
    ds_read_b64_tr_b16 v[104:105], v10 offset:18432
    ds_read_b64_tr_b16 v[106:107], v10 offset:19712
    v_mfma_f32_16x16x32_bf16 v[28:31], v[108:111], v[132:135], v[28:31]
    v_mfma_f32_16x16x32_bf16 v[52:55], v[108:111], v[20:23], v[52:55]
    v_mfma_f32_16x16x32_bf16 v[76:79], v[132:135], v[132:135], v[76:79]
    ds_read_b64_tr_b16 v[108:109], v10 offset:18464
    ds_read_b64_tr_b16 v[110:111], v10 offset:19744
    s_waitcnt lgkmcnt(15)
    v_mfma_f32_16x16x32_bf16 v[32:35], v[112:115], v[132:135], v[32:35]
    v_mfma_f32_16x16x32_bf16 v[56:59], v[112:115], v[20:23], v[56:59]
    ds_read_b64_tr_b16 v[112:113], v10 offset:18496
    ds_read_b64_tr_b16 v[114:115], v10 offset:19776
    v_mfma_f32_16x16x32_bf16 v[36:39], v[116:119], v[132:135], v[36:39]
    v_mfma_f32_16x16x32_bf16 v[60:63], v[116:119], v[20:23], v[60:63]
    ds_read_b64_tr_b16 v[116:117], v10 offset:18528
    ds_read_b64_tr_b16 v[118:119], v10 offset:19808
    v_mfma_f32_16x16x32_bf16 v[40:43], v[120:123], v[132:135], v[40:43]
    v_mfma_f32_16x16x32_bf16 v[64:67], v[120:123], v[20:23], v[64:67]
    ds_read_b64_tr_b16 v[120:121], v10 offset:18560
    ds_read_b64_tr_b16 v[122:123], v10 offset:19840
    v_mfma_f32_16x16x32_bf16 v[44:47], v[124:127], v[132:135], v[44:47]
    v_mfma_f32_16x16x32_bf16 v[68:71], v[124:127], v[20:23], v[68:71]
    ds_read_b64_tr_b16 v[124:125], v13 offset:24064
    ds_read_b64_tr_b16 v[126:127], v13 offset:24192
    v_mfma_f32_16x16x32_bf16 v[24:27], v[80:83], v[136:139], v[24:27]
    v_mfma_f32_16x16x32_bf16 v[48:51], v[80:83], v[20:23], v[48:51]
    v_mfma_f32_16x16x32_bf16 v[72:75], v[20:23], v[136:139], v[72:75]
    s_barrier
    ds_read_b128 v[132:135], v2 offset:0
    ds_read_b64_tr_b16 v[80:81], v8 offset:8192
    ds_read_b64_tr_b16 v[82:83], v8 offset:9472
    s_waitcnt lgkmcnt(15)
    v_mfma_f32_16x16x32_bf16 v[28:31], v[84:87], v[136:139], v[28:31]
    v_mfma_f32_16x16x32_bf16 v[52:55], v[84:87], v[20:23], v[52:55]
    v_mfma_f32_16x16x32_bf16 v[76:79], v[136:139], v[136:139], v[76:79]
    ds_read_b64_tr_b16 v[84:85], v8 offset:8224
    ds_read_b64_tr_b16 v[86:87], v8 offset:9504
    v_mfma_f32_16x16x32_bf16 v[32:35], v[88:91], v[136:139], v[32:35]
    v_mfma_f32_16x16x32_bf16 v[56:59], v[88:91], v[20:23], v[56:59]
    ds_read_b64_tr_b16 v[88:89], v8 offset:8256
    ds_read_b64_tr_b16 v[90:91], v8 offset:9536
    v_mfma_f32_16x16x32_bf16 v[36:39], v[92:95], v[136:139], v[36:39]
    v_mfma_f32_16x16x32_bf16 v[60:63], v[92:95], v[20:23], v[60:63]
    ds_read_b64_tr_b16 v[92:93], v8 offset:8288
    ds_read_b64_tr_b16 v[94:95], v8 offset:9568
    v_mfma_f32_16x16x32_bf16 v[40:43], v[96:99], v[136:139], v[40:43]
    v_mfma_f32_16x16x32_bf16 v[64:67], v[96:99], v[20:23], v[64:67]
    ds_read_b64_tr_b16 v[96:97], v8 offset:8320
    ds_read_b64_tr_b16 v[98:99], v8 offset:9600
    v_mfma_f32_16x16x32_bf16 v[44:47], v[100:103], v[136:139], v[44:47]
    v_mfma_f32_16x16x32_bf16 v[68:71], v[100:103], v[20:23], v[68:71]
    ds_read_b64_tr_b16 v[100:101], v11 offset:18432
    ds_read_b64_tr_b16 v[102:103], v11 offset:18560
    s_waitcnt lgkmcnt(15)
    v_mfma_f32_16x16x32_bf16 v[24:27], v[104:107], v[128:131], v[24:27]
    v_mfma_f32_16x16x32_bf16 v[48:51], v[104:107], v[20:23], v[48:51]
    v_mfma_f32_16x16x32_bf16 v[72:75], v[20:23], v[128:131], v[72:75]
    ds_read_b128 v[136:139], v5 offset:0
    ds_read_b64_tr_b16 v[104:105], v8 offset:13312
    ds_read_b64_tr_b16 v[106:107], v8 offset:14592
    v_mfma_f32_16x16x32_bf16 v[28:31], v[108:111], v[128:131], v[28:31]
    v_mfma_f32_16x16x32_bf16 v[52:55], v[108:111], v[20:23], v[52:55]
    v_mfma_f32_16x16x32_bf16 v[76:79], v[128:131], v[128:131], v[76:79]
    ds_read_b64_tr_b16 v[108:109], v8 offset:13344
    ds_read_b64_tr_b16 v[110:111], v8 offset:14624
    v_mfma_f32_16x16x32_bf16 v[32:35], v[112:115], v[128:131], v[32:35]
    v_mfma_f32_16x16x32_bf16 v[56:59], v[112:115], v[20:23], v[56:59]
    ds_read_b64_tr_b16 v[112:113], v8 offset:13376
    ds_read_b64_tr_b16 v[114:115], v8 offset:14656
    v_mfma_f32_16x16x32_bf16 v[36:39], v[116:119], v[128:131], v[36:39]
    v_mfma_f32_16x16x32_bf16 v[60:63], v[116:119], v[20:23], v[60:63]
    ds_read_b64_tr_b16 v[116:117], v8 offset:13408
    ds_read_b64_tr_b16 v[118:119], v8 offset:14688
    v_mfma_f32_16x16x32_bf16 v[40:43], v[120:123], v[128:131], v[40:43]
    v_mfma_f32_16x16x32_bf16 v[64:67], v[120:123], v[20:23], v[64:67]
    ds_read_b64_tr_b16 v[120:121], v8 offset:13440
    ds_read_b64_tr_b16 v[122:123], v8 offset:14720
    s_waitcnt lgkmcnt(15)
    v_mfma_f32_16x16x32_bf16 v[44:47], v[124:127], v[128:131], v[44:47]
    v_mfma_f32_16x16x32_bf16 v[68:71], v[124:127], v[20:23], v[68:71]
    ds_read_b64_tr_b16 v[124:125], v11 offset:18944
    ds_read_b64_tr_b16 v[126:127], v11 offset:19072
    v_mfma_f32_16x16x32_bf16 v[24:27], v[80:83], v[132:135], v[24:27]
    v_mfma_f32_16x16x32_bf16 v[48:51], v[80:83], v[20:23], v[48:51]
    v_mfma_f32_16x16x32_bf16 v[72:75], v[20:23], v[132:135], v[72:75]
    s_barrier
    ds_read_b128 v[128:131], v2 offset:19456
    ds_read_b64_tr_b16 v[80:81], v8 offset:27648
    ds_read_b64_tr_b16 v[82:83], v8 offset:28928
    v_mfma_f32_16x16x32_bf16 v[28:31], v[84:87], v[132:135], v[28:31]
    v_mfma_f32_16x16x32_bf16 v[52:55], v[84:87], v[20:23], v[52:55]
    v_mfma_f32_16x16x32_bf16 v[76:79], v[132:135], v[132:135], v[76:79]
    ds_read_b64_tr_b16 v[84:85], v8 offset:27680
    ds_read_b64_tr_b16 v[86:87], v8 offset:28960
    v_mfma_f32_16x16x32_bf16 v[32:35], v[88:91], v[132:135], v[32:35]
    v_mfma_f32_16x16x32_bf16 v[56:59], v[88:91], v[20:23], v[56:59]
    ds_read_b64_tr_b16 v[88:89], v8 offset:27712
    ds_read_b64_tr_b16 v[90:91], v8 offset:28992
    v_mfma_f32_16x16x32_bf16 v[36:39], v[92:95], v[132:135], v[36:39]
    v_mfma_f32_16x16x32_bf16 v[60:63], v[92:95], v[20:23], v[60:63]
    ds_read_b64_tr_b16 v[92:93], v8 offset:27744
    ds_read_b64_tr_b16 v[94:95], v8 offset:29024
    s_waitcnt lgkmcnt(15)
    v_mfma_f32_16x16x32_bf16 v[40:43], v[96:99], v[132:135], v[40:43]
    v_mfma_f32_16x16x32_bf16 v[64:67], v[96:99], v[20:23], v[64:67]
    ds_read_b64_tr_b16 v[96:97], v8 offset:27776
    ds_read_b64_tr_b16 v[98:99], v8 offset:29056
    v_mfma_f32_16x16x32_bf16 v[44:47], v[100:103], v[132:135], v[44:47]
    v_mfma_f32_16x16x32_bf16 v[68:71], v[100:103], v[20:23], v[68:71]
    ds_read_b64_tr_b16 v[100:101], v11 offset:37888
    ds_read_b64_tr_b16 v[102:103], v11 offset:38016
    v_mfma_f32_16x16x32_bf16 v[24:27], v[104:107], v[136:139], v[24:27]
    v_mfma_f32_16x16x32_bf16 v[48:51], v[104:107], v[20:23], v[48:51]
    v_mfma_f32_16x16x32_bf16 v[72:75], v[20:23], v[136:139], v[72:75]
    ds_read_b128 v[132:135], v5 offset:19456
    ds_read_b64_tr_b16 v[104:105], v8 offset:32768
    ds_read_b64_tr_b16 v[106:107], v8 offset:34048
    v_mfma_f32_16x16x32_bf16 v[28:31], v[108:111], v[136:139], v[28:31]
    v_mfma_f32_16x16x32_bf16 v[52:55], v[108:111], v[20:23], v[52:55]
    v_mfma_f32_16x16x32_bf16 v[76:79], v[136:139], v[136:139], v[76:79]
    ds_read_b64_tr_b16 v[108:109], v8 offset:32800
    ds_read_b64_tr_b16 v[110:111], v8 offset:34080
    v_mfma_f32_16x16x32_bf16 v[32:35], v[112:115], v[136:139], v[32:35]
    v_mfma_f32_16x16x32_bf16 v[56:59], v[112:115], v[20:23], v[56:59]
    ds_read_b64_tr_b16 v[112:113], v8 offset:32832
    ds_read_b64_tr_b16 v[114:115], v8 offset:34112
    s_waitcnt lgkmcnt(15)
    v_mfma_f32_16x16x32_bf16 v[36:39], v[116:119], v[136:139], v[36:39]
    v_mfma_f32_16x16x32_bf16 v[60:63], v[116:119], v[20:23], v[60:63]
    ds_read_b64_tr_b16 v[116:117], v8 offset:32864
    ds_read_b64_tr_b16 v[118:119], v8 offset:34144
    v_mfma_f32_16x16x32_bf16 v[40:43], v[120:123], v[136:139], v[40:43]
    v_mfma_f32_16x16x32_bf16 v[64:67], v[120:123], v[20:23], v[64:67]
    ds_read_b64_tr_b16 v[120:121], v8 offset:32896
    ds_read_b64_tr_b16 v[122:123], v8 offset:34176
    v_mfma_f32_16x16x32_bf16 v[44:47], v[124:127], v[136:139], v[44:47]
    v_mfma_f32_16x16x32_bf16 v[68:71], v[124:127], v[20:23], v[68:71]
    ds_read_b64_tr_b16 v[124:125], v11 offset:38400
    ds_read_b64_tr_b16 v[126:127], v11 offset:38528
    v_mfma_f32_16x16x32_bf16 v[24:27], v[80:83], v[128:131], v[24:27]
    v_mfma_f32_16x16x32_bf16 v[48:51], v[80:83], v[20:23], v[48:51]
    v_mfma_f32_16x16x32_bf16 v[72:75], v[20:23], v[128:131], v[72:75]
    v_mfma_f32_16x16x32_bf16 v[28:31], v[84:87], v[128:131], v[28:31]
    v_mfma_f32_16x16x32_bf16 v[52:55], v[84:87], v[20:23], v[52:55]
    v_mfma_f32_16x16x32_bf16 v[76:79], v[128:131], v[128:131], v[76:79]
    s_waitcnt lgkmcnt(15)
    v_mfma_f32_16x16x32_bf16 v[32:35], v[88:91], v[128:131], v[32:35]
    v_mfma_f32_16x16x32_bf16 v[56:59], v[88:91], v[20:23], v[56:59]
    v_mfma_f32_16x16x32_bf16 v[36:39], v[92:95], v[128:131], v[36:39]
    v_mfma_f32_16x16x32_bf16 v[60:63], v[92:95], v[20:23], v[60:63]
    v_mfma_f32_16x16x32_bf16 v[40:43], v[96:99], v[128:131], v[40:43]
    v_mfma_f32_16x16x32_bf16 v[64:67], v[96:99], v[20:23], v[64:67]
    s_waitcnt lgkmcnt(13)
    v_mfma_f32_16x16x32_bf16 v[44:47], v[100:103], v[128:131], v[44:47]
    v_mfma_f32_16x16x32_bf16 v[68:71], v[100:103], v[20:23], v[68:71]
    s_waitcnt lgkmcnt(10)
    v_mfma_f32_16x16x32_bf16 v[24:27], v[104:107], v[132:135], v[24:27]
    v_mfma_f32_16x16x32_bf16 v[48:51], v[104:107], v[20:23], v[48:51]
    v_mfma_f32_16x16x32_bf16 v[72:75], v[20:23], v[132:135], v[72:75]
    s_waitcnt lgkmcnt(8)
    v_mfma_f32_16x16x32_bf16 v[28:31], v[108:111], v[132:135], v[28:31]
    v_mfma_f32_16x16x32_bf16 v[52:55], v[108:111], v[20:23], v[52:55]
    v_mfma_f32_16x16x32_bf16 v[76:79], v[132:135], v[132:135], v[76:79]
    s_waitcnt lgkmcnt(6)
    v_mfma_f32_16x16x32_bf16 v[32:35], v[112:115], v[132:135], v[32:35]
    v_mfma_f32_16x16x32_bf16 v[56:59], v[112:115], v[20:23], v[56:59]
    s_waitcnt lgkmcnt(4)
    v_mfma_f32_16x16x32_bf16 v[36:39], v[116:119], v[132:135], v[36:39]
    v_mfma_f32_16x16x32_bf16 v[60:63], v[116:119], v[20:23], v[60:63]
    s_waitcnt lgkmcnt(2)
    v_mfma_f32_16x16x32_bf16 v[40:43], v[120:123], v[132:135], v[40:43]
    v_mfma_f32_16x16x32_bf16 v[64:67], v[120:123], v[20:23], v[64:67]
    s_waitcnt lgkmcnt(0)
    v_mfma_f32_16x16x32_bf16 v[44:47], v[124:127], v[132:135], v[44:47]
    v_mfma_f32_16x16x32_bf16 v[68:71], v[124:127], v[20:23], v[68:71]
    s_nop 7
    s_nop 7
    v_and_b32 v140, 15, v1
    v_and_b32 v141, 3, v1
    v_cmp_eq_u32 vcc, 1, v141
    s_nop 1
    v_cndmask_b32 v142, v76, v77, vcc
    v_cmp_eq_u32 vcc, 2, v141
    s_nop 1
    v_cndmask_b32 v142, v142, v78, vcc
    v_cmp_eq_u32 vcc, 3, v141
    s_nop 1
    v_cndmask_b32 v142, v142, v79, vcc
    v_lshrrev_b32 v143, 2, v140
    v_lshl_add_u32 v143, v143, 4, v140
    v_lshlrev_b32 v143, 2, v143
    ds_bpermute_b32 v142, v143, v142
    v_mul_f32 v144, 0x3acccccd, v72
    s_waitcnt lgkmcnt(0)
    v_mul_f32 v142, 0x3acccccd, v142
    v_fma_f32 v142, -v144, v144, v142
    v_max_f32 v142, 0, v142
    v_cvt_pk_bf16_f32 v142, v142, v142
    v_lshlrev_b32 v142, 16, v142
    v_add_f32 v142, 0x3727c5ac, v142
    v_cvt_pk_bf16_f32 v142, v142, v142
    v_lshlrev_b32 v142, 16, v142
    v_sqrt_f32 v142, v142
    v_cvt_pk_bf16_f32 v144, v144, v144
    v_lshlrev_b32 v144, 16, v144
    v_cvt_pk_bf16_f32 v142, v142, v142
    v_lshlrev_b32 v142, 16, v142
    v_rcp_f32 v145, v142
    s_nop 0
    v_mul_f32 v146, 0x3ea52b5c, v145
    s_lshl_b32 s36, s32, 4
    s_add_u32 s36, s36, s33
    v_add_u32 v147, s36, v140
    v_lshrrev_b32 v148, 4, v1
    v_mul_u32_u24 v149, 1280, v147
    v_lshl_add_u32 v149, v148, 3, v149
    v_add_u32 v149, s34, v149
    v_fma_f32 v24, -v144, v48, v24
    v_mul_f32 v24, v24, v146
    v_fma_f32 v25, -v144, v49, v25
    v_mul_f32 v25, v25, v146
    v_fma_f32 v26, -v144, v50, v26
    v_mul_f32 v26, v26, v146
    v_fma_f32 v27, -v144, v51, v27
    v_mul_f32 v27, v27, v146
    v_cvt_pk_bf16_f32 v150, v24, v25
    v_cvt_pk_bf16_f32 v151, v26, v27
    buffer_store_dwordx2 v[150:151], v149, s[20:23], 0 offen offset:0
    v_fma_f32 v28, -v144, v52, v28
    v_mul_f32 v28, v28, v146
    v_fma_f32 v29, -v144, v53, v29
    v_mul_f32 v29, v29, v146
    v_fma_f32 v30, -v144, v54, v30
    v_mul_f32 v30, v30, v146
    v_fma_f32 v31, -v144, v55, v31
    v_mul_f32 v31, v31, v146
    v_cvt_pk_bf16_f32 v152, v28, v29
    v_cvt_pk_bf16_f32 v153, v30, v31
    buffer_store_dwordx2 v[152:153], v149, s[20:23], 0 offen offset:32
    v_fma_f32 v32, -v144, v56, v32
    v_mul_f32 v32, v32, v146
    v_fma_f32 v33, -v144, v57, v33
    v_mul_f32 v33, v33, v146
    v_fma_f32 v34, -v144, v58, v34
    v_mul_f32 v34, v34, v146
    v_fma_f32 v35, -v144, v59, v35
    v_mul_f32 v35, v35, v146
    v_cvt_pk_bf16_f32 v150, v32, v33
    v_cvt_pk_bf16_f32 v151, v34, v35
    buffer_store_dwordx2 v[150:151], v149, s[20:23], 0 offen offset:64
    v_fma_f32 v36, -v144, v60, v36
    v_mul_f32 v36, v36, v146
    v_fma_f32 v37, -v144, v61, v37
    v_mul_f32 v37, v37, v146
    v_fma_f32 v38, -v144, v62, v38
    v_mul_f32 v38, v38, v146
    v_fma_f32 v39, -v144, v63, v39
    v_mul_f32 v39, v39, v146
    v_cvt_pk_bf16_f32 v152, v36, v37
    v_cvt_pk_bf16_f32 v153, v38, v39
    buffer_store_dwordx2 v[152:153], v149, s[20:23], 0 offen offset:96
    v_fma_f32 v40, -v144, v64, v40
    v_mul_f32 v40, v40, v146
    v_fma_f32 v41, -v144, v65, v41
    v_mul_f32 v41, v41, v146
    v_fma_f32 v42, -v144, v66, v42
    v_mul_f32 v42, v42, v146
    v_fma_f32 v43, -v144, v67, v43
    v_mul_f32 v43, v43, v146
    v_cvt_pk_bf16_f32 v150, v40, v41
    v_cvt_pk_bf16_f32 v151, v42, v43
    buffer_store_dwordx2 v[150:151], v149, s[20:23], 0 offen offset:128
    v_fma_f32 v44, -v144, v68, v44
    v_mul_f32 v44, v44, v145
    v_fma_f32 v45, -v144, v69, v45
    v_mul_f32 v45, v45, v145
    v_fma_f32 v46, -v144, v70, v46
    v_mul_f32 v46, v46, v145
    v_fma_f32 v47, -v144, v71, v47
    v_mul_f32 v47, v47, v145
    v_cvt_pk_bf16_f32 v154, v44, v45
    v_cvt_pk_bf16_f32 v155, v46, v47
    s_lshr_b32 s36, s35, 1
    v_lshl_add_u32 v150, v148, 2, s36
    v_lshrrev_b32 v151, 5, v147
    v_lshlrev_b32 v151, 11, v151
    v_and_b32 v152, 31, v147
    s_cmp_ge_u32 s51, 4
    s_cbranch_scc1 L_k1_v
    v_lshrrev_b32 v153, 3, v150
    v_lshlrev_b32 v153, 9, v153
    v_add_u32 v153, v153, v151
    v_lshl_add_u32 v153, v152, 4, v153
    v_and_b32 v149, 7, v150
    v_lshl_add_u32 v153, v149, 1, v153
    v_add_u32 v153, 0x300000, v153
    v_cmp_gt_u32 vcc, 2, v148
    s_and_saveexec_b64 s[40:41], vcc
    buffer_store_dwordx2 v[154:155], v153, s[20:23], 0 offen
    s_mov_b64 exec, s[40:41]
    v_and_b32 v44, 0x7fffffff, v44
    v_and_b32 v45, 0x7fffffff, v45
    v_and_b32 v46, 0x7fffffff, v46
    v_and_b32 v47, 0x7fffffff, v47
    s_nop 1
    v_max_f32_dpp v44, v44, v44 row_ror:8 row_mask:0xf bank_mask:0xf
    v_max_f32_dpp v45, v45, v45 row_ror:8 row_mask:0xf bank_mask:0xf
    v_max_f32_dpp v46, v46, v46 row_ror:8 row_mask:0xf bank_mask:0xf
    v_max_f32_dpp v47, v47, v47 row_ror:8 row_mask:0xf bank_mask:0xf
    s_nop 1
    v_max_f32_dpp v44, v44, v44 row_ror:4 row_mask:0xf bank_mask:0xf
    v_max_f32_dpp v45, v45, v45 row_ror:4 row_mask:0xf bank_mask:0xf
    v_max_f32_dpp v46, v46, v46 row_ror:4 row_mask:0xf bank_mask:0xf
    v_max_f32_dpp v47, v47, v47 row_ror:4 row_mask:0xf bank_mask:0xf
    s_nop 1
    v_max_f32_dpp v44, v44, v44 row_ror:2 row_mask:0xf bank_mask:0xf
    v_max_f32_dpp v45, v45, v45 row_ror:2 row_mask:0xf bank_mask:0xf
    v_max_f32_dpp v46, v46, v46 row_ror:2 row_mask:0xf bank_mask:0xf
    v_max_f32_dpp v47, v47, v47 row_ror:2 row_mask:0xf bank_mask:0xf
    s_nop 1
    v_max_f32_dpp v44, v44, v44 row_ror:1 row_mask:0xf bank_mask:0xf
    v_max_f32_dpp v45, v45, v45 row_ror:1 row_mask:0xf bank_mask:0xf
    v_max_f32_dpp v46, v46, v46 row_ror:1 row_mask:0xf bank_mask:0xf
    v_max_f32_dpp v47, v47, v47 row_ror:1 row_mask:0xf bank_mask:0xf
    v_lshlrev_b32 v149, 2, v150
    v_add_u32 v149, 155648, v149
    v_cmp_gt_u32 vcc, 2, v148
    s_and_saveexec_b64 s[40:41], vcc
    ds_max_f32 v149, v44 offset:0
    ds_max_f32 v149, v45 offset:4
    ds_max_f32 v149, v46 offset:8
    ds_max_f32 v149, v47 offset:12
    s_mov_b64 exec, s[40:41]
    s_cmp_lg_u32 s51, 3
    s_cbranch_scc1 L_k1_kskip
    v_mov_b32 v154, 0x3f803f80
    v_mov_b32 v155, 0x00003f80
    v_cmp_eq_u32 vcc, 1, v148
    s_and_saveexec_b64 s[40:41], vcc
    buffer_store_dwordx2 v[154:155], v153, s[20:23], 0 offen offset:8
    s_mov_b64 exec, s[40:41]
    v_mov_b32 v156, 0
    v_mov_b32 v157, 0
    v_mov_b32 v158, 0
    v_mov_b32 v159, 0
    v_lshl_add_u32 v153, v152, 4, v151
    v_add_u32 v153, 0x300600, v153
    v_cmp_eq_u32 vcc, 2, v148
    s_and_saveexec_b64 s[40:41], vcc
    buffer_store_dwordx4 v[156:159], v153, s[20:23], 0 offen
    s_mov_b64 exec, s[40:41]
L_k1_kskip:
    s_waitcnt lgkmcnt(0)
    s_barrier
    s_cmp_lg_u32 s32, 0
    s_cbranch_scc1 L_k1_kernel_end
    s_lshr_b32 s36, s35, 1
    v_add_u32 v140, s36, v1
    v_lshlrev_b32 v140, 2, v140
    v_add_u32 v141, 155648, v140
    ds_read_b32 v142, v141
    s_lshl_b32 s36, s52, 7
    s_add_u32 s36, s36, 0x380000
    v_add_u32 v140, s36, v140
    v_cmp_gt_u32 vcc, 8, v1
    s_and_saveexec_b64 s[40:41], vcc
    s_waitcnt lgkmcnt(0)
    buffer_store_dword v142, v140, s[20:23], 0 offen
    s_branch L_k1_kernel_end
L_k1_v:
    v_lshrrev_b32 v153, 4, v152
    v_lshl_add_u32 v153, v153, 10, v151
    v_bfe_u32 v149, v152, 2, 1
    v_lshl_add_u32 v153, v149, 9, v153
    v_and_b32 v149, 3, v152
    v_lshl_add_u32 v153, v149, 1, v153
    v_bfe_u32 v149, v152, 3, 1
    v_lshl_add_u32 v153, v149, 3, v153
    v_lshl_add_u32 v153, v150, 4, v153
    v_add_u32 v153, 0x340000, v153
    v_cmp_gt_u32 vcc, 2, v148
    s_and_saveexec_b64 s[40:41], vcc
    buffer_store_short v154, v153, s[20:23], 0 offen
    buffer_store_short_d16_hi v154, v153, s[20:23], 0 offen offset:16
    buffer_store_short v155, v153, s[20:23], 0 offen offset:32
    buffer_store_short_d16_hi v155, v153, s[20:23], 0 offen offset:48
    s_mov_b64 exec, s[40:41]
    s_cmp_lg_u32 s51, 7
    s_cbranch_scc1 L_k1_kernel_end
    v_mov_b32 v154, 0x3f80
    v_cmp_eq_u32 vcc, 2, v148
    s_and_saveexec_b64 s[40:41], vcc
    buffer_store_short v154, v153, s[20:23], 0 offen
    s_branch L_k1_kernel_end
L_k1_kernel_prod:
    s_and_b32 s32, s32, 3
    s_mul_i32 s54, s55, 1
    s_mul_i32 s57, s56, 3
    s_add_u32 s54, s54, s57
    s_sub_u32 s57, s54, 10
    s_cmp_ge_u32 s54, 10
    s_cselect_b32 s54, s57, s54
    s_mov_b32 s45, 0
    s_lshl_b32 s36, s32, 3
    s_add_u32 s36, s36, 0
    v_lshrrev_b32 v27, 3, v1
    v_add_u32 v27, s36, v27
    v_lshrrev_b32 v28, 1, v27
    v_xor_b32 v28, v28, v1
    v_and_b32 v28, 7, v28
    v_add_u32 v27, s33, v27
    s_mov_b32 s36, 1280
    v_mul_lo_u32 v27, v27, s36
    v_lshl_add_u32 v2, v28, 4, v27
    s_lshl_b32 s36, s32, 3
    s_add_u32 s36, s36, 32
    v_lshrrev_b32 v27, 3, v1
    v_add_u32 v27, s36, v27
    v_lshrrev_b32 v28, 1, v27
    v_xor_b32 v28, v28, v1
    v_and_b32 v28, 7, v28
    v_add_u32 v27, s33, v27
    s_mov_b32 s36, 1280
    v_mul_lo_u32 v27, v27, s36
    v_lshl_add_u32 v3, v28, 4, v27
    s_mov_b32 s37, 0
    s_mov_b32 s38, 6554
    s_mov_b32 s39, 10
    s_mov_b32 s41, 1280
    s_mov_b32 s42, s34
    s_cmp_ge_u32 s32, 1
    s_cselect_b32 s37, 64, s37
    s_cmp_ge_u32 s32, 2
    s_cselect_b32 s37, 128, s37
    s_cmp_ge_u32 s32, 3
    s_cselect_b32 s37, 192, s37
    v_add_u32 v27, s37, v1
    v_mul_lo_u32 v28, v27, s38
    v_lshrrev_b32 v28, 16, v28
    v_mul_lo_u32 v29, v28, s39
    v_sub_u32 v27, v27, v29
    v_and_b32 v29, 4, v28
    v_lshlrev_b32 v29, 1, v29
    v_and_b32 v4, 8, v28
    v_lshrrev_b32 v4, 1, v4
    v_or_b32 v29, v29, v4
    v_and_b32 v28, 0xf3, v28
    v_or_b32 v28, v28, v29
    v_mul_lo_u32 v28, v28, s41
    v_lshl_add_u32 v28, v27, 4, v28
    v_add_u32 v4, s42, v28
    s_mov_b32 s37, 256
    s_mov_b32 s38, 6554
    s_mov_b32 s39, 10
    s_mov_b32 s41, 1280
    s_mov_b32 s42, s34
    s_cmp_ge_u32 s32, 1
    s_cselect_b32 s37, 320, s37
    s_cmp_ge_u32 s32, 2
    s_cselect_b32 s37, 384, s37
    s_cmp_ge_u32 s32, 3
    s_cselect_b32 s37, 448, s37
    v_add_u32 v27, s37, v1
    v_mul_lo_u32 v28, v27, s38
    v_lshrrev_b32 v28, 16, v28
    v_mul_lo_u32 v29, v28, s39
    v_sub_u32 v27, v27, v29
    v_and_b32 v29, 4, v28
    v_lshlrev_b32 v29, 1, v29
    v_and_b32 v5, 8, v28
    v_lshrrev_b32 v5, 1, v5
    v_or_b32 v29, v29, v5
    v_and_b32 v28, 0xf3, v28
    v_or_b32 v28, v28, v29
    v_mul_lo_u32 v28, v28, s41
    v_lshl_add_u32 v28, v27, 4, v28
    v_add_u32 v5, s42, v28
    s_mov_b32 s37, 512
    s_mov_b32 s38, 6554
    s_mov_b32 s39, 10
    s_mov_b32 s41, 1280
    s_mov_b32 s42, s34
    s_cmp_ge_u32 s32, 1
    s_cselect_b32 s37, 576, s37
    s_cmp_ge_u32 s32, 2
    s_cselect_b32 s37, 0, s37
    s_cselect_b32 s38, 65536, s38
    s_cselect_b32 s39, 1, s39
    s_cselect_b32 s41, 40, s41
    s_cselect_b32 s42, s35, s42
    v_add_u32 v27, s37, v1
    v_mul_lo_u32 v28, v27, s38
    v_lshrrev_b32 v28, 16, v28
    v_mul_lo_u32 v29, v28, s39
    v_sub_u32 v27, v27, v29
    v_and_b32 v29, 4, v28
    v_lshlrev_b32 v29, 1, v29
    v_and_b32 v6, 8, v28
    v_lshrrev_b32 v6, 1, v6
    v_or_b32 v29, v29, v6
    v_and_b32 v28, 0xf3, v28
    v_or_b32 v28, v28, v29
    v_mul_lo_u32 v28, v28, s41
    v_lshl_add_u32 v28, v27, 4, v28
    v_add_u32 v6, s42, v28
    s_mov_b32 s16, s8
    s_mov_b32 s17, s9
    s_mov_b32 s18, s10
    s_mov_b32 s19, s11
    s_mov_b32 s44, 16384
    s_mov_b32 s45, 81920
    s_cmp_ge_u32 s32, 1
    s_cselect_b32 s44, 17408, s44
    s_cmp_ge_u32 s32, 2
    s_cselect_b32 s16, s12, s16
    s_cselect_b32 s17, s13, s17
    s_cselect_b32 s18, s14, s18
    s_cselect_b32 s45, 2560, s45
    s_cselect_b32 s44, 18432, s44
    s_lshl_b32 s46, s32, 10
    s_cmp_ge_u32 s32, 3
    s_cbranch_scc1 L_k1_kernel_prod1
    s_lshl_b32 s47, s54, 7
    s_mul_i32 s48, s54, 81920
    s_mul_i32 s49, s54, 2560
    s_mul_i32 s50, s45, s54
    s_add_u32 s54, s54, 1
    s_cmp_eq_u32 s54, 10
    s_cselect_b32 s54, 0, s54
    s_add_u32 m0, s46, 0
    s_nop 0
    buffer_load_dwordx4 v2, s[4:7], s47 offen lds
    s_add_u32 m0, s46, 4096
    s_nop 0
    buffer_load_dwordx4 v3, s[4:7], s47 offen lds
    s_add_u32 m0, s46, 8192
    s_nop 0
    buffer_load_dwordx4 v4, s[8:11], s48 offen lds
    s_add_u32 m0, s46, 12288
    s_nop 0
    buffer_load_dwordx4 v5, s[8:11], s48 offen lds
    s_add_u32 m0, s44, 0
    s_nop 0
    buffer_load_dwordx4 v6, s[16:19], s50 offen lds
    s_lshl_b32 s47, s54, 7
    s_mul_i32 s48, s54, 81920
    s_mul_i32 s49, s54, 2560
    s_mul_i32 s50, s45, s54
    s_add_u32 s54, s54, 1
    s_cmp_eq_u32 s54, 10
    s_cselect_b32 s54, 0, s54
    s_add_u32 m0, s46, 19456
    s_nop 0
    buffer_load_dwordx4 v2, s[4:7], s47 offen lds
    s_add_u32 m0, s46, 23552
    s_nop 0
    buffer_load_dwordx4 v3, s[4:7], s47 offen lds
    s_add_u32 m0, s46, 27648
    s_nop 0
    buffer_load_dwordx4 v4, s[8:11], s48 offen lds
    s_add_u32 m0, s46, 31744
    s_nop 0
    buffer_load_dwordx4 v5, s[8:11], s48 offen lds
    s_add_u32 m0, s44, 19456
    s_nop 0
    buffer_load_dwordx4 v6, s[16:19], s50 offen lds
    s_lshl_b32 s47, s54, 7
    s_mul_i32 s48, s54, 81920
    s_mul_i32 s49, s54, 2560
    s_mul_i32 s50, s45, s54
    s_add_u32 s54, s54, 1
    s_cmp_eq_u32 s54, 10
    s_cselect_b32 s54, 0, s54
    s_add_u32 m0, s46, 38912
    s_nop 0
    buffer_load_dwordx4 v2, s[4:7], s47 offen lds
    s_add_u32 m0, s46, 43008
    s_nop 0
    buffer_load_dwordx4 v3, s[4:7], s47 offen lds
    s_add_u32 m0, s46, 47104
    s_nop 0
    buffer_load_dwordx4 v4, s[8:11], s48 offen lds
    s_add_u32 m0, s46, 51200
    s_nop 0
    buffer_load_dwordx4 v5, s[8:11], s48 offen lds
    s_add_u32 m0, s44, 38912
    s_nop 0
    buffer_load_dwordx4 v6, s[16:19], s50 offen lds
    s_lshl_b32 s47, s54, 7
    s_mul_i32 s48, s54, 81920
    s_mul_i32 s49, s54, 2560
    s_mul_i32 s50, s45, s54
    s_add_u32 s54, s54, 1
    s_cmp_eq_u32 s54, 10
    s_cselect_b32 s54, 0, s54
    s_add_u32 m0, s46, 58368
    s_nop 0
    buffer_load_dwordx4 v2, s[4:7], s47 offen lds
    s_add_u32 m0, s46, 62464
    s_nop 0
    buffer_load_dwordx4 v3, s[4:7], s47 offen lds
    s_add_u32 m0, s46, 66560
    s_nop 0
    buffer_load_dwordx4 v4, s[8:11], s48 offen lds
    s_add_u32 m0, s46, 70656
    s_nop 0
    buffer_load_dwordx4 v5, s[8:11], s48 offen lds
    s_add_u32 m0, s44, 58368
    s_nop 0
    buffer_load_dwordx4 v6, s[16:19], s50 offen lds
    s_waitcnt vmcnt(15)
    s_barrier
    s_lshl_b32 s47, s54, 7
    s_mul_i32 s48, s54, 81920
    s_mul_i32 s49, s54, 2560
    s_mul_i32 s50, s45, s54
    s_add_u32 s54, s54, 1
    s_cmp_eq_u32 s54, 10
    s_cselect_b32 s54, 0, s54
    s_add_u32 m0, s46, 77824
    s_nop 0
    buffer_load_dwordx4 v2, s[4:7], s47 offen lds
    s_add_u32 m0, s46, 81920
    s_nop 0
    buffer_load_dwordx4 v3, s[4:7], s47 offen lds
    s_add_u32 m0, s46, 86016
    s_nop 0
    buffer_load_dwordx4 v4, s[8:11], s48 offen lds
    s_add_u32 m0, s46, 90112
    s_nop 0
    buffer_load_dwordx4 v5, s[8:11], s48 offen lds
    s_add_u32 m0, s44, 77824
    s_nop 0
    buffer_load_dwordx4 v6, s[16:19], s50 offen lds
    s_waitcnt vmcnt(15)
    s_barrier
    s_lshl_b32 s47, s54, 7
    s_mul_i32 s48, s54, 81920
    s_mul_i32 s49, s54, 2560
    s_mul_i32 s50, s45, s54
    s_add_u32 s54, s54, 1
    s_cmp_eq_u32 s54, 10
    s_cselect_b32 s54, 0, s54
    s_add_u32 m0, s46, 97280
    s_nop 0
    buffer_load_dwordx4 v2, s[4:7], s47 offen lds
    s_add_u32 m0, s46, 101376
    s_nop 0
    buffer_load_dwordx4 v3, s[4:7], s47 offen lds
    s_add_u32 m0, s46, 105472
    s_nop 0
    buffer_load_dwordx4 v4, s[8:11], s48 offen lds
    s_add_u32 m0, s46, 109568
    s_nop 0
    buffer_load_dwordx4 v5, s[8:11], s48 offen lds
    s_add_u32 m0, s44, 97280
    s_nop 0
    buffer_load_dwordx4 v6, s[16:19], s50 offen lds
    s_waitcnt vmcnt(15)
    s_barrier
    s_lshl_b32 s47, s54, 7
    s_mul_i32 s48, s54, 81920
    s_mul_i32 s49, s54, 2560
    s_mul_i32 s50, s45, s54
    s_add_u32 s54, s54, 1
    s_cmp_eq_u32 s54, 10
    s_cselect_b32 s54, 0, s54
    s_add_u32 m0, s46, 116736
    s_nop 0
    buffer_load_dwordx4 v2, s[4:7], s47 offen lds
    s_add_u32 m0, s46, 120832
    s_nop 0
    buffer_load_dwordx4 v3, s[4:7], s47 offen lds
    s_add_u32 m0, s46, 124928
    s_nop 0
    buffer_load_dwordx4 v4, s[8:11], s48 offen lds
    s_add_u32 m0, s46, 129024
    s_nop 0
    buffer_load_dwordx4 v5, s[8:11], s48 offen lds
    s_add_u32 m0, s44, 116736
    s_nop 0
    buffer_load_dwordx4 v6, s[16:19], s50 offen lds
    s_waitcnt vmcnt(15)
    s_barrier
    s_lshl_b32 s47, s54, 7
    s_mul_i32 s48, s54, 81920
    s_mul_i32 s49, s54, 2560
    s_mul_i32 s50, s45, s54
    s_add_u32 s54, s54, 1
    s_cmp_eq_u32 s54, 10
    s_cselect_b32 s54, 0, s54
    s_add_u32 m0, s46, 136192
    s_nop 0
    buffer_load_dwordx4 v2, s[4:7], s47 offen lds
    s_add_u32 m0, s46, 140288
    s_nop 0
    buffer_load_dwordx4 v3, s[4:7], s47 offen lds
    s_add_u32 m0, s46, 144384
    s_nop 0
    buffer_load_dwordx4 v4, s[8:11], s48 offen lds
    s_add_u32 m0, s46, 148480
    s_nop 0
    buffer_load_dwordx4 v5, s[8:11], s48 offen lds
    s_add_u32 m0, s44, 136192
    s_nop 0
    buffer_load_dwordx4 v6, s[16:19], s50 offen lds
    s_waitcnt vmcnt(15)
    s_barrier
    s_lshl_b32 s47, s54, 7
    s_mul_i32 s48, s54, 81920
    s_mul_i32 s49, s54, 2560
    s_mul_i32 s50, s45, s54
    s_add_u32 s54, s54, 1
    s_cmp_eq_u32 s54, 10
    s_cselect_b32 s54, 0, s54
    s_add_u32 m0, s46, 0
    s_nop 0
    buffer_load_dwordx4 v2, s[4:7], s47 offen lds
    s_add_u32 m0, s46, 4096
    s_nop 0
    buffer_load_dwordx4 v3, s[4:7], s47 offen lds
    s_add_u32 m0, s46, 8192
    s_nop 0
    buffer_load_dwordx4 v4, s[8:11], s48 offen lds
    s_add_u32 m0, s46, 12288
    s_nop 0
    buffer_load_dwordx4 v5, s[8:11], s48 offen lds
    s_add_u32 m0, s44, 0
    s_nop 0
    buffer_load_dwordx4 v6, s[16:19], s50 offen lds
    s_waitcnt vmcnt(15)
    s_barrier
    s_lshl_b32 s47, s54, 7
    s_mul_i32 s48, s54, 81920
    s_mul_i32 s49, s54, 2560
    s_mul_i32 s50, s45, s54
    s_add_u32 s54, s54, 1
    s_cmp_eq_u32 s54, 10
    s_cselect_b32 s54, 0, s54
    s_add_u32 m0, s46, 19456
    s_nop 0
    buffer_load_dwordx4 v2, s[4:7], s47 offen lds
    s_add_u32 m0, s46, 23552
    s_nop 0
    buffer_load_dwordx4 v3, s[4:7], s47 offen lds
    s_add_u32 m0, s46, 27648
    s_nop 0
    buffer_load_dwordx4 v4, s[8:11], s48 offen lds
    s_add_u32 m0, s46, 31744
    s_nop 0
    buffer_load_dwordx4 v5, s[8:11], s48 offen lds
    s_add_u32 m0, s44, 19456
    s_nop 0
    buffer_load_dwordx4 v6, s[16:19], s50 offen lds
    s_waitcnt vmcnt(15)
    s_barrier
    s_waitcnt vmcnt(10)
    s_barrier
    s_waitcnt vmcnt(5)
    s_barrier
    s_waitcnt vmcnt(0)
    s_barrier
    s_branch L_k1_kernel_end
L_k1_kernel_prod1:
    s_lshl_b32 s47, s54, 7
    s_mul_i32 s48, s54, 81920
    s_mul_i32 s49, s54, 2560
    s_mul_i32 s50, s45, s54
    s_add_u32 s54, s54, 1
    s_cmp_eq_u32 s54, 10
    s_cselect_b32 s54, 0, s54
    s_add_u32 m0, s46, 0
    s_nop 0
    buffer_load_dwordx4 v2, s[4:7], s47 offen lds
    s_add_u32 m0, s46, 4096
    s_nop 0
    buffer_load_dwordx4 v3, s[4:7], s47 offen lds
    s_add_u32 m0, s46, 8192
    s_nop 0
    buffer_load_dwordx4 v4, s[8:11], s48 offen lds
    s_add_u32 m0, s46, 12288
    s_nop 0
    buffer_load_dwordx4 v5, s[8:11], s48 offen lds
    s_lshl_b32 s47, s54, 7
    s_mul_i32 s48, s54, 81920
    s_mul_i32 s49, s54, 2560
    s_mul_i32 s50, s45, s54
    s_add_u32 s54, s54, 1
    s_cmp_eq_u32 s54, 10
    s_cselect_b32 s54, 0, s54
    s_add_u32 m0, s46, 19456
    s_nop 0
    buffer_load_dwordx4 v2, s[4:7], s47 offen lds
    s_add_u32 m0, s46, 23552
    s_nop 0
    buffer_load_dwordx4 v3, s[4:7], s47 offen lds
    s_add_u32 m0, s46, 27648
    s_nop 0
    buffer_load_dwordx4 v4, s[8:11], s48 offen lds
    s_add_u32 m0, s46, 31744
    s_nop 0
    buffer_load_dwordx4 v5, s[8:11], s48 offen lds
    s_lshl_b32 s47, s54, 7
    s_mul_i32 s48, s54, 81920
    s_mul_i32 s49, s54, 2560
    s_mul_i32 s50, s45, s54
    s_add_u32 s54, s54, 1
    s_cmp_eq_u32 s54, 10
    s_cselect_b32 s54, 0, s54
    s_add_u32 m0, s46, 38912
    s_nop 0
    buffer_load_dwordx4 v2, s[4:7], s47 offen lds
    s_add_u32 m0, s46, 43008
    s_nop 0
    buffer_load_dwordx4 v3, s[4:7], s47 offen lds
    s_add_u32 m0, s46, 47104
    s_nop 0
    buffer_load_dwordx4 v4, s[8:11], s48 offen lds
    s_add_u32 m0, s46, 51200
    s_nop 0
    buffer_load_dwordx4 v5, s[8:11], s48 offen lds
    s_lshl_b32 s47, s54, 7
    s_mul_i32 s48, s54, 81920
    s_mul_i32 s49, s54, 2560
    s_mul_i32 s50, s45, s54
    s_add_u32 s54, s54, 1
    s_cmp_eq_u32 s54, 10
    s_cselect_b32 s54, 0, s54
    s_add_u32 m0, s46, 58368
    s_nop 0
    buffer_load_dwordx4 v2, s[4:7], s47 offen lds
    s_add_u32 m0, s46, 62464
    s_nop 0
    buffer_load_dwordx4 v3, s[4:7], s47 offen lds
    s_add_u32 m0, s46, 66560
    s_nop 0
    buffer_load_dwordx4 v4, s[8:11], s48 offen lds
    s_add_u32 m0, s46, 70656
    s_nop 0
    buffer_load_dwordx4 v5, s[8:11], s48 offen lds
    s_waitcnt vmcnt(12)
    s_barrier
    s_lshl_b32 s47, s54, 7
    s_mul_i32 s48, s54, 81920
    s_mul_i32 s49, s54, 2560
    s_mul_i32 s50, s45, s54
    s_add_u32 s54, s54, 1
    s_cmp_eq_u32 s54, 10
    s_cselect_b32 s54, 0, s54
    s_add_u32 m0, s46, 77824
    s_nop 0
    buffer_load_dwordx4 v2, s[4:7], s47 offen lds
    s_add_u32 m0, s46, 81920
    s_nop 0
    buffer_load_dwordx4 v3, s[4:7], s47 offen lds
    s_add_u32 m0, s46, 86016
    s_nop 0
    buffer_load_dwordx4 v4, s[8:11], s48 offen lds
    s_add_u32 m0, s46, 90112
    s_nop 0
    buffer_load_dwordx4 v5, s[8:11], s48 offen lds
    s_waitcnt vmcnt(12)
    s_barrier
    s_lshl_b32 s47, s54, 7
    s_mul_i32 s48, s54, 81920
    s_mul_i32 s49, s54, 2560
    s_mul_i32 s50, s45, s54
    s_add_u32 s54, s54, 1
    s_cmp_eq_u32 s54, 10
    s_cselect_b32 s54, 0, s54
    s_add_u32 m0, s46, 97280
    s_nop 0
    buffer_load_dwordx4 v2, s[4:7], s47 offen lds
    s_add_u32 m0, s46, 101376
    s_nop 0
    buffer_load_dwordx4 v3, s[4:7], s47 offen lds
    s_add_u32 m0, s46, 105472
    s_nop 0
    buffer_load_dwordx4 v4, s[8:11], s48 offen lds
    s_add_u32 m0, s46, 109568
    s_nop 0
    buffer_load_dwordx4 v5, s[8:11], s48 offen lds
    s_waitcnt vmcnt(12)
    s_barrier
    s_lshl_b32 s47, s54, 7
    s_mul_i32 s48, s54, 81920
    s_mul_i32 s49, s54, 2560
    s_mul_i32 s50, s45, s54
    s_add_u32 s54, s54, 1
    s_cmp_eq_u32 s54, 10
    s_cselect_b32 s54, 0, s54
    s_add_u32 m0, s46, 116736
    s_nop 0
    buffer_load_dwordx4 v2, s[4:7], s47 offen lds
    s_add_u32 m0, s46, 120832
    s_nop 0
    buffer_load_dwordx4 v3, s[4:7], s47 offen lds
    s_add_u32 m0, s46, 124928
    s_nop 0
    buffer_load_dwordx4 v4, s[8:11], s48 offen lds
    s_add_u32 m0, s46, 129024
    s_nop 0
    buffer_load_dwordx4 v5, s[8:11], s48 offen lds
    s_waitcnt vmcnt(12)
    s_barrier
    s_lshl_b32 s47, s54, 7
    s_mul_i32 s48, s54, 81920
    s_mul_i32 s49, s54, 2560
    s_mul_i32 s50, s45, s54
    s_add_u32 s54, s54, 1
    s_cmp_eq_u32 s54, 10
    s_cselect_b32 s54, 0, s54
    s_add_u32 m0, s46, 136192
    s_nop 0
    buffer_load_dwordx4 v2, s[4:7], s47 offen lds
    s_add_u32 m0, s46, 140288
    s_nop 0
    buffer_load_dwordx4 v3, s[4:7], s47 offen lds
    s_add_u32 m0, s46, 144384
    s_nop 0
    buffer_load_dwordx4 v4, s[8:11], s48 offen lds
    s_add_u32 m0, s46, 148480
    s_nop 0
    buffer_load_dwordx4 v5, s[8:11], s48 offen lds
    s_waitcnt vmcnt(12)
    s_barrier
    s_lshl_b32 s47, s54, 7
    s_mul_i32 s48, s54, 81920
    s_mul_i32 s49, s54, 2560
    s_mul_i32 s50, s45, s54
    s_add_u32 s54, s54, 1
    s_cmp_eq_u32 s54, 10
    s_cselect_b32 s54, 0, s54
    s_add_u32 m0, s46, 0
    s_nop 0
    buffer_load_dwordx4 v2, s[4:7], s47 offen lds
    s_add_u32 m0, s46, 4096
    s_nop 0
    buffer_load_dwordx4 v3, s[4:7], s47 offen lds
    s_add_u32 m0, s46, 8192
    s_nop 0
    buffer_load_dwordx4 v4, s[8:11], s48 offen lds
    s_add_u32 m0, s46, 12288
    s_nop 0
    buffer_load_dwordx4 v5, s[8:11], s48 offen lds
    s_waitcnt vmcnt(12)
    s_barrier
    s_lshl_b32 s47, s54, 7
    s_mul_i32 s48, s54, 81920
    s_mul_i32 s49, s54, 2560
    s_mul_i32 s50, s45, s54
    s_add_u32 s54, s54, 1
    s_cmp_eq_u32 s54, 10
    s_cselect_b32 s54, 0, s54
    s_add_u32 m0, s46, 19456
    s_nop 0
    buffer_load_dwordx4 v2, s[4:7], s47 offen lds
    s_add_u32 m0, s46, 23552
    s_nop 0
    buffer_load_dwordx4 v3, s[4:7], s47 offen lds
    s_add_u32 m0, s46, 27648
    s_nop 0
    buffer_load_dwordx4 v4, s[8:11], s48 offen lds
    s_add_u32 m0, s46, 31744
    s_nop 0
    buffer_load_dwordx4 v5, s[8:11], s48 offen lds
    s_waitcnt vmcnt(12)
    s_barrier
    s_waitcnt vmcnt(8)
    s_barrier
    s_waitcnt vmcnt(4)
    s_barrier
    s_waitcnt vmcnt(0)
    s_barrier
    s_branch L_k1_kernel_end
L_k1_kernel_end:
    s_endpgm
.section .rodata,"a"
.p2align 6
.amdhsa_kernel k1_kernel
  .amdhsa_next_free_vgpr 160
  .amdhsa_next_free_sgpr 102
  .amdhsa_accum_offset 160
  .amdhsa_group_segment_fixed_size 0
  .amdhsa_kernarg_size 96
  .amdhsa_user_sgpr_count 2
  .amdhsa_user_sgpr_kernarg_segment_ptr 1
  .amdhsa_system_sgpr_workgroup_id_x 1
.end_amdhsa_kernel
.text

.globl k2_kernel
.p2align 8
.type k2_kernel,@function
k2_kernel:
    s_cmp_ge_u32 s2, 256
    s_cbranch_scc1 L_k2_kernel_end
    s_load_dwordx16 s[64:79], s[0:1], 0
    s_load_dwordx8 s[80:87], s[0:1], 64
    v_and_b32 v1, 63, v0
    v_lshrrev_b32 v2, 6, v0
    s_nop 0
    v_readfirstlane_b32 s32, v2
    s_nop 3
    s_mov_b32 s53, s32
    s_waitcnt lgkmcnt(0)
    s_add_u32 s4, s86, 0x300000
    s_addc_u32 s5, s87, 0
    s_mov_b32 s6, 0x60000
    s_mov_b32 s7, 0x20000
    s_mov_b32 s8, s86
    s_mov_b32 s9, s87
    s_mov_b32 s10, 0x800000
    s_mov_b32 s11, 0x20000
    s_lshr_b32 s33, s2, 2
    s_and_b32 s34, s2, 3
    s_and_b32 s35, s32, 3
    s_lshr_b32 s36, s32, 2
    s_lshr_b32 s37, s32, 1
    s_and_b32 s38, s32, 1
    s_lshl_b32 s40, s37, 14
    s_lshl_b32 s39, s38, 13
    s_add_u32 s40, s40, s39
    s_and_b32 s41, s37, 1
    s_lshl_b32 s41, s41, 18
    s_lshr_b32 s42, s37, 1
    s_lshl_b32 s42, s42, 16
    s_add_u32 s41, s41, s42
    s_add_u32 s41, s41, s39
    v_lshlrev_b32 v132, 4, v1
    v_lshlrev_b32 v252, 4, v1
    s_mov_b32 s60, 0
    v_add_u32 v133, 0x380000, v252
    buffer_load_dwordx4 v[136:139], v133, s[8:11], 0 offen offset:0
    buffer_load_dwordx4 v[140:143], v133, s[8:11], 0 offen offset:1024
    buffer_load_dwordx4 v[144:147], v133, s[8:11], 0 offen offset:2048
    buffer_load_dwordx4 v[148:151], v133, s[8:11], 0 offen offset:3072
    v_and_b32 v250, 31, v1
    s_lshl_b32 s39, s33, 5
    v_add_u32 v250, s39, v250
    v_lshrrev_b32 v251, 5, v1
    s_lshl_b32 s39, s34, 3
    s_lshl_b32 s44, s35, 1
    s_add_u32 s39, s39, s44
    s_mul_i32 s39, s39, 40
    v_mul_u32_u24 v249, 1280, v250
    v_add_u32 v249, s39, v249
    v_lshl_add_u32 v132, v251, 4, v249
    buffer_load_dwordx4 v[4:7], v132, s[8:11], 0 offen
    buffer_load_dwordx2 v[8:9], v249, s[8:11], 0 offen offset:32
    buffer_load_dwordx4 v[12:15], v132, s[8:11], 0 offen offset:40
    buffer_load_dwordx2 v[16:17], v249, s[8:11], 0 offen offset:72
    s_cmp_eq_u32 s38, 0
    s_cbranch_scc0 L_k2_d0skip
    s_add_u32 m0, s40, 0
    s_add_u32 s43, s41, 0
    buffer_load_dwordx4 v252, s[4:7], s43 offen offset:0 lds
    buffer_load_dwordx4 v252, s[4:7], s43 offen offset:1024 lds
    buffer_load_dwordx4 v252, s[4:7], s43 offen offset:2048 lds
    buffer_load_dwordx4 v252, s[4:7], s43 offen offset:3072 lds
    s_add_u32 m0, s40, 4096
    s_add_u32 s43, s41, 4096
    buffer_load_dwordx4 v252, s[4:7], s43 offen offset:0 lds
    buffer_load_dwordx4 v252, s[4:7], s43 offen offset:1024 lds
    buffer_load_dwordx4 v252, s[4:7], s43 offen offset:2048 lds
    buffer_load_dwordx4 v252, s[4:7], s43 offen offset:3072 lds
L_k2_d0skip:
    s_lshl_b32 s39, s36, 15
    v_add_u32 v2, s39, v252
    v_add_u32 v3, 65536, v2
    v_mov_b32 v132, 0
    v_lshlrev_b32 v133, 2, v1
    v_add_u32 v133, 131072, v133
    ds_write_b32 v133, v132
    s_cmp_lt_u32 s2, 108
    s_cselect_b32 s12, s76, s78
    s_cselect_b32 s13, s77, s79
    s_mov_b32 s14, 2211840
    s_mov_b32 s15, 0x20000
    s_sub_u32 s39, s2, 108
    s_cmp_lt_u32 s2, 108
    s_cselect_b32 s39, s2, s39
    s_lshl_b32 s39, s39, 5
    s_cmp_ge_u32 s2, 216
    s_cselect_b32 s39, 2211840, s39
    v_lshrrev_b32 v168, 1, v0
    v_mul_u32_u24 v168, 3456, v168
    v_and_b32 v135, 1, v0
    v_lshl_add_u32 v168, v135, 4, v168
    v_add_u32 v168, s39, v168
    s_mov_b32 s16, s80
    s_mov_b32 s17, s81
    s_mov_b32 s18, 0x21c000
    s_mov_b32 s19, 0x20000
    s_mov_b32 s20, s72
    s_mov_b32 s21, s73
    s_mov_b32 s22, 0xc8000
    s_mov_b32 s23, 0x20000
    s_add_u32 s24, s86, 0x1200000
    s_addc_u32 s25, s87, 0
    s_mov_b32 s26, 0x780000
    s_mov_b32 s27, 0x20000
    s_mov_b32 s28, s76
    s_mov_b32 s29, s77
    s_mov_b32 s30, 0x21c000
    s_mov_b32 s31, 0x20000
    s_mov_b32 s48, s78
    s_mov_b32 s49, s79
    s_mov_b32 s50, 0x21c000
    s_mov_b32 s51, 0x20000
    s_mul_i32 s39, s2, 200
    s_add_u32 s39, s39, 0
    v_add_u32 v132, s39, v0
    s_mov_b32 s44, 0x1999999a
    v_mul_hi_u32 v133, v132, s44
    v_mul_u32_u24 v134, 10, v133
    v_sub_u32 v134, v132, v134
    s_mov_b32 s44, 0x666667
    v_mul_hi_u32 v135, v133, s44
    v_mul_u32_u24 v176, 640, v135
    v_sub_u32 v133, v133, v176
    v_mul_u32_u24 v133, 1280, v133
    v_mul_u32_u24 v135, 10, v135
    v_add_u32 v134, v134, v135
    v_lshl_add_u32 v176, v134, 4, v133
    v_lshlrev_b32 v182, 4, v132
    v_cmp_gt_u32 vcc, 200, v0
    v_mov_b32 v132, 0x7f000000
    s_nop 0
    v_cndmask_b32 v176, v132, v176, vcc
    v_cndmask_b32 v182, v132, v182, vcc
    s_mul_i32 s39, s2, 540
    s_add_u32 s39, s39, 0
    v_add_u32 v132, s39, v0
    s_mov_b32 s44, 0x1999999a
    v_mul_hi_u32 v133, v132, s44
    v_mul_u32_u24 v134, 10, v133
    v_sub_u32 v134, v132, v134
    s_mov_b32 s44, 0x25ed0a
    v_mul_hi_u32 v135, v133, s44
    v_mul_u32_u24 v177, 1728, v135
    v_sub_u32 v133, v133, v177
    v_mul_u32_u24 v133, 1280, v133
    v_mul_u32_u24 v135, 10, v135
    v_add_u32 v134, v134, v135
    v_lshl_add_u32 v177, v134, 4, v133
    v_lshlrev_b32 v183, 4, v132
    s_mul_i32 s39, s2, 540
    s_add_u32 s39, s39, 512
    v_add_u32 v132, s39, v0
    s_mov_b32 s44, 0x1999999a
    v_mul_hi_u32 v133, v132, s44
    v_mul_u32_u24 v134, 10, v133
    v_sub_u32 v134, v132, v134
    s_mov_b32 s44, 0x25ed0a
    v_mul_hi_u32 v135, v133, s44
    v_mul_u32_u24 v178, 1728, v135
    v_sub_u32 v133, v133, v178
    v_mul_u32_u24 v133, 1280, v133
    v_mul_u32_u24 v135, 10, v135
    v_add_u32 v134, v134, v135
    v_lshl_add_u32 v178, v134, 4, v133
    v_lshlrev_b32 v184, 4, v132
    v_cmp_gt_u32 vcc, 28, v0
    v_mov_b32 v132, 0x7f000000
    s_nop 0
    v_cndmask_b32 v178, v132, v178, vcc
    v_cndmask_b32 v184, v132, v184, vcc
    s_mul_i32 s39, s2, 560
    s_add_u32 s39, s39, 0
    v_add_u32 v132, s39, v0
    s_mov_b32 s44, 0x12492493
    v_mul_hi_u32 v133, v132, s44
    v_mul_u32_u24 v134, 14, v133
    v_sub_u32 v134, v132, v134
    s_mov_b32 s44, 0x666667
    v_mul_hi_u32 v135, v133, s44
    v_mul_u32_u24 v179, 640, v135
    v_sub_u32 v133, v133, v179
    v_mul_u32_u24 v133, 3456, v133
    v_mul_u32_u24 v135, 14, v135
    v_add_u32 v134, v134, v135
    v_lshl_add_u32 v179, v134, 4, v133
    v_lshlrev_b32 v185, 4, v132
    s_mul_i32 s39, s2, 560
    s_add_u32 s39, s39, 512
    v_add_u32 v132, s39, v0
    s_mov_b32 s44, 0x12492493
    v_mul_hi_u32 v133, v132, s44
    v_mul_u32_u24 v134, 14, v133
    v_sub_u32 v134, v132, v134
    s_mov_b32 s44, 0x666667
    v_mul_hi_u32 v135, v133, s44
    v_mul_u32_u24 v180, 640, v135
    v_sub_u32 v133, v133, v180
    v_mul_u32_u24 v133, 3456, v133
    v_mul_u32_u24 v135, 14, v135
    v_add_u32 v134, v134, v135
    v_lshl_add_u32 v180, v134, 4, v133
    v_lshlrev_b32 v186, 4, v132
    v_cmp_gt_u32 vcc, 48, v0
    v_mov_b32 v132, 0x7f000000
    s_nop 0
    v_cndmask_b32 v180, v132, v180, vcc
    v_cndmask_b32 v186, v132, v186, vcc
    v_and_b32 v135, 7, v1
    v_mov_b32 v164, 0
    v_cmp_eq_u32 vcc, 0, v135
    v_mov_b32 v133, 0x3f80
    s_nop 0
    v_cndmask_b32 v164, v164, v133, vcc
    v_cmp_eq_u32 vcc, 1, v135
    v_mov_b32 v133, 0x3f800000
    s_nop 0
    v_cndmask_b32 v164, v164, v133, vcc
    v_mov_b32 v165, 0
    v_cmp_eq_u32 vcc, 2, v135
    v_mov_b32 v133, 0x3f80
    s_nop 0
    v_cndmask_b32 v165, v165, v133, vcc
    v_cmp_eq_u32 vcc, 3, v135
    v_mov_b32 v133, 0x3f800000
    s_nop 0
    v_cndmask_b32 v165, v165, v133, vcc
    v_mov_b32 v166, 0
    v_cmp_eq_u32 vcc, 4, v135
    v_mov_b32 v133, 0x3f80
    s_nop 0
    v_cndmask_b32 v166, v166, v133, vcc
    v_cmp_eq_u32 vcc, 5, v135
    v_mov_b32 v133, 0x3f800000
    s_nop 0
    v_cndmask_b32 v166, v166, v133, vcc
    v_mov_b32 v167, 0
    v_cmp_eq_u32 vcc, 6, v135
    v_mov_b32 v133, 0x3f80
    s_nop 0
    v_cndmask_b32 v167, v167, v133, vcc
    v_cmp_eq_u32 vcc, 7, v135
    v_mov_b32 v133, 0x3f800000
    s_nop 0
    v_cndmask_b32 v167, v167, v133, vcc
    s_cmp_eq_u32 s38, 0
    s_cbranch_scc1 L_k2_w1a
    s_waitcnt vmcnt(4)
    s_branch L_k2_w1b
L_k2_w1a:
    s_waitcnt vmcnt(12)
L_k2_w1b:
    v_max3_f32 v136, v136, v140, v144
    v_max_f32 v136, v136, v148
    v_max3_f32 v137, v137, v141, v145
    v_max_f32 v137, v137, v149
    v_max3_f32 v138, v138, v142, v146
    v_max_f32 v138, v138, v150
    v_max3_f32 v139, v139, v143, v147
    v_max_f32 v139, v139, v151
    s_nop 1
    v_max_f32_dpp v136, v136, v136 row_ror:8 row_mask:0xf bank_mask:0xf
    v_max_f32_dpp v137, v137, v137 row_ror:8 row_mask:0xf bank_mask:0xf
    v_max_f32_dpp v138, v138, v138 row_ror:8 row_mask:0xf bank_mask:0xf
    v_max_f32_dpp v139, v139, v139 row_ror:8 row_mask:0xf bank_mask:0xf
    ds_swizzle_b32 v140, v136 offset:0x401F
    ds_swizzle_b32 v141, v137 offset:0x401F
    ds_swizzle_b32 v142, v138 offset:0x401F
    ds_swizzle_b32 v143, v139 offset:0x401F
    s_waitcnt lgkmcnt(0)
    v_max_f32 v136, v136, v140
    v_mov_b32 v140, v136
    v_max_f32 v137, v137, v141
    v_mov_b32 v141, v137
    v_max_f32 v138, v138, v142
    v_mov_b32 v142, v138
    v_max_f32 v139, v139, v143
    v_mov_b32 v143, v139
    s_nop 1
    v_permlane32_swap_b32 v136, v140
    v_permlane32_swap_b32 v137, v141
    v_permlane32_swap_b32 v138, v142
    v_permlane32_swap_b32 v139, v143
    v_max_f32 v136, v136, v140
    v_max_f32 v137, v137, v141
    v_max_f32 v138, v138, v142
    v_max_f32 v139, v139, v143
    v_mul_f32 v140, v136, v136
    v_fmac_f32 v140, v137, v137
    v_fmac_f32 v140, v138, v138
    v_fmac_f32 v140, v139, v139
    v_and_b32 v135, 7, v1
    v_cmp_gt_u32 vcc, 5, v135
    s_nop 1
    v_cndmask_b32 v140, 0, v140, vcc
    s_nop 1
    v_add_f32_dpp v140, v140, v140 row_ror:1 row_mask:0xf bank_mask:0xf
    s_nop 1
    v_add_f32_dpp v140, v140, v140 row_ror:2 row_mask:0xf bank_mask:0xf
    s_nop 1
    v_add_f32_dpp v140, v140, v140 row_ror:4 row_mask:0xf bank_mask:0xf
    v_sqrt_f32 v248, v140
    s_nop 0
    v_mul_f32 v248, 0x3f83d70a, v248
    s_cmp_eq_u32 s38, 0
    s_cbranch_scc1 L_k2_w2a
    s_waitcnt vmcnt(0)
    s_branch L_k2_w2b
L_k2_w2a:
    s_waitcnt vmcnt(8)
L_k2_w2b:
    v_cmp_eq_u32 vcc, 0, v251
    s_nop 1
    v_cndmask_b32 v8, 0, v8, vcc
    v_cndmask_b32 v9, 0, v9, vcc
    v_lshlrev_b32 v132, 16, v4
    v_and_b32 v133, 0xffff0000, v4
    v_mul_f32 v135, v132, v132
    v_fmac_f32 v135, v133, v133
    v_lshlrev_b32 v132, 16, v5
    v_and_b32 v133, 0xffff0000, v5
    v_fmac_f32 v135, v132, v132
    v_fmac_f32 v135, v133, v133
    v_lshlrev_b32 v132, 16, v6
    v_and_b32 v133, 0xffff0000, v6
    v_fmac_f32 v135, v132, v132
    v_fmac_f32 v135, v133, v133
    v_lshlrev_b32 v132, 16, v7
    v_and_b32 v133, 0xffff0000, v7
    v_fmac_f32 v135, v132, v132
    v_fmac_f32 v135, v133, v133
    v_lshlrev_b32 v132, 16, v8
    v_and_b32 v133, 0xffff0000, v8
    v_fmac_f32 v135, v132, v132
    v_fmac_f32 v135, v133, v133
    v_lshlrev_b32 v132, 16, v9
    v_and_b32 v133, 0xffff0000, v9
    v_fmac_f32 v135, v132, v132
    v_fmac_f32 v135, v133, v133
    v_mov_b32 v134, v135
    s_nop 1
    v_permlane32_swap_b32 v135, v134
    v_add_f32 v135, v135, v134
    v_sqrt_f32 v135, v135
    s_nop 0
    v_mul_f32 v135, v135, v248
    v_sub_f32 v132, 0, v135
    v_and_b32 v133, 0xffff0000, v132
    v_sub_f32 v132, v132, v133
    v_and_b32 v134, 0xffff0000, v132
    v_sub_f32 v132, v132, v134
    v_lshrrev_b32 v133, 16, v133
    v_or_b32 v10, v133, v134
    v_lshrrev_b32 v11, 16, v132
    v_cmp_eq_u32 vcc, 0, v251
    s_nop 1
    v_cndmask_b32 v8, 0, v8, vcc
    v_cndmask_b32 v9, 0, v9, vcc
    v_cndmask_b32 v10, 0, v10, vcc
    v_cndmask_b32 v11, 0, v11, vcc
    v_cmp_eq_u32 vcc, 0, v251
    s_nop 1
    v_cndmask_b32 v16, 0, v16, vcc
    v_cndmask_b32 v17, 0, v17, vcc
    v_lshlrev_b32 v132, 16, v12
    v_and_b32 v133, 0xffff0000, v12
    v_mul_f32 v135, v132, v132
    v_fmac_f32 v135, v133, v133
    v_lshlrev_b32 v132, 16, v13
    v_and_b32 v133, 0xffff0000, v13
    v_fmac_f32 v135, v132, v132
    v_fmac_f32 v135, v133, v133
    v_lshlrev_b32 v132, 16, v14
    v_and_b32 v133, 0xffff0000, v14
    v_fmac_f32 v135, v132, v132
    v_fmac_f32 v135, v133, v133
    v_lshlrev_b32 v132, 16, v15
    v_and_b32 v133, 0xffff0000, v15
    v_fmac_f32 v135, v132, v132
    v_fmac_f32 v135, v133, v133
    v_lshlrev_b32 v132, 16, v16
    v_and_b32 v133, 0xffff0000, v16
    v_fmac_f32 v135, v132, v132
    v_fmac_f32 v135, v133, v133
    v_lshlrev_b32 v132, 16, v17
    v_and_b32 v133, 0xffff0000, v17
    v_fmac_f32 v135, v132, v132
    v_fmac_f32 v135, v133, v133
    v_mov_b32 v134, v135
    s_nop 1
    v_permlane32_swap_b32 v135, v134
    v_add_f32 v135, v135, v134
    v_sqrt_f32 v135, v135
    s_nop 0
    v_mul_f32 v135, v135, v248
    v_sub_f32 v132, 0, v135
    v_and_b32 v133, 0xffff0000, v132
    v_sub_f32 v132, v132, v133
    v_and_b32 v134, 0xffff0000, v132
    v_sub_f32 v132, v132, v134
    v_lshrrev_b32 v133, 16, v133
    v_or_b32 v18, v133, v134
    v_lshrrev_b32 v19, 16, v132
    v_cmp_eq_u32 vcc, 0, v251
    s_nop 1
    v_cndmask_b32 v16, 0, v16, vcc
    v_cndmask_b32 v17, 0, v17, vcc
    v_cndmask_b32 v18, 0, v18, vcc
    v_cndmask_b32 v19, 0, v19, vcc
    s_cmp_eq_u32 s38, 0
    s_cbranch_scc1 L_k2_d1skip
    s_add_u32 m0, s40, 0
    s_add_u32 s43, s41, 0
    buffer_load_dwordx4 v252, s[4:7], s43 offen offset:0 lds
    buffer_load_dwordx4 v252, s[4:7], s43 offen offset:1024 lds
    buffer_load_dwordx4 v252, s[4:7], s43 offen offset:2048 lds
    buffer_load_dwordx4 v252, s[4:7], s43 offen offset:3072 lds
    s_add_u32 m0, s40, 4096
    s_add_u32 s43, s41, 4096
    buffer_load_dwordx4 v252, s[4:7], s43 offen offset:0 lds
    buffer_load_dwordx4 v252, s[4:7], s43 offen offset:1024 lds
    buffer_load_dwordx4 v252, s[4:7], s43 offen offset:2048 lds
    buffer_load_dwordx4 v252, s[4:7], s43 offen offset:3072 lds
L_k2_d1skip:
L_k2_main:
    s_cmp_eq_u32 s38, 0
    s_cbranch_scc0 L_k2_w3
    s_waitcnt vmcnt(0)
L_k2_w3:
    s_waitcnt lgkmcnt(0)
    s_barrier
    ds_read_b128 v[20:23], v2 offset:0
    ds_read_b128 v[24:27], v2 offset:1024
    ds_read_b128 v[36:39], v2 offset:16384
    ds_read_b128 v[40:43], v2 offset:17408
    s_waitcnt lgkmcnt(2)
    v_mfma_f32_32x32x16_bf16 v[52:67], v[20:23], v[4:7], 0
    v_mfma_f32_32x32x16_bf16 v[52:67], v[24:27], v[8:11], v[52:67]
    s_nop 7
    s_nop 7
    s_waitcnt lgkmcnt(0)
    v_mfma_f32_32x32x16_bf16 v[68:83], v[20:23], v[12:15], 0
    v_exp_f32 v52, v52
    v_exp_f32 v53, v53
    v_exp_f32 v54, v54
    v_exp_f32 v55, v55
    s_add_u32 m0, s40, 65536
    s_add_u32 s43, s41, 16384
    buffer_load_dwordx4 v252, s[4:7], s43 offen offset:0 lds
    buffer_load_dwordx4 v252, s[4:7], s43 offen offset:1024 lds
    ds_read_b128 v[28:31], v2 offset:2048
    ds_read_b128 v[32:35], v2 offset:3072
    ds_read_b128 v[44:47], v2 offset:18432
    ds_read_b128 v[48:51], v2 offset:19456
    v_exp_f32 v56, v56
    v_exp_f32 v57, v57
    v_exp_f32 v58, v58
    v_exp_f32 v59, v59
    v_cvt_pk_bf16_f32 v84, v52, v53
    v_cvt_pk_bf16_f32 v85, v54, v55
    v_mfma_f32_32x32x16_bf16 v[68:83], v[24:27], v[16:19], v[68:83]
    v_cvt_pk_bf16_f32 v86, v56, v57
    v_cvt_pk_bf16_f32 v87, v58, v59
    v_exp_f32 v60, v60
    v_exp_f32 v61, v61
    v_exp_f32 v62, v62
    v_exp_f32 v63, v63
    v_mfma_f32_32x32x16_bf16 v[100:115], v[36:39], v[84:87], 0
    v_exp_f32 v64, v64
    v_exp_f32 v65, v65
    v_exp_f32 v66, v66
    v_exp_f32 v67, v67
    v_cvt_pk_bf16_f32 v88, v60, v61
    v_cvt_pk_bf16_f32 v89, v62, v63
    v_cvt_pk_bf16_f32 v90, v64, v65
    v_cvt_pk_bf16_f32 v91, v66, v67
    s_waitcnt lgkmcnt(2)
    v_mfma_f32_32x32x16_bf16 v[52:67], v[28:31], v[4:7], 0
    v_exp_f32 v68, v68
    v_exp_f32 v69, v69
    v_exp_f32 v70, v70
    v_exp_f32 v71, v71
    v_mfma_f32_32x32x16_bf16 v[100:115], v[40:43], v[88:91], v[100:115]
    v_exp_f32 v72, v72
    v_exp_f32 v73, v73
    v_exp_f32 v74, v74
    v_exp_f32 v75, v75
    v_cvt_pk_bf16_f32 v92, v68, v69
    v_cvt_pk_bf16_f32 v93, v70, v71
    v_mfma_f32_32x32x16_bf16 v[52:67], v[32:35], v[8:11], v[52:67]
    v_cvt_pk_bf16_f32 v94, v72, v73
    v_cvt_pk_bf16_f32 v95, v74, v75
    v_exp_f32 v76, v76
    v_exp_f32 v77, v77
    v_exp_f32 v78, v78
    v_exp_f32 v79, v79
    v_mfma_f32_32x32x16_bf16 v[116:131], v[36:39], v[92:95], 0
    v_exp_f32 v80, v80
    v_exp_f32 v81, v81
    v_exp_f32 v82, v82
    v_exp_f32 v83, v83
    v_cvt_pk_bf16_f32 v96, v76, v77
    v_cvt_pk_bf16_f32 v97, v78, v79
    v_cvt_pk_bf16_f32 v98, v80, v81
    v_cvt_pk_bf16_f32 v99, v82, v83
    s_waitcnt lgkmcnt(0)
    v_mfma_f32_32x32x16_bf16 v[68:83], v[28:31], v[12:15], 0
    v_exp_f32 v52, v52
    v_exp_f32 v53, v53
    v_exp_f32 v54, v54
    v_exp_f32 v55, v55
    v_mfma_f32_32x32x16_bf16 v[116:131], v[40:43], v[96:99], v[116:131]
    s_add_u32 m0, s40, 65536
    s_add_u32 s43, s41, 16384
    buffer_load_dwordx4 v252, s[4:7], s43 offen offset:2048 lds
    buffer_load_dwordx4 v252, s[4:7], s43 offen offset:3072 lds
    ds_read_b128 v[20:23], v2 offset:4096
    ds_read_b128 v[24:27], v2 offset:5120
    ds_read_b128 v[36:39], v2 offset:20480
    ds_read_b128 v[40:43], v2 offset:21504
    v_exp_f32 v56, v56
    v_exp_f32 v57, v57
    v_exp_f32 v58, v58
    v_exp_f32 v59, v59
    v_cvt_pk_bf16_f32 v84, v52, v53
    v_cvt_pk_bf16_f32 v85, v54, v55
    v_mfma_f32_32x32x16_bf16 v[68:83], v[32:35], v[16:19], v[68:83]
    v_cvt_pk_bf16_f32 v86, v56, v57
    v_cvt_pk_bf16_f32 v87, v58, v59
    v_exp_f32 v60, v60
    v_exp_f32 v61, v61
    v_exp_f32 v62, v62
    v_exp_f32 v63, v63
    v_mfma_f32_32x32x16_bf16 v[100:115], v[44:47], v[84:87], v[100:115]
    v_exp_f32 v64, v64
    v_exp_f32 v65, v65
    v_exp_f32 v66, v66
    v_exp_f32 v67, v67
    v_cvt_pk_bf16_f32 v88, v60, v61
    v_cvt_pk_bf16_f32 v89, v62, v63
    v_cvt_pk_bf16_f32 v90, v64, v65
    v_cvt_pk_bf16_f32 v91, v66, v67
    s_waitcnt lgkmcnt(2)
    v_mfma_f32_32x32x16_bf16 v[52:67], v[20:23], v[4:7], 0
    v_exp_f32 v68, v68
    v_exp_f32 v69, v69
    v_exp_f32 v70, v70
    v_exp_f32 v71, v71
    v_mfma_f32_32x32x16_bf16 v[100:115], v[48:51], v[88:91], v[100:115]
    v_exp_f32 v72, v72
    v_exp_f32 v73, v73
    v_exp_f32 v74, v74
    v_exp_f32 v75, v75
    v_cvt_pk_bf16_f32 v92, v68, v69
    v_cvt_pk_bf16_f32 v93, v70, v71
    v_mfma_f32_32x32x16_bf16 v[52:67], v[24:27], v[8:11], v[52:67]
    v_cvt_pk_bf16_f32 v94, v72, v73
    v_cvt_pk_bf16_f32 v95, v74, v75
    v_exp_f32 v76, v76
    v_exp_f32 v77, v77
    v_exp_f32 v78, v78
    v_exp_f32 v79, v79
    v_mfma_f32_32x32x16_bf16 v[116:131], v[44:47], v[92:95], v[116:131]
    v_exp_f32 v80, v80
    v_exp_f32 v81, v81
    v_exp_f32 v82, v82
    v_exp_f32 v83, v83
    v_cvt_pk_bf16_f32 v96, v76, v77
    v_cvt_pk_bf16_f32 v97, v78, v79
    v_cvt_pk_bf16_f32 v98, v80, v81
    v_cvt_pk_bf16_f32 v99, v82, v83
    s_waitcnt lgkmcnt(0)
    v_mfma_f32_32x32x16_bf16 v[68:83], v[20:23], v[12:15], 0
    v_exp_f32 v52, v52
    v_exp_f32 v53, v53
    v_exp_f32 v54, v54
    v_exp_f32 v55, v55
    v_mfma_f32_32x32x16_bf16 v[116:131], v[48:51], v[96:99], v[116:131]
    s_add_u32 m0, s40, 69632
    s_add_u32 s43, s41, 20480
    buffer_load_dwordx4 v252, s[4:7], s43 offen offset:0 lds
    buffer_load_dwordx4 v252, s[4:7], s43 offen offset:1024 lds
    ds_read_b128 v[28:31], v2 offset:6144
    ds_read_b128 v[32:35], v2 offset:7168
    ds_read_b128 v[44:47], v2 offset:22528
    ds_read_b128 v[48:51], v2 offset:23552
    v_exp_f32 v56, v56
    v_exp_f32 v57, v57
    v_exp_f32 v58, v58
    v_exp_f32 v59, v59
    v_cvt_pk_bf16_f32 v84, v52, v53
    v_cvt_pk_bf16_f32 v85, v54, v55
    v_mfma_f32_32x32x16_bf16 v[68:83], v[24:27], v[16:19], v[68:83]
    v_cvt_pk_bf16_f32 v86, v56, v57
    v_cvt_pk_bf16_f32 v87, v58, v59
    v_exp_f32 v60, v60
    v_exp_f32 v61, v61
    v_exp_f32 v62, v62
    v_exp_f32 v63, v63
    v_mfma_f32_32x32x16_bf16 v[100:115], v[36:39], v[84:87], v[100:115]
    v_exp_f32 v64, v64
    v_exp_f32 v65, v65
    v_exp_f32 v66, v66
    v_exp_f32 v67, v67
    v_cvt_pk_bf16_f32 v88, v60, v61
    v_cvt_pk_bf16_f32 v89, v62, v63
    v_cvt_pk_bf16_f32 v90, v64, v65
    v_cvt_pk_bf16_f32 v91, v66, v67
    s_waitcnt lgkmcnt(2)
    v_mfma_f32_32x32x16_bf16 v[52:67], v[28:31], v[4:7], 0
    v_exp_f32 v68, v68
    v_exp_f32 v69, v69
    v_exp_f32 v70, v70
    v_exp_f32 v71, v71
    v_mfma_f32_32x32x16_bf16 v[100:115], v[40:43], v[88:91], v[100:115]
    v_exp_f32 v72, v72
    v_exp_f32 v73, v73
    v_exp_f32 v74, v74
    v_exp_f32 v75, v75
    v_cvt_pk_bf16_f32 v92, v68, v69
    v_cvt_pk_bf16_f32 v93, v70, v71
    v_mfma_f32_32x32x16_bf16 v[52:67], v[32:35], v[8:11], v[52:67]
    v_cvt_pk_bf16_f32 v94, v72, v73
    v_cvt_pk_bf16_f32 v95, v74, v75
    v_exp_f32 v76, v76
    v_exp_f32 v77, v77
    v_exp_f32 v78, v78
    v_exp_f32 v79, v79
    v_mfma_f32_32x32x16_bf16 v[116:131], v[36:39], v[92:95], v[116:131]
    v_exp_f32 v80, v80
    v_exp_f32 v81, v81
    v_exp_f32 v82, v82
    v_exp_f32 v83, v83
    v_cvt_pk_bf16_f32 v96, v76, v77
    v_cvt_pk_bf16_f32 v97, v78, v79
    v_cvt_pk_bf16_f32 v98, v80, v81
    v_cvt_pk_bf16_f32 v99, v82, v83
    s_waitcnt lgkmcnt(0)
    v_mfma_f32_32x32x16_bf16 v[68:83], v[28:31], v[12:15], 0
    v_exp_f32 v52, v52
    v_exp_f32 v53, v53
    v_exp_f32 v54, v54
    v_exp_f32 v55, v55
    v_mfma_f32_32x32x16_bf16 v[116:131], v[40:43], v[96:99], v[116:131]
    s_add_u32 m0, s40, 69632
    s_add_u32 s43, s41, 20480
    buffer_load_dwordx4 v252, s[4:7], s43 offen offset:2048 lds
    buffer_load_dwordx4 v252, s[4:7], s43 offen offset:3072 lds
    s_waitcnt vmcnt(8)
    s_barrier
    ds_read_b128 v[20:23], v2 offset:8192
    ds_read_b128 v[24:27], v2 offset:9216
    ds_read_b128 v[36:39], v2 offset:24576
    ds_read_b128 v[40:43], v2 offset:25600
    v_exp_f32 v56, v56
    v_exp_f32 v57, v57
    v_exp_f32 v58, v58
    v_exp_f32 v59, v59
    v_cvt_pk_bf16_f32 v84, v52, v53
    v_cvt_pk_bf16_f32 v85, v54, v55
    v_mfma_f32_32x32x16_bf16 v[68:83], v[32:35], v[16:19], v[68:83]
    v_cvt_pk_bf16_f32 v86, v56, v57
    v_cvt_pk_bf16_f32 v87, v58, v59
    v_exp_f32 v60, v60
    v_exp_f32 v61, v61
    v_exp_f32 v62, v62
    v_exp_f32 v63, v63
    v_mfma_f32_32x32x16_bf16 v[100:115], v[44:47], v[84:87], v[100:115]
    v_exp_f32 v64, v64
    v_exp_f32 v65, v65
    v_exp_f32 v66, v66
    v_exp_f32 v67, v67
    v_cvt_pk_bf16_f32 v88, v60, v61
    v_cvt_pk_bf16_f32 v89, v62, v63
    v_cvt_pk_bf16_f32 v90, v64, v65
    v_cvt_pk_bf16_f32 v91, v66, v67
    s_waitcnt lgkmcnt(2)
    v_mfma_f32_32x32x16_bf16 v[52:67], v[20:23], v[4:7], 0
    v_exp_f32 v68, v68
    v_exp_f32 v69, v69
    v_exp_f32 v70, v70
    v_exp_f32 v71, v71
    v_mfma_f32_32x32x16_bf16 v[100:115], v[48:51], v[88:91], v[100:115]
    v_exp_f32 v72, v72
    v_exp_f32 v73, v73
    v_exp_f32 v74, v74
    v_exp_f32 v75, v75
    v_cvt_pk_bf16_f32 v92, v68, v69
    v_cvt_pk_bf16_f32 v93, v70, v71
    v_mfma_f32_32x32x16_bf16 v[52:67], v[24:27], v[8:11], v[52:67]
    v_cvt_pk_bf16_f32 v94, v72, v73
    v_cvt_pk_bf16_f32 v95, v74, v75
    v_exp_f32 v76, v76
    v_exp_f32 v77, v77
    v_exp_f32 v78, v78
    v_exp_f32 v79, v79
    v_mfma_f32_32x32x16_bf16 v[116:131], v[44:47], v[92:95], v[116:131]
    v_exp_f32 v80, v80
    v_exp_f32 v81, v81
    v_exp_f32 v82, v82
    v_exp_f32 v83, v83
    v_cvt_pk_bf16_f32 v96, v76, v77
    v_cvt_pk_bf16_f32 v97, v78, v79
    v_cvt_pk_bf16_f32 v98, v80, v81
    v_cvt_pk_bf16_f32 v99, v82, v83
    s_waitcnt lgkmcnt(0)
    v_mfma_f32_32x32x16_bf16 v[68:83], v[20:23], v[12:15], 0
    v_exp_f32 v52, v52
    v_exp_f32 v53, v53
    v_exp_f32 v54, v54
    v_exp_f32 v55, v55
    v_mfma_f32_32x32x16_bf16 v[116:131], v[48:51], v[96:99], v[116:131]
    s_mov_b32 s44, 0
    buffer_load_dwordx4 v[152:155], v168, s[12:15], s44 offen
    s_mov_b32 s44, 884736
    buffer_load_dwordx4 v[156:159], v168, s[12:15], s44 offen
    ds_read_b128 v[28:31], v2 offset:10240
    ds_read_b128 v[32:35], v2 offset:11264
    ds_read_b128 v[44:47], v2 offset:26624
    ds_read_b128 v[48:51], v2 offset:27648
    v_exp_f32 v56, v56
    v_exp_f32 v57, v57
    v_exp_f32 v58, v58
    v_exp_f32 v59, v59
    v_cvt_pk_bf16_f32 v84, v52, v53
    v_cvt_pk_bf16_f32 v85, v54, v55
    v_mfma_f32_32x32x16_bf16 v[68:83], v[24:27], v[16:19], v[68:83]
    v_cvt_pk_bf16_f32 v86, v56, v57
    v_cvt_pk_bf16_f32 v87, v58, v59
    v_exp_f32 v60, v60
    v_exp_f32 v61, v61
    v_exp_f32 v62, v62
    v_exp_f32 v63, v63
    v_mfma_f32_32x32x16_bf16 v[100:115], v[36:39], v[84:87], v[100:115]
    v_exp_f32 v64, v64
    v_exp_f32 v65, v65
    v_exp_f32 v66, v66
    v_exp_f32 v67, v67
    v_cvt_pk_bf16_f32 v88, v60, v61
    v_cvt_pk_bf16_f32 v89, v62, v63
    v_cvt_pk_bf16_f32 v90, v64, v65
    v_cvt_pk_bf16_f32 v91, v66, v67
    s_waitcnt lgkmcnt(2)
    v_mfma_f32_32x32x16_bf16 v[52:67], v[28:31], v[4:7], 0
    v_exp_f32 v68, v68
    v_exp_f32 v69, v69
    v_exp_f32 v70, v70
    v_exp_f32 v71, v71
    v_mfma_f32_32x32x16_bf16 v[100:115], v[40:43], v[88:91], v[100:115]
    v_exp_f32 v72, v72
    v_exp_f32 v73, v73
    v_exp_f32 v74, v74
    v_exp_f32 v75, v75
    v_cvt_pk_bf16_f32 v92, v68, v69
    v_cvt_pk_bf16_f32 v93, v70, v71
    v_mfma_f32_32x32x16_bf16 v[52:67], v[32:35], v[8:11], v[52:67]
    v_cvt_pk_bf16_f32 v94, v72, v73
    v_cvt_pk_bf16_f32 v95, v74, v75
    v_exp_f32 v76, v76
    v_exp_f32 v77, v77
    v_exp_f32 v78, v78
    v_exp_f32 v79, v79
    v_mfma_f32_32x32x16_bf16 v[116:131], v[36:39], v[92:95], v[116:131]
    v_exp_f32 v80, v80
    v_exp_f32 v81, v81
    v_exp_f32 v82, v82
    v_exp_f32 v83, v83
    v_cvt_pk_bf16_f32 v96, v76, v77
    v_cvt_pk_bf16_f32 v97, v78, v79
    v_cvt_pk_bf16_f32 v98, v80, v81
    v_cvt_pk_bf16_f32 v99, v82, v83
    s_waitcnt lgkmcnt(0)
    v_mfma_f32_32x32x16_bf16 v[68:83], v[28:31], v[12:15], 0
    v_exp_f32 v52, v52
    v_exp_f32 v53, v53
    v_exp_f32 v54, v54
    v_exp_f32 v55, v55
    v_mfma_f32_32x32x16_bf16 v[116:131], v[40:43], v[96:99], v[116:131]
    s_mov_b32 s44, 1769472
    buffer_load_dwordx4 v[160:163], v168, s[12:15], s44 offen
    buffer_load_dwordx4 v[188:191], v176, s[20:23], 0 offen
    ds_read_b128 v[20:23], v2 offset:12288
    ds_read_b128 v[24:27], v2 offset:13312
    ds_read_b128 v[36:39], v2 offset:28672
    ds_read_b128 v[40:43], v2 offset:29696
    v_exp_f32 v56, v56
    v_exp_f32 v57, v57
    v_exp_f32 v58, v58
    v_exp_f32 v59, v59
    v_cvt_pk_bf16_f32 v84, v52, v53
    v_cvt_pk_bf16_f32 v85, v54, v55
    v_mfma_f32_32x32x16_bf16 v[68:83], v[32:35], v[16:19], v[68:83]
    v_cvt_pk_bf16_f32 v86, v56, v57
    v_cvt_pk_bf16_f32 v87, v58, v59
    v_exp_f32 v60, v60
    v_exp_f32 v61, v61
    v_exp_f32 v62, v62
    v_exp_f32 v63, v63
    v_mfma_f32_32x32x16_bf16 v[100:115], v[44:47], v[84:87], v[100:115]
    v_exp_f32 v64, v64
    v_exp_f32 v65, v65
    v_exp_f32 v66, v66
    v_exp_f32 v67, v67
    v_cvt_pk_bf16_f32 v88, v60, v61
    v_cvt_pk_bf16_f32 v89, v62, v63
    v_cvt_pk_bf16_f32 v90, v64, v65
    v_cvt_pk_bf16_f32 v91, v66, v67
    s_waitcnt lgkmcnt(2)
    v_mfma_f32_32x32x16_bf16 v[52:67], v[20:23], v[4:7], 0
    v_exp_f32 v68, v68
    v_exp_f32 v69, v69
    v_exp_f32 v70, v70
    v_exp_f32 v71, v71
    v_mfma_f32_32x32x16_bf16 v[100:115], v[48:51], v[88:91], v[100:115]
    v_exp_f32 v72, v72
    v_exp_f32 v73, v73
    v_exp_f32 v74, v74
    v_exp_f32 v75, v75
    v_cvt_pk_bf16_f32 v92, v68, v69
    v_cvt_pk_bf16_f32 v93, v70, v71
    v_mfma_f32_32x32x16_bf16 v[52:67], v[24:27], v[8:11], v[52:67]
    v_cvt_pk_bf16_f32 v94, v72, v73
    v_cvt_pk_bf16_f32 v95, v74, v75
    v_exp_f32 v76, v76
    v_exp_f32 v77, v77
    v_exp_f32 v78, v78
    v_exp_f32 v79, v79
    v_mfma_f32_32x32x16_bf16 v[116:131], v[44:47], v[92:95], v[116:131]
    v_exp_f32 v80, v80
    v_exp_f32 v81, v81
    v_exp_f32 v82, v82
    v_exp_f32 v83, v83
    v_cvt_pk_bf16_f32 v96, v76, v77
    v_cvt_pk_bf16_f32 v97, v78, v79
    v_cvt_pk_bf16_f32 v98, v80, v81
    v_cvt_pk_bf16_f32 v99, v82, v83
    s_waitcnt lgkmcnt(0)
    v_mfma_f32_32x32x16_bf16 v[68:83], v[20:23], v[12:15], 0
    v_exp_f32 v52, v52
    v_exp_f32 v53, v53
    v_exp_f32 v54, v54
    v_exp_f32 v55, v55
    v_mfma_f32_32x32x16_bf16 v[116:131], v[48:51], v[96:99], v[116:131]
    buffer_load_dwordx4 v[192:195], v177, s[16:19], 0 offen
    buffer_load_dwordx4 v[196:199], v178, s[16:19], 0 offen
    ds_read_b128 v[28:31], v2 offset:14336
    ds_read_b128 v[32:35], v2 offset:15360
    ds_read_b128 v[44:47], v2 offset:30720
    ds_read_b128 v[48:51], v2 offset:31744
    v_exp_f32 v56, v56
    v_exp_f32 v57, v57
    v_exp_f32 v58, v58
    v_exp_f32 v59, v59
    v_cvt_pk_bf16_f32 v84, v52, v53
    v_cvt_pk_bf16_f32 v85, v54, v55
    v_mfma_f32_32x32x16_bf16 v[68:83], v[24:27], v[16:19], v[68:83]
    v_cvt_pk_bf16_f32 v86, v56, v57
    v_cvt_pk_bf16_f32 v87, v58, v59
    v_exp_f32 v60, v60
    v_exp_f32 v61, v61
    v_exp_f32 v62, v62
    v_exp_f32 v63, v63
    v_mfma_f32_32x32x16_bf16 v[100:115], v[36:39], v[84:87], v[100:115]
    v_exp_f32 v64, v64
    v_exp_f32 v65, v65
    v_exp_f32 v66, v66
    v_exp_f32 v67, v67
    v_cvt_pk_bf16_f32 v88, v60, v61
    v_cvt_pk_bf16_f32 v89, v62, v63
    v_cvt_pk_bf16_f32 v90, v64, v65
    v_cvt_pk_bf16_f32 v91, v66, v67
    s_waitcnt lgkmcnt(2)
    v_mfma_f32_32x32x16_bf16 v[52:67], v[28:31], v[4:7], 0
    v_exp_f32 v68, v68
    v_exp_f32 v69, v69
    v_exp_f32 v70, v70
    v_exp_f32 v71, v71
    v_mfma_f32_32x32x16_bf16 v[100:115], v[40:43], v[88:91], v[100:115]
    v_exp_f32 v72, v72
    v_exp_f32 v73, v73
    v_exp_f32 v74, v74
    v_exp_f32 v75, v75
    v_cvt_pk_bf16_f32 v92, v68, v69
    v_cvt_pk_bf16_f32 v93, v70, v71
    v_mfma_f32_32x32x16_bf16 v[52:67], v[32:35], v[8:11], v[52:67]
    v_cvt_pk_bf16_f32 v94, v72, v73
    v_cvt_pk_bf16_f32 v95, v74, v75
    v_exp_f32 v76, v76
    v_exp_f32 v77, v77
    v_exp_f32 v78, v78
    v_exp_f32 v79, v79
    v_mfma_f32_32x32x16_bf16 v[116:131], v[36:39], v[92:95], v[116:131]
    v_exp_f32 v80, v80
    v_exp_f32 v81, v81
    v_exp_f32 v82, v82
    v_exp_f32 v83, v83
    v_cvt_pk_bf16_f32 v96, v76, v77
    v_cvt_pk_bf16_f32 v97, v78, v79
    v_cvt_pk_bf16_f32 v98, v80, v81
    v_cvt_pk_bf16_f32 v99, v82, v83
    s_waitcnt lgkmcnt(0)
    v_mfma_f32_32x32x16_bf16 v[68:83], v[28:31], v[12:15], 0
    v_exp_f32 v52, v52
    v_exp_f32 v53, v53
    v_exp_f32 v54, v54
    v_exp_f32 v55, v55
    v_mfma_f32_32x32x16_bf16 v[116:131], v[40:43], v[96:99], v[116:131]
    s_waitcnt vmcnt(6) lgkmcnt(0)
    s_barrier
    ds_read_b128 v[20:23], v3 offset:0
    ds_read_b128 v[24:27], v3 offset:1024
    ds_read_b128 v[36:39], v3 offset:16384
    ds_read_b128 v[40:43], v3 offset:17408
    v_exp_f32 v56, v56
    v_exp_f32 v57, v57
    v_exp_f32 v58, v58
    v_exp_f32 v59, v59
    v_cvt_pk_bf16_f32 v84, v52, v53
    v_cvt_pk_bf16_f32 v85, v54, v55
    v_mfma_f32_32x32x16_bf16 v[68:83], v[32:35], v[16:19], v[68:83]
    v_cvt_pk_bf16_f32 v86, v56, v57
    v_cvt_pk_bf16_f32 v87, v58, v59
    v_exp_f32 v60, v60
    v_exp_f32 v61, v61
    v_exp_f32 v62, v62
    v_exp_f32 v63, v63
    v_mfma_f32_32x32x16_bf16 v[100:115], v[44:47], v[84:87], v[100:115]
    v_exp_f32 v64, v64
    v_exp_f32 v65, v65
    v_exp_f32 v66, v66
    v_exp_f32 v67, v67
    v_cvt_pk_bf16_f32 v88, v60, v61
    v_cvt_pk_bf16_f32 v89, v62, v63
    v_cvt_pk_bf16_f32 v90, v64, v65
    v_cvt_pk_bf16_f32 v91, v66, v67
    s_waitcnt lgkmcnt(2)
    v_mfma_f32_32x32x16_bf16 v[52:67], v[20:23], v[4:7], 0
    v_exp_f32 v68, v68
    v_exp_f32 v69, v69
    v_exp_f32 v70, v70
    v_exp_f32 v71, v71
    v_mfma_f32_32x32x16_bf16 v[100:115], v[48:51], v[88:91], v[100:115]
    v_exp_f32 v72, v72
    v_exp_f32 v73, v73
    v_exp_f32 v74, v74
    v_exp_f32 v75, v75
    v_cvt_pk_bf16_f32 v92, v68, v69
    v_cvt_pk_bf16_f32 v93, v70, v71
    v_mfma_f32_32x32x16_bf16 v[52:67], v[24:27], v[8:11], v[52:67]
    v_cvt_pk_bf16_f32 v94, v72, v73
    v_cvt_pk_bf16_f32 v95, v74, v75
    v_exp_f32 v76, v76
    v_exp_f32 v77, v77
    v_exp_f32 v78, v78
    v_exp_f32 v79, v79
    v_mfma_f32_32x32x16_bf16 v[116:131], v[44:47], v[92:95], v[116:131]
    v_exp_f32 v80, v80
    v_exp_f32 v81, v81
    v_exp_f32 v82, v82
    v_exp_f32 v83, v83
    v_cvt_pk_bf16_f32 v96, v76, v77
    v_cvt_pk_bf16_f32 v97, v78, v79
    v_cvt_pk_bf16_f32 v98, v80, v81
    v_cvt_pk_bf16_f32 v99, v82, v83
    s_waitcnt lgkmcnt(0)
    v_mfma_f32_32x32x16_bf16 v[68:83], v[20:23], v[12:15], 0
    v_exp_f32 v52, v52
    v_exp_f32 v53, v53
    v_exp_f32 v54, v54
    v_exp_f32 v55, v55
    v_mfma_f32_32x32x16_bf16 v[116:131], v[48:51], v[96:99], v[116:131]
    s_add_u32 m0, s40, 0
    s_add_u32 s43, s41, 32768
    buffer_load_dwordx4 v252, s[4:7], s43 offen offset:0 lds
    buffer_load_dwordx4 v252, s[4:7], s43 offen offset:1024 lds
    ds_read_b128 v[28:31], v3 offset:2048
    ds_read_b128 v[32:35], v3 offset:3072
    ds_read_b128 v[44:47], v3 offset:18432
    ds_read_b128 v[48:51], v3 offset:19456
    v_exp_f32 v56, v56
    v_exp_f32 v57, v57
    v_exp_f32 v58, v58
    v_exp_f32 v59, v59
    v_cvt_pk_bf16_f32 v84, v52, v53
    v_cvt_pk_bf16_f32 v85, v54, v55
    v_mfma_f32_32x32x16_bf16 v[68:83], v[24:27], v[16:19], v[68:83]
    v_cvt_pk_bf16_f32 v86, v56, v57
    v_cvt_pk_bf16_f32 v87, v58, v59
    v_exp_f32 v60, v60
    v_exp_f32 v61, v61
    v_exp_f32 v62, v62
    v_exp_f32 v63, v63
    v_mfma_f32_32x32x16_bf16 v[100:115], v[36:39], v[84:87], v[100:115]
    v_exp_f32 v64, v64
    v_exp_f32 v65, v65
    v_exp_f32 v66, v66
    v_exp_f32 v67, v67
    v_cvt_pk_bf16_f32 v88, v60, v61
    v_cvt_pk_bf16_f32 v89, v62, v63
    v_cvt_pk_bf16_f32 v90, v64, v65
    v_cvt_pk_bf16_f32 v91, v66, v67
    s_waitcnt lgkmcnt(2)
    v_mfma_f32_32x32x16_bf16 v[52:67], v[28:31], v[4:7], 0
    v_exp_f32 v68, v68
    v_exp_f32 v69, v69
    v_exp_f32 v70, v70
    v_exp_f32 v71, v71
    v_mfma_f32_32x32x16_bf16 v[100:115], v[40:43], v[88:91], v[100:115]
    v_exp_f32 v72, v72
    v_exp_f32 v73, v73
    v_exp_f32 v74, v74
    v_exp_f32 v75, v75
    v_cvt_pk_bf16_f32 v92, v68, v69
    v_cvt_pk_bf16_f32 v93, v70, v71
    v_mfma_f32_32x32x16_bf16 v[52:67], v[32:35], v[8:11], v[52:67]
    v_cvt_pk_bf16_f32 v94, v72, v73
    v_cvt_pk_bf16_f32 v95, v74, v75
    v_exp_f32 v76, v76
    v_exp_f32 v77, v77
    v_exp_f32 v78, v78
    v_exp_f32 v79, v79
    v_mfma_f32_32x32x16_bf16 v[116:131], v[36:39], v[92:95], v[116:131]
    v_exp_f32 v80, v80
    v_exp_f32 v81, v81
    v_exp_f32 v82, v82
    v_exp_f32 v83, v83
    v_cvt_pk_bf16_f32 v96, v76, v77
    v_cvt_pk_bf16_f32 v97, v78, v79
    v_cvt_pk_bf16_f32 v98, v80, v81
    v_cvt_pk_bf16_f32 v99, v82, v83
    s_waitcnt lgkmcnt(0)
    v_mfma_f32_32x32x16_bf16 v[68:83], v[28:31], v[12:15], 0
    v_exp_f32 v52, v52
    v_exp_f32 v53, v53
    v_exp_f32 v54, v54
    v_exp_f32 v55, v55
    v_mfma_f32_32x32x16_bf16 v[116:131], v[40:43], v[96:99], v[116:131]
    s_add_u32 m0, s40, 0
    s_add_u32 s43, s41, 32768
    buffer_load_dwordx4 v252, s[4:7], s43 offen offset:2048 lds
    buffer_load_dwordx4 v252, s[4:7], s43 offen offset:3072 lds
    ds_read_b128 v[20:23], v3 offset:4096
    ds_read_b128 v[24:27], v3 offset:5120
    ds_read_b128 v[36:39], v3 offset:20480
    ds_read_b128 v[40:43], v3 offset:21504
    v_exp_f32 v56, v56
    v_exp_f32 v57, v57
    v_exp_f32 v58, v58
    v_exp_f32 v59, v59
    v_cvt_pk_bf16_f32 v84, v52, v53
    v_cvt_pk_bf16_f32 v85, v54, v55
    v_mfma_f32_32x32x16_bf16 v[68:83], v[32:35], v[16:19], v[68:83]
    v_cvt_pk_bf16_f32 v86, v56, v57
    v_cvt_pk_bf16_f32 v87, v58, v59
    v_exp_f32 v60, v60
    v_exp_f32 v61, v61
    v_exp_f32 v62, v62
    v_exp_f32 v63, v63
    v_mfma_f32_32x32x16_bf16 v[100:115], v[44:47], v[84:87], v[100:115]
    v_exp_f32 v64, v64
    v_exp_f32 v65, v65
    v_exp_f32 v66, v66
    v_exp_f32 v67, v67
    v_cvt_pk_bf16_f32 v88, v60, v61
    v_cvt_pk_bf16_f32 v89, v62, v63
    v_cvt_pk_bf16_f32 v90, v64, v65
    v_cvt_pk_bf16_f32 v91, v66, v67
    s_waitcnt lgkmcnt(2)
    v_mfma_f32_32x32x16_bf16 v[52:67], v[20:23], v[4:7], 0
    v_exp_f32 v68, v68
    v_exp_f32 v69, v69
    v_exp_f32 v70, v70
    v_exp_f32 v71, v71
    v_mfma_f32_32x32x16_bf16 v[100:115], v[48:51], v[88:91], v[100:115]
    v_exp_f32 v72, v72
    v_exp_f32 v73, v73
    v_exp_f32 v74, v74
    v_exp_f32 v75, v75
    v_cvt_pk_bf16_f32 v92, v68, v69
    v_cvt_pk_bf16_f32 v93, v70, v71
    v_mfma_f32_32x32x16_bf16 v[52:67], v[24:27], v[8:11], v[52:67]
    v_cvt_pk_bf16_f32 v94, v72, v73
    v_cvt_pk_bf16_f32 v95, v74, v75
    v_exp_f32 v76, v76
    v_exp_f32 v77, v77
    v_exp_f32 v78, v78
    v_exp_f32 v79, v79
    v_mfma_f32_32x32x16_bf16 v[116:131], v[44:47], v[92:95], v[116:131]
    v_exp_f32 v80, v80
    v_exp_f32 v81, v81
    v_exp_f32 v82, v82
    v_exp_f32 v83, v83
    v_cvt_pk_bf16_f32 v96, v76, v77
    v_cvt_pk_bf16_f32 v97, v78, v79
    v_cvt_pk_bf16_f32 v98, v80, v81
    v_cvt_pk_bf16_f32 v99, v82, v83
    s_waitcnt lgkmcnt(0)
    v_mfma_f32_32x32x16_bf16 v[68:83], v[20:23], v[12:15], 0
    v_exp_f32 v52, v52
    v_exp_f32 v53, v53
    v_exp_f32 v54, v54
    v_exp_f32 v55, v55
    v_mfma_f32_32x32x16_bf16 v[116:131], v[48:51], v[96:99], v[116:131]
    s_add_u32 m0, s40, 4096
    s_add_u32 s43, s41, 36864
    buffer_load_dwordx4 v252, s[4:7], s43 offen offset:0 lds
    buffer_load_dwordx4 v252, s[4:7], s43 offen offset:1024 lds
    ds_read_b128 v[28:31], v3 offset:6144
    ds_read_b128 v[32:35], v3 offset:7168
    ds_read_b128 v[44:47], v3 offset:22528
    ds_read_b128 v[48:51], v3 offset:23552
    v_exp_f32 v56, v56
    v_exp_f32 v57, v57
    v_exp_f32 v58, v58
    v_exp_f32 v59, v59
    v_cvt_pk_bf16_f32 v84, v52, v53
    v_cvt_pk_bf16_f32 v85, v54, v55
    v_mfma_f32_32x32x16_bf16 v[68:83], v[24:27], v[16:19], v[68:83]
    v_cvt_pk_bf16_f32 v86, v56, v57
    v_cvt_pk_bf16_f32 v87, v58, v59
    v_exp_f32 v60, v60
    v_exp_f32 v61, v61
    v_exp_f32 v62, v62
    v_exp_f32 v63, v63
    v_mfma_f32_32x32x16_bf16 v[100:115], v[36:39], v[84:87], v[100:115]
    v_exp_f32 v64, v64
    v_exp_f32 v65, v65
    v_exp_f32 v66, v66
    v_exp_f32 v67, v67
    v_cvt_pk_bf16_f32 v88, v60, v61
    v_cvt_pk_bf16_f32 v89, v62, v63
    v_cvt_pk_bf16_f32 v90, v64, v65
    v_cvt_pk_bf16_f32 v91, v66, v67
    s_waitcnt lgkmcnt(2)
    v_mfma_f32_32x32x16_bf16 v[52:67], v[28:31], v[4:7], 0
    v_exp_f32 v68, v68
    v_exp_f32 v69, v69
    v_exp_f32 v70, v70
    v_exp_f32 v71, v71
    v_mfma_f32_32x32x16_bf16 v[100:115], v[40:43], v[88:91], v[100:115]
    v_exp_f32 v72, v72
    v_exp_f32 v73, v73
    v_exp_f32 v74, v74
    v_exp_f32 v75, v75
    v_cvt_pk_bf16_f32 v92, v68, v69
    v_cvt_pk_bf16_f32 v93, v70, v71
    v_mfma_f32_32x32x16_bf16 v[52:67], v[32:35], v[8:11], v[52:67]
    v_cvt_pk_bf16_f32 v94, v72, v73
    v_cvt_pk_bf16_f32 v95, v74, v75
    v_exp_f32 v76, v76
    v_exp_f32 v77, v77
    v_exp_f32 v78, v78
    v_exp_f32 v79, v79
    v_mfma_f32_32x32x16_bf16 v[116:131], v[36:39], v[92:95], v[116:131]
    v_exp_f32 v80, v80
    v_exp_f32 v81, v81
    v_exp_f32 v82, v82
    v_exp_f32 v83, v83
    v_cvt_pk_bf16_f32 v96, v76, v77
    v_cvt_pk_bf16_f32 v97, v78, v79
    v_cvt_pk_bf16_f32 v98, v80, v81
    v_cvt_pk_bf16_f32 v99, v82, v83
    s_waitcnt lgkmcnt(0)
    v_mfma_f32_32x32x16_bf16 v[68:83], v[28:31], v[12:15], 0
    v_exp_f32 v52, v52
    v_exp_f32 v53, v53
    v_exp_f32 v54, v54
    v_exp_f32 v55, v55
    v_mfma_f32_32x32x16_bf16 v[116:131], v[40:43], v[96:99], v[116:131]
    s_add_u32 m0, s40, 4096
    s_add_u32 s43, s41, 36864
    buffer_load_dwordx4 v252, s[4:7], s43 offen offset:2048 lds
    buffer_load_dwordx4 v252, s[4:7], s43 offen offset:3072 lds
    ds_read_b128 v[20:23], v3 offset:8192
    ds_read_b128 v[24:27], v3 offset:9216
    ds_read_b128 v[36:39], v3 offset:24576
    ds_read_b128 v[40:43], v3 offset:25600
    v_exp_f32 v56, v56
    v_exp_f32 v57, v57
    v_exp_f32 v58, v58
    v_exp_f32 v59, v59
    v_cvt_pk_bf16_f32 v84, v52, v53
    v_cvt_pk_bf16_f32 v85, v54, v55
    v_mfma_f32_32x32x16_bf16 v[68:83], v[32:35], v[16:19], v[68:83]
    v_cvt_pk_bf16_f32 v86, v56, v57
    v_cvt_pk_bf16_f32 v87, v58, v59
    v_exp_f32 v60, v60
    v_exp_f32 v61, v61
    v_exp_f32 v62, v62
    v_exp_f32 v63, v63
    v_mfma_f32_32x32x16_bf16 v[100:115], v[44:47], v[84:87], v[100:115]
    v_exp_f32 v64, v64
    v_exp_f32 v65, v65
    v_exp_f32 v66, v66
    v_exp_f32 v67, v67
    v_cvt_pk_bf16_f32 v88, v60, v61
    v_cvt_pk_bf16_f32 v89, v62, v63
    v_cvt_pk_bf16_f32 v90, v64, v65
    v_cvt_pk_bf16_f32 v91, v66, v67
    s_waitcnt lgkmcnt(2)
    v_mfma_f32_32x32x16_bf16 v[52:67], v[20:23], v[4:7], 0
    v_exp_f32 v68, v68
    v_exp_f32 v69, v69
    v_exp_f32 v70, v70
    v_exp_f32 v71, v71
    v_mfma_f32_32x32x16_bf16 v[100:115], v[48:51], v[88:91], v[100:115]
    v_exp_f32 v72, v72
    v_exp_f32 v73, v73
    v_exp_f32 v74, v74
    v_exp_f32 v75, v75
    v_cvt_pk_bf16_f32 v92, v68, v69
    v_cvt_pk_bf16_f32 v93, v70, v71
    v_mfma_f32_32x32x16_bf16 v[52:67], v[24:27], v[8:11], v[52:67]
    v_cvt_pk_bf16_f32 v94, v72, v73
    v_cvt_pk_bf16_f32 v95, v74, v75
    v_exp_f32 v76, v76
    v_exp_f32 v77, v77
    v_exp_f32 v78, v78
    v_exp_f32 v79, v79
    v_mfma_f32_32x32x16_bf16 v[116:131], v[44:47], v[92:95], v[116:131]
    v_exp_f32 v80, v80
    v_exp_f32 v81, v81
    v_exp_f32 v82, v82
    v_exp_f32 v83, v83
    v_cvt_pk_bf16_f32 v96, v76, v77
    v_cvt_pk_bf16_f32 v97, v78, v79
    v_cvt_pk_bf16_f32 v98, v80, v81
    v_cvt_pk_bf16_f32 v99, v82, v83
    s_waitcnt lgkmcnt(0)
    v_mfma_f32_32x32x16_bf16 v[68:83], v[20:23], v[12:15], 0
    v_exp_f32 v52, v52
    v_exp_f32 v53, v53
    v_exp_f32 v54, v54
    v_exp_f32 v55, v55
    v_mfma_f32_32x32x16_bf16 v[116:131], v[48:51], v[96:99], v[116:131]
    buffer_load_dwordx4 v[200:203], v179, s[28:31], 0 offen
    buffer_load_dwordx4 v[204:207], v180, s[28:31], 0 offen
    ds_read_b128 v[28:31], v3 offset:10240
    ds_read_b128 v[32:35], v3 offset:11264
    ds_read_b128 v[44:47], v3 offset:26624
    ds_read_b128 v[48:51], v3 offset:27648
    v_exp_f32 v56, v56
    v_exp_f32 v57, v57
    v_exp_f32 v58, v58
    v_exp_f32 v59, v59
    v_cvt_pk_bf16_f32 v84, v52, v53
    v_cvt_pk_bf16_f32 v85, v54, v55
    v_mfma_f32_32x32x16_bf16 v[68:83], v[24:27], v[16:19], v[68:83]
    v_cvt_pk_bf16_f32 v86, v56, v57
    v_cvt_pk_bf16_f32 v87, v58, v59
    v_exp_f32 v60, v60
    v_exp_f32 v61, v61
    v_exp_f32 v62, v62
    v_exp_f32 v63, v63
    v_mfma_f32_32x32x16_bf16 v[100:115], v[36:39], v[84:87], v[100:115]
    v_exp_f32 v64, v64
    v_exp_f32 v65, v65
    v_exp_f32 v66, v66
    v_exp_f32 v67, v67
    v_cvt_pk_bf16_f32 v88, v60, v61
    v_cvt_pk_bf16_f32 v89, v62, v63
    v_cvt_pk_bf16_f32 v90, v64, v65
    v_cvt_pk_bf16_f32 v91, v66, v67
    s_waitcnt lgkmcnt(2)
    v_mfma_f32_32x32x16_bf16 v[52:67], v[28:31], v[4:7], 0
    v_exp_f32 v68, v68
    v_exp_f32 v69, v69
    v_exp_f32 v70, v70
    v_exp_f32 v71, v71
    v_mfma_f32_32x32x16_bf16 v[100:115], v[40:43], v[88:91], v[100:115]
    v_exp_f32 v72, v72
    v_exp_f32 v73, v73
    v_exp_f32 v74, v74
    v_exp_f32 v75, v75
    v_cvt_pk_bf16_f32 v92, v68, v69
    v_cvt_pk_bf16_f32 v93, v70, v71
    v_mfma_f32_32x32x16_bf16 v[52:67], v[32:35], v[8:11], v[52:67]
    v_cvt_pk_bf16_f32 v94, v72, v73
    v_cvt_pk_bf16_f32 v95, v74, v75
    v_exp_f32 v76, v76
    v_exp_f32 v77, v77
    v_exp_f32 v78, v78
    v_exp_f32 v79, v79
    v_mfma_f32_32x32x16_bf16 v[116:131], v[36:39], v[92:95], v[116:131]
    v_exp_f32 v80, v80
    v_exp_f32 v81, v81
    v_exp_f32 v82, v82
    v_exp_f32 v83, v83
    v_cvt_pk_bf16_f32 v96, v76, v77
    v_cvt_pk_bf16_f32 v97, v78, v79
    v_cvt_pk_bf16_f32 v98, v80, v81
    v_cvt_pk_bf16_f32 v99, v82, v83
    s_waitcnt lgkmcnt(0)
    v_mfma_f32_32x32x16_bf16 v[68:83], v[28:31], v[12:15], 0
    v_exp_f32 v52, v52
    v_exp_f32 v53, v53
    v_exp_f32 v54, v54
    v_exp_f32 v55, v55
    v_mfma_f32_32x32x16_bf16 v[116:131], v[40:43], v[96:99], v[116:131]
    buffer_load_dwordx4 v[208:211], v179, s[48:51], 0 offen
    buffer_load_dwordx4 v[212:215], v180, s[48:51], 0 offen
    ds_read_b128 v[20:23], v3 offset:12288
    ds_read_b128 v[24:27], v3 offset:13312
    ds_read_b128 v[36:39], v3 offset:28672
    ds_read_b128 v[40:43], v3 offset:29696
    v_exp_f32 v56, v56
    v_exp_f32 v57, v57
    v_exp_f32 v58, v58
    v_exp_f32 v59, v59
    v_cvt_pk_bf16_f32 v84, v52, v53
    v_cvt_pk_bf16_f32 v85, v54, v55
    v_mfma_f32_32x32x16_bf16 v[68:83], v[32:35], v[16:19], v[68:83]
    v_cvt_pk_bf16_f32 v86, v56, v57
    v_cvt_pk_bf16_f32 v87, v58, v59
    v_exp_f32 v60, v60
    v_exp_f32 v61, v61
    v_exp_f32 v62, v62
    v_exp_f32 v63, v63
    v_mfma_f32_32x32x16_bf16 v[100:115], v[44:47], v[84:87], v[100:115]
    v_exp_f32 v64, v64
    v_exp_f32 v65, v65
    v_exp_f32 v66, v66
    v_exp_f32 v67, v67
    v_cvt_pk_bf16_f32 v88, v60, v61
    v_cvt_pk_bf16_f32 v89, v62, v63
    v_cvt_pk_bf16_f32 v90, v64, v65
    v_cvt_pk_bf16_f32 v91, v66, v67
    s_waitcnt lgkmcnt(2)
    v_mfma_f32_32x32x16_bf16 v[52:67], v[20:23], v[4:7], 0
    v_exp_f32 v68, v68
    v_exp_f32 v69, v69
    v_exp_f32 v70, v70
    v_exp_f32 v71, v71
    v_mfma_f32_32x32x16_bf16 v[100:115], v[48:51], v[88:91], v[100:115]
    v_exp_f32 v72, v72
    v_exp_f32 v73, v73
    v_exp_f32 v74, v74
    v_exp_f32 v75, v75
    v_cvt_pk_bf16_f32 v92, v68, v69
    v_cvt_pk_bf16_f32 v93, v70, v71
    v_mfma_f32_32x32x16_bf16 v[52:67], v[24:27], v[8:11], v[52:67]
    v_cvt_pk_bf16_f32 v94, v72, v73
    v_cvt_pk_bf16_f32 v95, v74, v75
    v_exp_f32 v76, v76
    v_exp_f32 v77, v77
    v_exp_f32 v78, v78
    v_exp_f32 v79, v79
    v_mfma_f32_32x32x16_bf16 v[116:131], v[44:47], v[92:95], v[116:131]
    v_exp_f32 v80, v80
    v_exp_f32 v81, v81
    v_exp_f32 v82, v82
    v_exp_f32 v83, v83
    v_cvt_pk_bf16_f32 v96, v76, v77
    v_cvt_pk_bf16_f32 v97, v78, v79
    v_cvt_pk_bf16_f32 v98, v80, v81
    v_cvt_pk_bf16_f32 v99, v82, v83
    s_waitcnt lgkmcnt(0)
    v_mfma_f32_32x32x16_bf16 v[68:83], v[20:23], v[12:15], 0
    v_exp_f32 v52, v52
    v_exp_f32 v53, v53
    v_exp_f32 v54, v54
    v_exp_f32 v55, v55
    v_mfma_f32_32x32x16_bf16 v[116:131], v[48:51], v[96:99], v[116:131]
    ds_read_b128 v[28:31], v3 offset:14336
    ds_read_b128 v[32:35], v3 offset:15360
    ds_read_b128 v[44:47], v3 offset:30720
    ds_read_b128 v[48:51], v3 offset:31744
    v_exp_f32 v56, v56
    v_exp_f32 v57, v57
    v_exp_f32 v58, v58
    v_exp_f32 v59, v59
    v_cvt_pk_bf16_f32 v84, v52, v53
    v_cvt_pk_bf16_f32 v85, v54, v55
    v_mfma_f32_32x32x16_bf16 v[68:83], v[24:27], v[16:19], v[68:83]
    v_cvt_pk_bf16_f32 v86, v56, v57
    v_cvt_pk_bf16_f32 v87, v58, v59
    v_exp_f32 v60, v60
    v_exp_f32 v61, v61
    v_exp_f32 v62, v62
    v_exp_f32 v63, v63
    v_mfma_f32_32x32x16_bf16 v[100:115], v[36:39], v[84:87], v[100:115]
    v_exp_f32 v64, v64
    v_exp_f32 v65, v65
    v_exp_f32 v66, v66
    v_exp_f32 v67, v67
    v_cvt_pk_bf16_f32 v88, v60, v61
    v_cvt_pk_bf16_f32 v89, v62, v63
    v_cvt_pk_bf16_f32 v90, v64, v65
    v_cvt_pk_bf16_f32 v91, v66, v67
    s_waitcnt lgkmcnt(2)
    v_mfma_f32_32x32x16_bf16 v[52:67], v[28:31], v[4:7], 0
    v_exp_f32 v68, v68
    v_exp_f32 v69, v69
    v_exp_f32 v70, v70
    v_exp_f32 v71, v71
    v_mfma_f32_32x32x16_bf16 v[100:115], v[40:43], v[88:91], v[100:115]
    v_exp_f32 v72, v72
    v_exp_f32 v73, v73
    v_exp_f32 v74, v74
    v_exp_f32 v75, v75
    v_cvt_pk_bf16_f32 v92, v68, v69
    v_cvt_pk_bf16_f32 v93, v70, v71
    v_mfma_f32_32x32x16_bf16 v[52:67], v[32:35], v[8:11], v[52:67]
    v_cvt_pk_bf16_f32 v94, v72, v73
    v_cvt_pk_bf16_f32 v95, v74, v75
    v_exp_f32 v76, v76
    v_exp_f32 v77, v77
    v_exp_f32 v78, v78
    v_exp_f32 v79, v79
    v_mfma_f32_32x32x16_bf16 v[116:131], v[36:39], v[92:95], v[116:131]
    v_exp_f32 v80, v80
    v_exp_f32 v81, v81
    v_exp_f32 v82, v82
    v_exp_f32 v83, v83
    v_cvt_pk_bf16_f32 v96, v76, v77
    v_cvt_pk_bf16_f32 v97, v78, v79
    v_cvt_pk_bf16_f32 v98, v80, v81
    v_cvt_pk_bf16_f32 v99, v82, v83
    s_waitcnt lgkmcnt(0)
    v_mfma_f32_32x32x16_bf16 v[68:83], v[28:31], v[12:15], 0
    v_exp_f32 v52, v52
    v_exp_f32 v53, v53
    v_exp_f32 v54, v54
    v_exp_f32 v55, v55
    v_mfma_f32_32x32x16_bf16 v[116:131], v[40:43], v[96:99], v[116:131]
    s_waitcnt vmcnt(4) lgkmcnt(0)
    s_barrier
    ds_read_b128 v[20:23], v2 offset:0
    ds_read_b128 v[24:27], v2 offset:1024
    ds_read_b128 v[36:39], v2 offset:16384
    ds_read_b128 v[40:43], v2 offset:17408
    v_exp_f32 v56, v56
    v_exp_f32 v57, v57
    v_exp_f32 v58, v58
    v_exp_f32 v59, v59
    v_cvt_pk_bf16_f32 v84, v52, v53
    v_cvt_pk_bf16_f32 v85, v54, v55
    v_mfma_f32_32x32x16_bf16 v[68:83], v[32:35], v[16:19], v[68:83]
    v_cvt_pk_bf16_f32 v86, v56, v57
    v_cvt_pk_bf16_f32 v87, v58, v59
    v_exp_f32 v60, v60
    v_exp_f32 v61, v61
    v_exp_f32 v62, v62
    v_exp_f32 v63, v63
    v_mfma_f32_32x32x16_bf16 v[100:115], v[44:47], v[84:87], v[100:115]
    v_exp_f32 v64, v64
    v_exp_f32 v65, v65
    v_exp_f32 v66, v66
    v_exp_f32 v67, v67
    v_cvt_pk_bf16_f32 v88, v60, v61
    v_cvt_pk_bf16_f32 v89, v62, v63
    v_cvt_pk_bf16_f32 v90, v64, v65
    v_cvt_pk_bf16_f32 v91, v66, v67
    s_waitcnt lgkmcnt(2)
    v_mfma_f32_32x32x16_bf16 v[52:67], v[20:23], v[4:7], 0
    v_exp_f32 v68, v68
    v_exp_f32 v69, v69
    v_exp_f32 v70, v70
    v_exp_f32 v71, v71
    v_mfma_f32_32x32x16_bf16 v[100:115], v[48:51], v[88:91], v[100:115]
    v_exp_f32 v72, v72
    v_exp_f32 v73, v73
    v_exp_f32 v74, v74
    v_exp_f32 v75, v75
    v_cvt_pk_bf16_f32 v92, v68, v69
    v_cvt_pk_bf16_f32 v93, v70, v71
    v_mfma_f32_32x32x16_bf16 v[52:67], v[24:27], v[8:11], v[52:67]
    v_cvt_pk_bf16_f32 v94, v72, v73
    v_cvt_pk_bf16_f32 v95, v74, v75
    v_exp_f32 v76, v76
    v_exp_f32 v77, v77
    v_exp_f32 v78, v78
    v_exp_f32 v79, v79
    v_mfma_f32_32x32x16_bf16 v[116:131], v[44:47], v[92:95], v[116:131]
    v_exp_f32 v80, v80
    v_exp_f32 v81, v81
    v_exp_f32 v82, v82
    v_exp_f32 v83, v83
    v_cvt_pk_bf16_f32 v96, v76, v77
    v_cvt_pk_bf16_f32 v97, v78, v79
    v_cvt_pk_bf16_f32 v98, v80, v81
    v_cvt_pk_bf16_f32 v99, v82, v83
    s_waitcnt lgkmcnt(0)
    v_mfma_f32_32x32x16_bf16 v[68:83], v[20:23], v[12:15], 0
    v_exp_f32 v52, v52
    v_exp_f32 v53, v53
    v_exp_f32 v54, v54
    v_exp_f32 v55, v55
    v_mfma_f32_32x32x16_bf16 v[116:131], v[48:51], v[96:99], v[116:131]
    s_add_u32 m0, s40, 65536
    s_add_u32 s43, s41, 49152
    buffer_load_dwordx4 v252, s[4:7], s43 offen offset:0 lds
    buffer_load_dwordx4 v252, s[4:7], s43 offen offset:1024 lds
    v_mfma_f32_16x16x32_bf16 v[136:139], v[152:155], v[164:167], 0
    v_mfma_f32_16x16x32_bf16 v[136:139], v[156:159], v[164:167], v[136:139]
    v_mfma_f32_16x16x32_bf16 v[136:139], v[160:163], v[164:167], v[136:139]
    ds_read_b128 v[28:31], v2 offset:2048
    ds_read_b128 v[32:35], v2 offset:3072
    ds_read_b128 v[44:47], v2 offset:18432
    ds_read_b128 v[48:51], v2 offset:19456
    v_exp_f32 v56, v56
    v_exp_f32 v57, v57
    v_exp_f32 v58, v58
    v_exp_f32 v59, v59
    v_cvt_pk_bf16_f32 v84, v52, v53
    v_cvt_pk_bf16_f32 v85, v54, v55
    v_mfma_f32_32x32x16_bf16 v[68:83], v[24:27], v[16:19], v[68:83]
    v_cvt_pk_bf16_f32 v86, v56, v57
    v_cvt_pk_bf16_f32 v87, v58, v59
    v_exp_f32 v60, v60
    v_exp_f32 v61, v61
    v_exp_f32 v62, v62
    v_exp_f32 v63, v63
    v_mfma_f32_32x32x16_bf16 v[100:115], v[36:39], v[84:87], v[100:115]
    v_exp_f32 v64, v64
    v_exp_f32 v65, v65
    v_exp_f32 v66, v66
    v_exp_f32 v67, v67
    v_cvt_pk_bf16_f32 v88, v60, v61
    v_cvt_pk_bf16_f32 v89, v62, v63
    v_cvt_pk_bf16_f32 v90, v64, v65
    v_cvt_pk_bf16_f32 v91, v66, v67
    s_waitcnt lgkmcnt(2)
    v_mfma_f32_32x32x16_bf16 v[52:67], v[28:31], v[4:7], 0
    v_exp_f32 v68, v68
    v_exp_f32 v69, v69
    v_exp_f32 v70, v70
    v_exp_f32 v71, v71
    v_mfma_f32_32x32x16_bf16 v[100:115], v[40:43], v[88:91], v[100:115]
    v_exp_f32 v72, v72
    v_exp_f32 v73, v73
    v_exp_f32 v74, v74
    v_exp_f32 v75, v75
    v_cvt_pk_bf16_f32 v92, v68, v69
    v_cvt_pk_bf16_f32 v93, v70, v71
    v_mfma_f32_32x32x16_bf16 v[52:67], v[32:35], v[8:11], v[52:67]
    v_cvt_pk_bf16_f32 v94, v72, v73
    v_cvt_pk_bf16_f32 v95, v74, v75
    v_exp_f32 v76, v76
    v_exp_f32 v77, v77
    v_exp_f32 v78, v78
    v_exp_f32 v79, v79
    v_mfma_f32_32x32x16_bf16 v[116:131], v[36:39], v[92:95], v[116:131]
    v_exp_f32 v80, v80
    v_exp_f32 v81, v81
    v_exp_f32 v82, v82
    v_exp_f32 v83, v83
    v_cvt_pk_bf16_f32 v96, v76, v77
    v_cvt_pk_bf16_f32 v97, v78, v79
    v_cvt_pk_bf16_f32 v98, v80, v81
    v_cvt_pk_bf16_f32 v99, v82, v83
    s_waitcnt lgkmcnt(0)
    v_mfma_f32_32x32x16_bf16 v[68:83], v[28:31], v[12:15], 0
    v_exp_f32 v52, v52
    v_exp_f32 v53, v53
    v_exp_f32 v54, v54
    v_exp_f32 v55, v55
    v_mfma_f32_32x32x16_bf16 v[116:131], v[40:43], v[96:99], v[116:131]
    s_add_u32 m0, s40, 65536
    s_add_u32 s43, s41, 49152
    buffer_load_dwordx4 v252, s[4:7], s43 offen offset:2048 lds
    buffer_load_dwordx4 v252, s[4:7], s43 offen offset:3072 lds
    v_add_f32 v136, v136, v138
    v_add_f32 v137, v137, v139
    v_and_b32 v132, 15, v1
    v_lshlrev_b32 v133, 2, v132
    v_add_u32 v133, 131136, v133
    s_cmp_eq_u32 s60, 0
    s_cbranch_scc0 L_k2_nocsadd
    v_cmp_gt_u32 vcc, 8, v132
    s_and_saveexec_b64 s[46:47], vcc
    ds_add_f32 v133, v136
    ds_add_f32 v133, v137 offset:32
    s_mov_b64 exec, s[46:47]
L_k2_nocsadd:
    ds_read_b128 v[20:23], v2 offset:4096
    ds_read_b128 v[24:27], v2 offset:5120
    ds_read_b128 v[36:39], v2 offset:20480
    ds_read_b128 v[40:43], v2 offset:21504
    v_exp_f32 v56, v56
    v_exp_f32 v57, v57
    v_exp_f32 v58, v58
    v_exp_f32 v59, v59
    v_cvt_pk_bf16_f32 v84, v52, v53
    v_cvt_pk_bf16_f32 v85, v54, v55
    v_mfma_f32_32x32x16_bf16 v[68:83], v[32:35], v[16:19], v[68:83]
    v_cvt_pk_bf16_f32 v86, v56, v57
    v_cvt_pk_bf16_f32 v87, v58, v59
    v_exp_f32 v60, v60
    v_exp_f32 v61, v61
    v_exp_f32 v62, v62
    v_exp_f32 v63, v63
    v_mfma_f32_32x32x16_bf16 v[100:115], v[44:47], v[84:87], v[100:115]
    v_exp_f32 v64, v64
    v_exp_f32 v65, v65
    v_exp_f32 v66, v66
    v_exp_f32 v67, v67
    v_cvt_pk_bf16_f32 v88, v60, v61
    v_cvt_pk_bf16_f32 v89, v62, v63
    v_cvt_pk_bf16_f32 v90, v64, v65
    v_cvt_pk_bf16_f32 v91, v66, v67
    s_waitcnt lgkmcnt(2)
    v_mfma_f32_32x32x16_bf16 v[52:67], v[20:23], v[4:7], 0
    v_exp_f32 v68, v68
    v_exp_f32 v69, v69
    v_exp_f32 v70, v70
    v_exp_f32 v71, v71
    v_mfma_f32_32x32x16_bf16 v[100:115], v[48:51], v[88:91], v[100:115]
    v_exp_f32 v72, v72
    v_exp_f32 v73, v73
    v_exp_f32 v74, v74
    v_exp_f32 v75, v75
    v_cvt_pk_bf16_f32 v92, v68, v69
    v_cvt_pk_bf16_f32 v93, v70, v71
    v_mfma_f32_32x32x16_bf16 v[52:67], v[24:27], v[8:11], v[52:67]
    v_cvt_pk_bf16_f32 v94, v72, v73
    v_cvt_pk_bf16_f32 v95, v74, v75
    v_exp_f32 v76, v76
    v_exp_f32 v77, v77
    v_exp_f32 v78, v78
    v_exp_f32 v79, v79
    v_mfma_f32_32x32x16_bf16 v[116:131], v[44:47], v[92:95], v[116:131]
    v_exp_f32 v80, v80
    v_exp_f32 v81, v81
    v_exp_f32 v82, v82
    v_exp_f32 v83, v83
    v_cvt_pk_bf16_f32 v96, v76, v77
    v_cvt_pk_bf16_f32 v97, v78, v79
    v_cvt_pk_bf16_f32 v98, v80, v81
    v_cvt_pk_bf16_f32 v99, v82, v83
    s_waitcnt lgkmcnt(0)
    v_mfma_f32_32x32x16_bf16 v[68:83], v[20:23], v[12:15], 0
    v_exp_f32 v52, v52
    v_exp_f32 v53, v53
    v_exp_f32 v54, v54
    v_exp_f32 v55, v55
    v_mfma_f32_32x32x16_bf16 v[116:131], v[48:51], v[96:99], v[116:131]
    s_add_u32 m0, s40, 69632
    s_add_u32 s43, s41, 53248
    buffer_load_dwordx4 v252, s[4:7], s43 offen offset:0 lds
    buffer_load_dwordx4 v252, s[4:7], s43 offen offset:1024 lds
    ds_read_b128 v[28:31], v2 offset:6144
    ds_read_b128 v[32:35], v2 offset:7168
    ds_read_b128 v[44:47], v2 offset:22528
    ds_read_b128 v[48:51], v2 offset:23552
    v_exp_f32 v56, v56
    v_exp_f32 v57, v57
    v_exp_f32 v58, v58
    v_exp_f32 v59, v59
    v_cvt_pk_bf16_f32 v84, v52, v53
    v_cvt_pk_bf16_f32 v85, v54, v55
    v_mfma_f32_32x32x16_bf16 v[68:83], v[24:27], v[16:19], v[68:83]
    v_cvt_pk_bf16_f32 v86, v56, v57
    v_cvt_pk_bf16_f32 v87, v58, v59
    v_exp_f32 v60, v60
    v_exp_f32 v61, v61
    v_exp_f32 v62, v62
    v_exp_f32 v63, v63
    v_mfma_f32_32x32x16_bf16 v[100:115], v[36:39], v[84:87], v[100:115]
    v_exp_f32 v64, v64
    v_exp_f32 v65, v65
    v_exp_f32 v66, v66
    v_exp_f32 v67, v67
    v_cvt_pk_bf16_f32 v88, v60, v61
    v_cvt_pk_bf16_f32 v89, v62, v63
    v_cvt_pk_bf16_f32 v90, v64, v65
    v_cvt_pk_bf16_f32 v91, v66, v67
    s_waitcnt lgkmcnt(2)
    v_mfma_f32_32x32x16_bf16 v[52:67], v[28:31], v[4:7], 0
    v_exp_f32 v68, v68
    v_exp_f32 v69, v69
    v_exp_f32 v70, v70
    v_exp_f32 v71, v71
    v_mfma_f32_32x32x16_bf16 v[100:115], v[40:43], v[88:91], v[100:115]
    v_exp_f32 v72, v72
    v_exp_f32 v73, v73
    v_exp_f32 v74, v74
    v_exp_f32 v75, v75
    v_cvt_pk_bf16_f32 v92, v68, v69
    v_cvt_pk_bf16_f32 v93, v70, v71
    v_mfma_f32_32x32x16_bf16 v[52:67], v[32:35], v[8:11], v[52:67]
    v_cvt_pk_bf16_f32 v94, v72, v73
    v_cvt_pk_bf16_f32 v95, v74, v75
    v_exp_f32 v76, v76
    v_exp_f32 v77, v77
    v_exp_f32 v78, v78
    v_exp_f32 v79, v79
    v_mfma_f32_32x32x16_bf16 v[116:131], v[36:39], v[92:95], v[116:131]
    v_exp_f32 v80, v80
    v_exp_f32 v81, v81
    v_exp_f32 v82, v82
    v_exp_f32 v83, v83
    v_cvt_pk_bf16_f32 v96, v76, v77
    v_cvt_pk_bf16_f32 v97, v78, v79
    v_cvt_pk_bf16_f32 v98, v80, v81
    v_cvt_pk_bf16_f32 v99, v82, v83
    s_waitcnt lgkmcnt(0)
    v_mfma_f32_32x32x16_bf16 v[68:83], v[28:31], v[12:15], 0
    v_exp_f32 v52, v52
    v_exp_f32 v53, v53
    v_exp_f32 v54, v54
    v_exp_f32 v55, v55
    v_mfma_f32_32x32x16_bf16 v[116:131], v[40:43], v[96:99], v[116:131]
    s_add_u32 m0, s40, 69632
    s_add_u32 s43, s41, 53248
    buffer_load_dwordx4 v252, s[4:7], s43 offen offset:2048 lds
    buffer_load_dwordx4 v252, s[4:7], s43 offen offset:3072 lds
    ds_read_b128 v[20:23], v2 offset:8192
    ds_read_b128 v[24:27], v2 offset:9216
    ds_read_b128 v[36:39], v2 offset:24576
    ds_read_b128 v[40:43], v2 offset:25600
    v_exp_f32 v56, v56
    v_exp_f32 v57, v57
    v_exp_f32 v58, v58
    v_exp_f32 v59, v59
    v_cvt_pk_bf16_f32 v84, v52, v53
    v_cvt_pk_bf16_f32 v85, v54, v55
    v_mfma_f32_32x32x16_bf16 v[68:83], v[32:35], v[16:19], v[68:83]
    v_cvt_pk_bf16_f32 v86, v56, v57
    v_cvt_pk_bf16_f32 v87, v58, v59
    v_exp_f32 v60, v60
    v_exp_f32 v61, v61
    v_exp_f32 v62, v62
    v_exp_f32 v63, v63
    v_mfma_f32_32x32x16_bf16 v[100:115], v[44:47], v[84:87], v[100:115]
    v_exp_f32 v64, v64
    v_exp_f32 v65, v65
    v_exp_f32 v66, v66
    v_exp_f32 v67, v67
    v_cvt_pk_bf16_f32 v88, v60, v61
    v_cvt_pk_bf16_f32 v89, v62, v63
    v_cvt_pk_bf16_f32 v90, v64, v65
    v_cvt_pk_bf16_f32 v91, v66, v67
    s_waitcnt lgkmcnt(2)
    v_mfma_f32_32x32x16_bf16 v[52:67], v[20:23], v[4:7], 0
    v_exp_f32 v68, v68
    v_exp_f32 v69, v69
    v_exp_f32 v70, v70
    v_exp_f32 v71, v71
    v_mfma_f32_32x32x16_bf16 v[100:115], v[48:51], v[88:91], v[100:115]
    v_exp_f32 v72, v72
    v_exp_f32 v73, v73
    v_exp_f32 v74, v74
    v_exp_f32 v75, v75
    v_cvt_pk_bf16_f32 v92, v68, v69
    v_cvt_pk_bf16_f32 v93, v70, v71
    v_mfma_f32_32x32x16_bf16 v[52:67], v[24:27], v[8:11], v[52:67]
    v_cvt_pk_bf16_f32 v94, v72, v73
    v_cvt_pk_bf16_f32 v95, v74, v75
    v_exp_f32 v76, v76
    v_exp_f32 v77, v77
    v_exp_f32 v78, v78
    v_exp_f32 v79, v79
    v_mfma_f32_32x32x16_bf16 v[116:131], v[44:47], v[92:95], v[116:131]
    v_exp_f32 v80, v80
    v_exp_f32 v81, v81
    v_exp_f32 v82, v82
    v_exp_f32 v83, v83
    v_cvt_pk_bf16_f32 v96, v76, v77
    v_cvt_pk_bf16_f32 v97, v78, v79
    v_cvt_pk_bf16_f32 v98, v80, v81
    v_cvt_pk_bf16_f32 v99, v82, v83
    s_waitcnt lgkmcnt(0)
    v_mfma_f32_32x32x16_bf16 v[68:83], v[20:23], v[12:15], 0
    v_exp_f32 v52, v52
    v_exp_f32 v53, v53
    v_exp_f32 v54, v54
    v_exp_f32 v55, v55
    v_mfma_f32_32x32x16_bf16 v[116:131], v[48:51], v[96:99], v[116:131]
    s_mov_b32 s44, 0x0
    buffer_store_dwordx4 v[188:191], v182, s[24:27], s44 offen sc1
    ds_read_b128 v[28:31], v2 offset:10240
    ds_read_b128 v[32:35], v2 offset:11264
    ds_read_b128 v[44:47], v2 offset:26624
    ds_read_b128 v[48:51], v2 offset:27648
    v_exp_f32 v56, v56
    v_exp_f32 v57, v57
    v_exp_f32 v58, v58
    v_exp_f32 v59, v59
    v_cvt_pk_bf16_f32 v84, v52, v53
    v_cvt_pk_bf16_f32 v85, v54, v55
    v_mfma_f32_32x32x16_bf16 v[68:83], v[24:27], v[16:19], v[68:83]
    v_cvt_pk_bf16_f32 v86, v56, v57
    v_cvt_pk_bf16_f32 v87, v58, v59
    v_exp_f32 v60, v60
    v_exp_f32 v61, v61
    v_exp_f32 v62, v62
    v_exp_f32 v63, v63
    v_mfma_f32_32x32x16_bf16 v[100:115], v[36:39], v[84:87], v[100:115]
    v_exp_f32 v64, v64
    v_exp_f32 v65, v65
    v_exp_f32 v66, v66
    v_exp_f32 v67, v67
    v_cvt_pk_bf16_f32 v88, v60, v61
    v_cvt_pk_bf16_f32 v89, v62, v63
    v_cvt_pk_bf16_f32 v90, v64, v65
    v_cvt_pk_bf16_f32 v91, v66, v67
    s_waitcnt lgkmcnt(2)
    v_mfma_f32_32x32x16_bf16 v[52:67], v[28:31], v[4:7], 0
    v_exp_f32 v68, v68
    v_exp_f32 v69, v69
    v_exp_f32 v70, v70
    v_exp_f32 v71, v71
    v_mfma_f32_32x32x16_bf16 v[100:115], v[40:43], v[88:91], v[100:115]
    v_exp_f32 v72, v72
    v_exp_f32 v73, v73
    v_exp_f32 v74, v74
    v_exp_f32 v75, v75
    v_cvt_pk_bf16_f32 v92, v68, v69
    v_cvt_pk_bf16_f32 v93, v70, v71
    v_mfma_f32_32x32x16_bf16 v[52:67], v[32:35], v[8:11], v[52:67]
    v_cvt_pk_bf16_f32 v94, v72, v73
    v_cvt_pk_bf16_f32 v95, v74, v75
    v_exp_f32 v76, v76
    v_exp_f32 v77, v77
    v_exp_f32 v78, v78
    v_exp_f32 v79, v79
    v_mfma_f32_32x32x16_bf16 v[116:131], v[36:39], v[92:95], v[116:131]
    v_exp_f32 v80, v80
    v_exp_f32 v81, v81
    v_exp_f32 v82, v82
    v_exp_f32 v83, v83
    v_cvt_pk_bf16_f32 v96, v76, v77
    v_cvt_pk_bf16_f32 v97, v78, v79
    v_cvt_pk_bf16_f32 v98, v80, v81
    v_cvt_pk_bf16_f32 v99, v82, v83
    s_waitcnt lgkmcnt(0)
    v_mfma_f32_32x32x16_bf16 v[68:83], v[28:31], v[12:15], 0
    v_exp_f32 v52, v52
    v_exp_f32 v53, v53
    v_exp_f32 v54, v54
    v_exp_f32 v55, v55
    v_mfma_f32_32x32x16_bf16 v[116:131], v[40:43], v[96:99], v[116:131]
    s_mov_b32 s44, 0x100000
    buffer_store_dwordx4 v[192:195], v183, s[24:27], s44 offen sc1
    ds_read_b128 v[20:23], v2 offset:12288
    ds_read_b128 v[24:27], v2 offset:13312
    ds_read_b128 v[36:39], v2 offset:28672
    ds_read_b128 v[40:43], v2 offset:29696
    v_exp_f32 v56, v56
    v_exp_f32 v57, v57
    v_exp_f32 v58, v58
    v_exp_f32 v59, v59
    v_cvt_pk_bf16_f32 v84, v52, v53
    v_cvt_pk_bf16_f32 v85, v54, v55
    v_mfma_f32_32x32x16_bf16 v[68:83], v[32:35], v[16:19], v[68:83]
    v_cvt_pk_bf16_f32 v86, v56, v57
    v_cvt_pk_bf16_f32 v87, v58, v59
    v_exp_f32 v60, v60
    v_exp_f32 v61, v61
    v_exp_f32 v62, v62
    v_exp_f32 v63, v63
    v_mfma_f32_32x32x16_bf16 v[100:115], v[44:47], v[84:87], v[100:115]
    v_exp_f32 v64, v64
    v_exp_f32 v65, v65
    v_exp_f32 v66, v66
    v_exp_f32 v67, v67
    v_cvt_pk_bf16_f32 v88, v60, v61
    v_cvt_pk_bf16_f32 v89, v62, v63
    v_cvt_pk_bf16_f32 v90, v64, v65
    v_cvt_pk_bf16_f32 v91, v66, v67
    s_waitcnt lgkmcnt(2)
    v_mfma_f32_32x32x16_bf16 v[52:67], v[20:23], v[4:7], 0
    v_exp_f32 v68, v68
    v_exp_f32 v69, v69
    v_exp_f32 v70, v70
    v_exp_f32 v71, v71
    v_mfma_f32_32x32x16_bf16 v[100:115], v[48:51], v[88:91], v[100:115]
    v_exp_f32 v72, v72
    v_exp_f32 v73, v73
    v_exp_f32 v74, v74
    v_exp_f32 v75, v75
    v_cvt_pk_bf16_f32 v92, v68, v69
    v_cvt_pk_bf16_f32 v93, v70, v71
    v_mfma_f32_32x32x16_bf16 v[52:67], v[24:27], v[8:11], v[52:67]
    v_cvt_pk_bf16_f32 v94, v72, v73
    v_cvt_pk_bf16_f32 v95, v74, v75
    v_exp_f32 v76, v76
    v_exp_f32 v77, v77
    v_exp_f32 v78, v78
    v_exp_f32 v79, v79
    v_mfma_f32_32x32x16_bf16 v[116:131], v[44:47], v[92:95], v[116:131]
    v_exp_f32 v80, v80
    v_exp_f32 v81, v81
    v_exp_f32 v82, v82
    v_exp_f32 v83, v83
    v_cvt_pk_bf16_f32 v96, v76, v77
    v_cvt_pk_bf16_f32 v97, v78, v79
    v_cvt_pk_bf16_f32 v98, v80, v81
    v_cvt_pk_bf16_f32 v99, v82, v83
    s_waitcnt lgkmcnt(0)
    v_mfma_f32_32x32x16_bf16 v[68:83], v[20:23], v[12:15], 0
    v_exp_f32 v52, v52
    v_exp_f32 v53, v53
    v_exp_f32 v54, v54
    v_exp_f32 v55, v55
    v_mfma_f32_32x32x16_bf16 v[116:131], v[48:51], v[96:99], v[116:131]
    s_mov_b32 s44, 0x100000
    buffer_store_dwordx4 v[196:199], v184, s[24:27], s44 offen sc1
    ds_read_b128 v[28:31], v2 offset:14336
    ds_read_b128 v[32:35], v2 offset:15360
    ds_read_b128 v[44:47], v2 offset:30720
    ds_read_b128 v[48:51], v2 offset:31744
    v_exp_f32 v56, v56
    v_exp_f32 v57, v57
    v_exp_f32 v58, v58
    v_exp_f32 v59, v59
    v_cvt_pk_bf16_f32 v84, v52, v53
    v_cvt_pk_bf16_f32 v85, v54, v55
    v_mfma_f32_32x32x16_bf16 v[68:83], v[24:27], v[16:19], v[68:83]
    v_cvt_pk_bf16_f32 v86, v56, v57
    v_cvt_pk_bf16_f32 v87, v58, v59
    v_exp_f32 v60, v60
    v_exp_f32 v61, v61
    v_exp_f32 v62, v62
    v_exp_f32 v63, v63
    v_mfma_f32_32x32x16_bf16 v[100:115], v[36:39], v[84:87], v[100:115]
    v_exp_f32 v64, v64
    v_exp_f32 v65, v65
    v_exp_f32 v66, v66
    v_exp_f32 v67, v67
    v_cvt_pk_bf16_f32 v88, v60, v61
    v_cvt_pk_bf16_f32 v89, v62, v63
    v_cvt_pk_bf16_f32 v90, v64, v65
    v_cvt_pk_bf16_f32 v91, v66, v67
    s_waitcnt lgkmcnt(2)
    v_mfma_f32_32x32x16_bf16 v[52:67], v[28:31], v[4:7], 0
    v_exp_f32 v68, v68
    v_exp_f32 v69, v69
    v_exp_f32 v70, v70
    v_exp_f32 v71, v71
    v_mfma_f32_32x32x16_bf16 v[100:115], v[40:43], v[88:91], v[100:115]
    v_exp_f32 v72, v72
    v_exp_f32 v73, v73
    v_exp_f32 v74, v74
    v_exp_f32 v75, v75
    v_cvt_pk_bf16_f32 v92, v68, v69
    v_cvt_pk_bf16_f32 v93, v70, v71
    v_mfma_f32_32x32x16_bf16 v[52:67], v[32:35], v[8:11], v[52:67]
    v_cvt_pk_bf16_f32 v94, v72, v73
    v_cvt_pk_bf16_f32 v95, v74, v75
    v_exp_f32 v76, v76
    v_exp_f32 v77, v77
    v_exp_f32 v78, v78
    v_exp_f32 v79, v79
    v_mfma_f32_32x32x16_bf16 v[116:131], v[36:39], v[92:95], v[116:131]
    v_exp_f32 v80, v80
    v_exp_f32 v81, v81
    v_exp_f32 v82, v82
    v_exp_f32 v83, v83
    v_cvt_pk_bf16_f32 v96, v76, v77
    v_cvt_pk_bf16_f32 v97, v78, v79
    v_cvt_pk_bf16_f32 v98, v80, v81
    v_cvt_pk_bf16_f32 v99, v82, v83
    s_waitcnt lgkmcnt(0)
    v_mfma_f32_32x32x16_bf16 v[68:83], v[28:31], v[12:15], 0
    v_exp_f32 v52, v52
    v_exp_f32 v53, v53
    v_exp_f32 v54, v54
    v_exp_f32 v55, v55
    v_mfma_f32_32x32x16_bf16 v[116:131], v[40:43], v[96:99], v[116:131]
    s_waitcnt vmcnt(3) lgkmcnt(0)
    s_barrier
    ds_read_b128 v[20:23], v3 offset:0
    ds_read_b128 v[24:27], v3 offset:1024
    ds_read_b128 v[36:39], v3 offset:16384
    ds_read_b128 v[40:43], v3 offset:17408
    v_exp_f32 v56, v56
    v_exp_f32 v57, v57
    v_exp_f32 v58, v58
    v_exp_f32 v59, v59
    v_cvt_pk_bf16_f32 v84, v52, v53
    v_cvt_pk_bf16_f32 v85, v54, v55
    v_mfma_f32_32x32x16_bf16 v[68:83], v[32:35], v[16:19], v[68:83]
    v_cvt_pk_bf16_f32 v86, v56, v57
    v_cvt_pk_bf16_f32 v87, v58, v59
    v_exp_f32 v60, v60
    v_exp_f32 v61, v61
    v_exp_f32 v62, v62
    v_exp_f32 v63, v63
    v_mfma_f32_32x32x16_bf16 v[100:115], v[44:47], v[84:87], v[100:115]
    v_exp_f32 v64, v64
    v_exp_f32 v65, v65
    v_exp_f32 v66, v66
    v_exp_f32 v67, v67
    v_cvt_pk_bf16_f32 v88, v60, v61
    v_cvt_pk_bf16_f32 v89, v62, v63
    v_cvt_pk_bf16_f32 v90, v64, v65
    v_cvt_pk_bf16_f32 v91, v66, v67
    s_waitcnt lgkmcnt(2)
    v_mfma_f32_32x32x16_bf16 v[52:67], v[20:23], v[4:7], 0
    v_exp_f32 v68, v68
    v_exp_f32 v69, v69
    v_exp_f32 v70, v70
    v_exp_f32 v71, v71
    v_mfma_f32_32x32x16_bf16 v[100:115], v[48:51], v[88:91], v[100:115]
    v_exp_f32 v72, v72
    v_exp_f32 v73, v73
    v_exp_f32 v74, v74
    v_exp_f32 v75, v75
    v_cvt_pk_bf16_f32 v92, v68, v69
    v_cvt_pk_bf16_f32 v93, v70, v71
    v_mfma_f32_32x32x16_bf16 v[52:67], v[24:27], v[8:11], v[52:67]
    v_cvt_pk_bf16_f32 v94, v72, v73
    v_cvt_pk_bf16_f32 v95, v74, v75
    v_exp_f32 v76, v76
    v_exp_f32 v77, v77
    v_exp_f32 v78, v78
    v_exp_f32 v79, v79
    v_mfma_f32_32x32x16_bf16 v[116:131], v[44:47], v[92:95], v[116:131]
    v_exp_f32 v80, v80
    v_exp_f32 v81, v81
    v_exp_f32 v82, v82
    v_exp_f32 v83, v83
    v_cvt_pk_bf16_f32 v96, v76, v77
    v_cvt_pk_bf16_f32 v97, v78, v79
    v_cvt_pk_bf16_f32 v98, v80, v81
    v_cvt_pk_bf16_f32 v99, v82, v83
    s_waitcnt lgkmcnt(0)
    v_mfma_f32_32x32x16_bf16 v[68:83], v[20:23], v[12:15], 0
    v_exp_f32 v52, v52
    v_exp_f32 v53, v53
    v_exp_f32 v54, v54
    v_exp_f32 v55, v55
    v_mfma_f32_32x32x16_bf16 v[116:131], v[48:51], v[96:99], v[116:131]
    s_mov_b32 s44, 0x320000
    buffer_store_dwordx4 v[200:203], v185, s[24:27], s44 offen sc1
    ds_read_b128 v[28:31], v3 offset:2048
    ds_read_b128 v[32:35], v3 offset:3072
    ds_read_b128 v[44:47], v3 offset:18432
    ds_read_b128 v[48:51], v3 offset:19456
    v_exp_f32 v56, v56
    v_exp_f32 v57, v57
    v_exp_f32 v58, v58
    v_exp_f32 v59, v59
    v_cvt_pk_bf16_f32 v84, v52, v53
    v_cvt_pk_bf16_f32 v85, v54, v55
    v_mfma_f32_32x32x16_bf16 v[68:83], v[24:27], v[16:19], v[68:83]
    v_cvt_pk_bf16_f32 v86, v56, v57
    v_cvt_pk_bf16_f32 v87, v58, v59
    v_exp_f32 v60, v60
    v_exp_f32 v61, v61
    v_exp_f32 v62, v62
    v_exp_f32 v63, v63
    v_mfma_f32_32x32x16_bf16 v[100:115], v[36:39], v[84:87], v[100:115]
    v_exp_f32 v64, v64
    v_exp_f32 v65, v65
    v_exp_f32 v66, v66
    v_exp_f32 v67, v67
    v_cvt_pk_bf16_f32 v88, v60, v61
    v_cvt_pk_bf16_f32 v89, v62, v63
    v_cvt_pk_bf16_f32 v90, v64, v65
    v_cvt_pk_bf16_f32 v91, v66, v67
    s_waitcnt lgkmcnt(2)
    v_mfma_f32_32x32x16_bf16 v[52:67], v[28:31], v[4:7], 0
    v_exp_f32 v68, v68
    v_exp_f32 v69, v69
    v_exp_f32 v70, v70
    v_exp_f32 v71, v71
    v_mfma_f32_32x32x16_bf16 v[100:115], v[40:43], v[88:91], v[100:115]
    v_exp_f32 v72, v72
    v_exp_f32 v73, v73
    v_exp_f32 v74, v74
    v_exp_f32 v75, v75
    v_cvt_pk_bf16_f32 v92, v68, v69
    v_cvt_pk_bf16_f32 v93, v70, v71
    v_mfma_f32_32x32x16_bf16 v[52:67], v[32:35], v[8:11], v[52:67]
    v_cvt_pk_bf16_f32 v94, v72, v73
    v_cvt_pk_bf16_f32 v95, v74, v75
    v_exp_f32 v76, v76
    v_exp_f32 v77, v77
    v_exp_f32 v78, v78
    v_exp_f32 v79, v79
    v_mfma_f32_32x32x16_bf16 v[116:131], v[36:39], v[92:95], v[116:131]
    v_exp_f32 v80, v80
    v_exp_f32 v81, v81
    v_exp_f32 v82, v82
    v_exp_f32 v83, v83
    v_cvt_pk_bf16_f32 v96, v76, v77
    v_cvt_pk_bf16_f32 v97, v78, v79
    v_cvt_pk_bf16_f32 v98, v80, v81
    v_cvt_pk_bf16_f32 v99, v82, v83
    s_waitcnt lgkmcnt(0)
    v_mfma_f32_32x32x16_bf16 v[68:83], v[28:31], v[12:15], 0
    v_exp_f32 v52, v52
    v_exp_f32 v53, v53
    v_exp_f32 v54, v54
    v_exp_f32 v55, v55
    v_mfma_f32_32x32x16_bf16 v[116:131], v[40:43], v[96:99], v[116:131]
    s_mov_b32 s44, 0x320000
    buffer_store_dwordx4 v[204:207], v186, s[24:27], s44 offen sc1
    ds_read_b128 v[20:23], v3 offset:4096
    ds_read_b128 v[24:27], v3 offset:5120
    ds_read_b128 v[36:39], v3 offset:20480
    ds_read_b128 v[40:43], v3 offset:21504
    v_exp_f32 v56, v56
    v_exp_f32 v57, v57
    v_exp_f32 v58, v58
    v_exp_f32 v59, v59
    v_cvt_pk_bf16_f32 v84, v52, v53
    v_cvt_pk_bf16_f32 v85, v54, v55
    v_mfma_f32_32x32x16_bf16 v[68:83], v[32:35], v[16:19], v[68:83]
    v_cvt_pk_bf16_f32 v86, v56, v57
    v_cvt_pk_bf16_f32 v87, v58, v59
    v_exp_f32 v60, v60
    v_exp_f32 v61, v61
    v_exp_f32 v62, v62
    v_exp_f32 v63, v63
    v_mfma_f32_32x32x16_bf16 v[100:115], v[44:47], v[84:87], v[100:115]
    v_exp_f32 v64, v64
    v_exp_f32 v65, v65
    v_exp_f32 v66, v66
    v_exp_f32 v67, v67
    v_cvt_pk_bf16_f32 v88, v60, v61
    v_cvt_pk_bf16_f32 v89, v62, v63
    v_cvt_pk_bf16_f32 v90, v64, v65
    v_cvt_pk_bf16_f32 v91, v66, v67
    s_waitcnt lgkmcnt(2)
    v_mfma_f32_32x32x16_bf16 v[52:67], v[20:23], v[4:7], 0
    v_exp_f32 v68, v68
    v_exp_f32 v69, v69
    v_exp_f32 v70, v70
    v_exp_f32 v71, v71
    v_mfma_f32_32x32x16_bf16 v[100:115], v[48:51], v[88:91], v[100:115]
    v_exp_f32 v72, v72
    v_exp_f32 v73, v73
    v_exp_f32 v74, v74
    v_exp_f32 v75, v75
    v_cvt_pk_bf16_f32 v92, v68, v69
    v_cvt_pk_bf16_f32 v93, v70, v71
    v_mfma_f32_32x32x16_bf16 v[52:67], v[24:27], v[8:11], v[52:67]
    v_cvt_pk_bf16_f32 v94, v72, v73
    v_cvt_pk_bf16_f32 v95, v74, v75
    v_exp_f32 v76, v76
    v_exp_f32 v77, v77
    v_exp_f32 v78, v78
    v_exp_f32 v79, v79
    v_mfma_f32_32x32x16_bf16 v[116:131], v[44:47], v[92:95], v[116:131]
    v_exp_f32 v80, v80
    v_exp_f32 v81, v81
    v_exp_f32 v82, v82
    v_exp_f32 v83, v83
    v_cvt_pk_bf16_f32 v96, v76, v77
    v_cvt_pk_bf16_f32 v97, v78, v79
    v_cvt_pk_bf16_f32 v98, v80, v81
    v_cvt_pk_bf16_f32 v99, v82, v83
    s_waitcnt lgkmcnt(0)
    v_mfma_f32_32x32x16_bf16 v[68:83], v[20:23], v[12:15], 0
    v_exp_f32 v52, v52
    v_exp_f32 v53, v53
    v_exp_f32 v54, v54
    v_exp_f32 v55, v55
    v_mfma_f32_32x32x16_bf16 v[116:131], v[48:51], v[96:99], v[116:131]
    s_mov_b32 s44, 0x550000
    buffer_store_dwordx4 v[208:211], v185, s[24:27], s44 offen sc1
    ds_read_b128 v[28:31], v3 offset:6144
    ds_read_b128 v[32:35], v3 offset:7168
    ds_read_b128 v[44:47], v3 offset:22528
    ds_read_b128 v[48:51], v3 offset:23552
    v_exp_f32 v56, v56
    v_exp_f32 v57, v57
    v_exp_f32 v58, v58
    v_exp_f32 v59, v59
    v_cvt_pk_bf16_f32 v84, v52, v53
    v_cvt_pk_bf16_f32 v85, v54, v55
    v_mfma_f32_32x32x16_bf16 v[68:83], v[24:27], v[16:19], v[68:83]
    v_cvt_pk_bf16_f32 v86, v56, v57
    v_cvt_pk_bf16_f32 v87, v58, v59
    v_exp_f32 v60, v60
    v_exp_f32 v61, v61
    v_exp_f32 v62, v62
    v_exp_f32 v63, v63
    v_mfma_f32_32x32x16_bf16 v[100:115], v[36:39], v[84:87], v[100:115]
    v_exp_f32 v64, v64
    v_exp_f32 v65, v65
    v_exp_f32 v66, v66
    v_exp_f32 v67, v67
    v_cvt_pk_bf16_f32 v88, v60, v61
    v_cvt_pk_bf16_f32 v89, v62, v63
    v_cvt_pk_bf16_f32 v90, v64, v65
    v_cvt_pk_bf16_f32 v91, v66, v67
    s_waitcnt lgkmcnt(2)
    v_mfma_f32_32x32x16_bf16 v[52:67], v[28:31], v[4:7], 0
    v_exp_f32 v68, v68
    v_exp_f32 v69, v69
    v_exp_f32 v70, v70
    v_exp_f32 v71, v71
    v_mfma_f32_32x32x16_bf16 v[100:115], v[40:43], v[88:91], v[100:115]
    v_exp_f32 v72, v72
    v_exp_f32 v73, v73
    v_exp_f32 v74, v74
    v_exp_f32 v75, v75
    v_cvt_pk_bf16_f32 v92, v68, v69
    v_cvt_pk_bf16_f32 v93, v70, v71
    v_mfma_f32_32x32x16_bf16 v[52:67], v[32:35], v[8:11], v[52:67]
    v_cvt_pk_bf16_f32 v94, v72, v73
    v_cvt_pk_bf16_f32 v95, v74, v75
    v_exp_f32 v76, v76
    v_exp_f32 v77, v77
    v_exp_f32 v78, v78
    v_exp_f32 v79, v79
    v_mfma_f32_32x32x16_bf16 v[116:131], v[36:39], v[92:95], v[116:131]
    v_exp_f32 v80, v80
    v_exp_f32 v81, v81
    v_exp_f32 v82, v82
    v_exp_f32 v83, v83
    v_cvt_pk_bf16_f32 v96, v76, v77
    v_cvt_pk_bf16_f32 v97, v78, v79
    v_cvt_pk_bf16_f32 v98, v80, v81
    v_cvt_pk_bf16_f32 v99, v82, v83
    s_waitcnt lgkmcnt(0)
    v_mfma_f32_32x32x16_bf16 v[68:83], v[28:31], v[12:15], 0
    v_exp_f32 v52, v52
    v_exp_f32 v53, v53
    v_exp_f32 v54, v54
    v_exp_f32 v55, v55
    v_mfma_f32_32x32x16_bf16 v[116:131], v[40:43], v[96:99], v[116:131]
    s_mov_b32 s44, 0x550000
    buffer_store_dwordx4 v[212:215], v186, s[24:27], s44 offen sc1
    ds_read_b128 v[20:23], v3 offset:8192
    ds_read_b128 v[24:27], v3 offset:9216
    ds_read_b128 v[36:39], v3 offset:24576
    ds_read_b128 v[40:43], v3 offset:25600
    v_exp_f32 v56, v56
    v_exp_f32 v57, v57
    v_exp_f32 v58, v58
    v_exp_f32 v59, v59
    v_cvt_pk_bf16_f32 v84, v52, v53
    v_cvt_pk_bf16_f32 v85, v54, v55
    v_mfma_f32_32x32x16_bf16 v[68:83], v[32:35], v[16:19], v[68:83]
    v_cvt_pk_bf16_f32 v86, v56, v57
    v_cvt_pk_bf16_f32 v87, v58, v59
    v_exp_f32 v60, v60
    v_exp_f32 v61, v61
    v_exp_f32 v62, v62
    v_exp_f32 v63, v63
    v_mfma_f32_32x32x16_bf16 v[100:115], v[44:47], v[84:87], v[100:115]
    v_exp_f32 v64, v64
    v_exp_f32 v65, v65
    v_exp_f32 v66, v66
    v_exp_f32 v67, v67
    v_cvt_pk_bf16_f32 v88, v60, v61
    v_cvt_pk_bf16_f32 v89, v62, v63
    v_cvt_pk_bf16_f32 v90, v64, v65
    v_cvt_pk_bf16_f32 v91, v66, v67
    s_waitcnt lgkmcnt(2)
    v_mfma_f32_32x32x16_bf16 v[52:67], v[20:23], v[4:7], 0
    v_exp_f32 v68, v68
    v_exp_f32 v69, v69
    v_exp_f32 v70, v70
    v_exp_f32 v71, v71
    v_mfma_f32_32x32x16_bf16 v[100:115], v[48:51], v[88:91], v[100:115]
    v_exp_f32 v72, v72
    v_exp_f32 v73, v73
    v_exp_f32 v74, v74
    v_exp_f32 v75, v75
    v_cvt_pk_bf16_f32 v92, v68, v69
    v_cvt_pk_bf16_f32 v93, v70, v71
    v_mfma_f32_32x32x16_bf16 v[52:67], v[24:27], v[8:11], v[52:67]
    v_cvt_pk_bf16_f32 v94, v72, v73
    v_cvt_pk_bf16_f32 v95, v74, v75
    v_exp_f32 v76, v76
    v_exp_f32 v77, v77
    v_exp_f32 v78, v78
    v_exp_f32 v79, v79
    v_mfma_f32_32x32x16_bf16 v[116:131], v[44:47], v[92:95], v[116:131]
    v_exp_f32 v80, v80
    v_exp_f32 v81, v81
    v_exp_f32 v82, v82
    v_exp_f32 v83, v83
    v_cvt_pk_bf16_f32 v96, v76, v77
    v_cvt_pk_bf16_f32 v97, v78, v79
    v_cvt_pk_bf16_f32 v98, v80, v81
    v_cvt_pk_bf16_f32 v99, v82, v83
    s_waitcnt lgkmcnt(0)
    v_mfma_f32_32x32x16_bf16 v[68:83], v[20:23], v[12:15], 0
    v_exp_f32 v52, v52
    v_exp_f32 v53, v53
    v_exp_f32 v54, v54
    v_exp_f32 v55, v55
    v_mfma_f32_32x32x16_bf16 v[116:131], v[48:51], v[96:99], v[116:131]
    ds_read_b128 v[28:31], v3 offset:10240
    ds_read_b128 v[32:35], v3 offset:11264
    ds_read_b128 v[44:47], v3 offset:26624
    ds_read_b128 v[48:51], v3 offset:27648
    v_exp_f32 v56, v56
    v_exp_f32 v57, v57
    v_exp_f32 v58, v58
    v_exp_f32 v59, v59
    v_cvt_pk_bf16_f32 v84, v52, v53
    v_cvt_pk_bf16_f32 v85, v54, v55
    v_mfma_f32_32x32x16_bf16 v[68:83], v[24:27], v[16:19], v[68:83]
    v_cvt_pk_bf16_f32 v86, v56, v57
    v_cvt_pk_bf16_f32 v87, v58, v59
    v_exp_f32 v60, v60
    v_exp_f32 v61, v61
    v_exp_f32 v62, v62
    v_exp_f32 v63, v63
    v_mfma_f32_32x32x16_bf16 v[100:115], v[36:39], v[84:87], v[100:115]
    v_exp_f32 v64, v64
    v_exp_f32 v65, v65
    v_exp_f32 v66, v66
    v_exp_f32 v67, v67
    v_cvt_pk_bf16_f32 v88, v60, v61
    v_cvt_pk_bf16_f32 v89, v62, v63
    v_cvt_pk_bf16_f32 v90, v64, v65
    v_cvt_pk_bf16_f32 v91, v66, v67
    s_waitcnt lgkmcnt(2)
    v_mfma_f32_32x32x16_bf16 v[52:67], v[28:31], v[4:7], 0
    v_exp_f32 v68, v68
    v_exp_f32 v69, v69
    v_exp_f32 v70, v70
    v_exp_f32 v71, v71
    v_mfma_f32_32x32x16_bf16 v[100:115], v[40:43], v[88:91], v[100:115]
    v_exp_f32 v72, v72
    v_exp_f32 v73, v73
    v_exp_f32 v74, v74
    v_exp_f32 v75, v75
    v_cvt_pk_bf16_f32 v92, v68, v69
    v_cvt_pk_bf16_f32 v93, v70, v71
    v_mfma_f32_32x32x16_bf16 v[52:67], v[32:35], v[8:11], v[52:67]
    v_cvt_pk_bf16_f32 v94, v72, v73
    v_cvt_pk_bf16_f32 v95, v74, v75
    v_exp_f32 v76, v76
    v_exp_f32 v77, v77
    v_exp_f32 v78, v78
    v_exp_f32 v79, v79
    v_mfma_f32_32x32x16_bf16 v[116:131], v[36:39], v[92:95], v[116:131]
    v_exp_f32 v80, v80
    v_exp_f32 v81, v81
    v_exp_f32 v82, v82
    v_exp_f32 v83, v83
    v_cvt_pk_bf16_f32 v96, v76, v77
    v_cvt_pk_bf16_f32 v97, v78, v79
    v_cvt_pk_bf16_f32 v98, v80, v81
    v_cvt_pk_bf16_f32 v99, v82, v83
    s_waitcnt lgkmcnt(0)
    v_mfma_f32_32x32x16_bf16 v[68:83], v[28:31], v[12:15], 0
    v_exp_f32 v52, v52
    v_exp_f32 v53, v53
    v_exp_f32 v54, v54
    v_exp_f32 v55, v55
    v_mfma_f32_32x32x16_bf16 v[116:131], v[40:43], v[96:99], v[116:131]
    ds_read_b128 v[20:23], v3 offset:12288
    ds_read_b128 v[24:27], v3 offset:13312
    ds_read_b128 v[36:39], v3 offset:28672
    ds_read_b128 v[40:43], v3 offset:29696
    v_exp_f32 v56, v56
    v_exp_f32 v57, v57
    v_exp_f32 v58, v58
    v_exp_f32 v59, v59
    v_cvt_pk_bf16_f32 v84, v52, v53
    v_cvt_pk_bf16_f32 v85, v54, v55
    v_mfma_f32_32x32x16_bf16 v[68:83], v[32:35], v[16:19], v[68:83]
    v_cvt_pk_bf16_f32 v86, v56, v57
    v_cvt_pk_bf16_f32 v87, v58, v59
    v_exp_f32 v60, v60
    v_exp_f32 v61, v61
    v_exp_f32 v62, v62
    v_exp_f32 v63, v63
    v_mfma_f32_32x32x16_bf16 v[100:115], v[44:47], v[84:87], v[100:115]
    v_exp_f32 v64, v64
    v_exp_f32 v65, v65
    v_exp_f32 v66, v66
    v_exp_f32 v67, v67
    v_cvt_pk_bf16_f32 v88, v60, v61
    v_cvt_pk_bf16_f32 v89, v62, v63
    v_cvt_pk_bf16_f32 v90, v64, v65
    v_cvt_pk_bf16_f32 v91, v66, v67
    s_waitcnt lgkmcnt(2)
    v_mfma_f32_32x32x16_bf16 v[52:67], v[20:23], v[4:7], 0
    v_exp_f32 v68, v68
    v_exp_f32 v69, v69
    v_exp_f32 v70, v70
    v_exp_f32 v71, v71
    v_mfma_f32_32x32x16_bf16 v[100:115], v[48:51], v[88:91], v[100:115]
    v_exp_f32 v72, v72
    v_exp_f32 v73, v73
    v_exp_f32 v74, v74
    v_exp_f32 v75, v75
    v_cvt_pk_bf16_f32 v92, v68, v69
    v_cvt_pk_bf16_f32 v93, v70, v71
    v_mfma_f32_32x32x16_bf16 v[52:67], v[24:27], v[8:11], v[52:67]
    v_cvt_pk_bf16_f32 v94, v72, v73
    v_cvt_pk_bf16_f32 v95, v74, v75
    v_exp_f32 v76, v76
    v_exp_f32 v77, v77
    v_exp_f32 v78, v78
    v_exp_f32 v79, v79
    v_mfma_f32_32x32x16_bf16 v[116:131], v[44:47], v[92:95], v[116:131]
    v_exp_f32 v80, v80
    v_exp_f32 v81, v81
    v_exp_f32 v82, v82
    v_exp_f32 v83, v83
    v_cvt_pk_bf16_f32 v96, v76, v77
    v_cvt_pk_bf16_f32 v97, v78, v79
    v_cvt_pk_bf16_f32 v98, v80, v81
    v_cvt_pk_bf16_f32 v99, v82, v83
    s_waitcnt lgkmcnt(0)
    v_mfma_f32_32x32x16_bf16 v[68:83], v[20:23], v[12:15], 0
    v_exp_f32 v52, v52
    v_exp_f32 v53, v53
    v_exp_f32 v54, v54
    v_exp_f32 v55, v55
    v_mfma_f32_32x32x16_bf16 v[116:131], v[48:51], v[96:99], v[116:131]
    ds_read_b128 v[28:31], v3 offset:14336
    ds_read_b128 v[32:35], v3 offset:15360
    ds_read_b128 v[44:47], v3 offset:30720
    ds_read_b128 v[48:51], v3 offset:31744
    v_exp_f32 v56, v56
    v_exp_f32 v57, v57
    v_exp_f32 v58, v58
    v_exp_f32 v59, v59
    v_cvt_pk_bf16_f32 v84, v52, v53
    v_cvt_pk_bf16_f32 v85, v54, v55
    v_mfma_f32_32x32x16_bf16 v[68:83], v[24:27], v[16:19], v[68:83]
    v_cvt_pk_bf16_f32 v86, v56, v57
    v_cvt_pk_bf16_f32 v87, v58, v59
    v_exp_f32 v60, v60
    v_exp_f32 v61, v61
    v_exp_f32 v62, v62
    v_exp_f32 v63, v63
    v_mfma_f32_32x32x16_bf16 v[100:115], v[36:39], v[84:87], v[100:115]
    v_exp_f32 v64, v64
    v_exp_f32 v65, v65
    v_exp_f32 v66, v66
    v_exp_f32 v67, v67
    v_cvt_pk_bf16_f32 v88, v60, v61
    v_cvt_pk_bf16_f32 v89, v62, v63
    v_cvt_pk_bf16_f32 v90, v64, v65
    v_cvt_pk_bf16_f32 v91, v66, v67
    s_waitcnt lgkmcnt(2)
    v_mfma_f32_32x32x16_bf16 v[52:67], v[28:31], v[4:7], 0
    v_exp_f32 v68, v68
    v_exp_f32 v69, v69
    v_exp_f32 v70, v70
    v_exp_f32 v71, v71
    v_mfma_f32_32x32x16_bf16 v[100:115], v[40:43], v[88:91], v[100:115]
    v_exp_f32 v72, v72
    v_exp_f32 v73, v73
    v_exp_f32 v74, v74
    v_exp_f32 v75, v75
    v_cvt_pk_bf16_f32 v92, v68, v69
    v_cvt_pk_bf16_f32 v93, v70, v71
    v_mfma_f32_32x32x16_bf16 v[52:67], v[32:35], v[8:11], v[52:67]
    v_cvt_pk_bf16_f32 v94, v72, v73
    v_cvt_pk_bf16_f32 v95, v74, v75
    v_exp_f32 v76, v76
    v_exp_f32 v77, v77
    v_exp_f32 v78, v78
    v_exp_f32 v79, v79
    v_mfma_f32_32x32x16_bf16 v[116:131], v[36:39], v[92:95], v[116:131]
    v_exp_f32 v80, v80
    v_exp_f32 v81, v81
    v_exp_f32 v82, v82
    v_exp_f32 v83, v83
    v_cvt_pk_bf16_f32 v96, v76, v77
    v_cvt_pk_bf16_f32 v97, v78, v79
    v_cvt_pk_bf16_f32 v98, v80, v81
    v_cvt_pk_bf16_f32 v99, v82, v83
    s_waitcnt lgkmcnt(0)
    v_mfma_f32_32x32x16_bf16 v[68:83], v[28:31], v[12:15], 0
    v_exp_f32 v52, v52
    v_exp_f32 v53, v53
    v_exp_f32 v54, v54
    v_exp_f32 v55, v55
    v_mfma_f32_32x32x16_bf16 v[116:131], v[40:43], v[96:99], v[116:131]
    v_exp_f32 v56, v56
    v_exp_f32 v57, v57
    v_exp_f32 v58, v58
    v_exp_f32 v59, v59
    v_cvt_pk_bf16_f32 v84, v52, v53
    v_cvt_pk_bf16_f32 v85, v54, v55
    v_mfma_f32_32x32x16_bf16 v[68:83], v[32:35], v[16:19], v[68:83]
    v_cvt_pk_bf16_f32 v86, v56, v57
    v_cvt_pk_bf16_f32 v87, v58, v59
    v_exp_f32 v60, v60
    v_exp_f32 v61, v61
    v_exp_f32 v62, v62
    v_exp_f32 v63, v63
    v_mfma_f32_32x32x16_bf16 v[100:115], v[44:47], v[84:87], v[100:115]
    v_exp_f32 v64, v64
    v_exp_f32 v65, v65
    v_exp_f32 v66, v66
    v_exp_f32 v67, v67
    v_cvt_pk_bf16_f32 v88, v60, v61
    v_cvt_pk_bf16_f32 v89, v62, v63
    v_cvt_pk_bf16_f32 v90, v64, v65
    v_cvt_pk_bf16_f32 v91, v66, v67
    v_exp_f32 v68, v68
    v_exp_f32 v69, v69
    v_exp_f32 v70, v70
    v_exp_f32 v71, v71
    v_mfma_f32_32x32x16_bf16 v[100:115], v[48:51], v[88:91], v[100:115]
    v_exp_f32 v72, v72
    v_exp_f32 v73, v73
    v_exp_f32 v74, v74
    v_exp_f32 v75, v75
    v_cvt_pk_bf16_f32 v92, v68, v69
    v_cvt_pk_bf16_f32 v93, v70, v71
    v_cvt_pk_bf16_f32 v94, v72, v73
    v_cvt_pk_bf16_f32 v95, v74, v75
    v_exp_f32 v76, v76
    v_exp_f32 v77, v77
    v_exp_f32 v78, v78
    v_exp_f32 v79, v79
    v_mfma_f32_32x32x16_bf16 v[116:131], v[44:47], v[92:95], v[116:131]
    v_exp_f32 v80, v80
    v_exp_f32 v81, v81
    v_exp_f32 v82, v82
    v_exp_f32 v83, v83
    v_cvt_pk_bf16_f32 v96, v76, v77
    v_cvt_pk_bf16_f32 v97, v78, v79
    v_cvt_pk_bf16_f32 v98, v80, v81
    v_cvt_pk_bf16_f32 v99, v82, v83
    s_nop 1
    v_mfma_f32_32x32x16_bf16 v[116:131], v[48:51], v[96:99], v[116:131]
    s_nop 7
    s_nop 7
    s_setprio 0
    s_lshl_b32 s39, s35, 13
    s_mul_i32 s44, s36, 3072
    s_add_u32 s44, s44, s39
    v_add_u32 v132, s44, v252
    s_xor_b32 s44, s36, 1
    s_mul_i32 s44, s44, 3072
    s_add_u32 s44, s44, s39
    v_add_u32 v133, s44, v252
    s_cmp_eq_u32 s36, 0
    s_cbranch_scc1 L_k2_lo
    ds_write_b128 v132, v[100:103] offset:0
    ds_write_b128 v132, v[104:107] offset:1024
    ds_write_b128 v132, v[108:111] offset:2048
    v_mov_b32 v100, v116
    v_mov_b32 v101, v117
    v_mov_b32 v102, v118
    v_mov_b32 v103, v119
    v_mov_b32 v104, v120
    v_mov_b32 v105, v121
    v_mov_b32 v106, v122
    v_mov_b32 v107, v123
    v_mov_b32 v108, v124
    v_mov_b32 v109, v125
    v_mov_b32 v110, v126
    v_mov_b32 v111, v127
    s_branch L_k2_cmb
L_k2_lo:
    ds_write_b128 v132, v[116:119] offset:0
    ds_write_b128 v132, v[120:123] offset:1024
    ds_write_b128 v132, v[124:127] offset:2048
L_k2_cmb:
    s_waitcnt lgkmcnt(0)
    s_barrier
    ds_read_b128 v[52:55], v133 offset:0
    ds_read_b128 v[56:59], v133 offset:1024
    ds_read_b128 v[60:63], v133 offset:2048
    s_waitcnt lgkmcnt(0)
    v_add_f32 v100, v100, v52
    v_add_f32 v101, v101, v53
    v_add_f32 v102, v102, v54
    v_add_f32 v103, v103, v55
    v_add_f32 v104, v104, v56
    v_add_f32 v105, v105, v57
    v_add_f32 v106, v106, v58
    v_add_f32 v107, v107, v59
    v_add_f32 v108, v108, v60
    v_add_f32 v109, v109, v61
    v_add_f32 v110, v110, v62
    v_add_f32 v111, v111, v63
    v_mov_b32 v136, v108
    v_mov_b32 v134, v108
    s_nop 1
    v_permlane32_swap_b32 v136, v134
    v_mov_b32 v138, 0x12800000
    s_nop 0
    v_cmp_nge_f32 vcc, v134, v138
    s_nop 1
    s_cbranch_vccz L_k2_chk
    v_mov_b32 v136, 1
    v_mov_b32 v137, 131072
    ds_write_b32 v137, v136
    s_waitcnt lgkmcnt(0)
L_k2_chk:
    v_rcp_f32 v134, v134
    s_lshl_b32 s39, s34, 3
    s_lshl_b32 s44, s35, 1
    s_add_u32 s39, s39, s44
    s_add_u32 s39, s39, s36
    s_mul_i32 s39, s39, 20
    v_lshrrev_b32 v136, 4, v250
    v_mul_u32_u24 v136, 20480, v136
    v_and_b32 v137, 15, v250
    v_lshl_add_u32 v136, v137, 4, v136
    v_add_u32 v136, 0x400000, v136
    v_lshl_add_u32 v137, v251, 2, s39
    v_lshrrev_b32 v138, 5, v137
    v_lshl_add_u32 v142, v138, 10, v136
    v_bfe_u32 v138, v137, 2, 2
    v_lshl_add_u32 v142, v138, 8, v142
    v_bfe_u32 v138, v137, 4, 1
    v_lshl_add_u32 v142, v138, 3, v142
    v_lshl_add_u32 v137, v251, 2, s39
    v_add_u32 v137, 8, v137
    v_lshrrev_b32 v138, 5, v137
    v_lshl_add_u32 v143, v138, 10, v136
    v_bfe_u32 v138, v137, 2, 2
    v_lshl_add_u32 v143, v138, 8, v143
    v_bfe_u32 v138, v137, 4, 1
    v_lshl_add_u32 v143, v138, 3, v143
    v_lshl_add_u32 v137, v251, 2, s39
    v_add_u32 v137, 16, v137
    v_lshrrev_b32 v138, 5, v137
    v_lshl_add_u32 v144, v138, 10, v136
    v_bfe_u32 v138, v137, 2, 2
    v_lshl_add_u32 v144, v138, 8, v144
    v_bfe_u32 v138, v137, 4, 1
    v_lshl_add_u32 v144, v138, 3, v144
    v_mul_f32 v100, v100, v134
    v_mul_f32 v101, v101, v134
    v_mul_f32 v102, v102, v134
    v_mul_f32 v103, v103, v134
    v_mul_f32 v104, v104, v134
    v_mul_f32 v105, v105, v134
    v_mul_f32 v106, v106, v134
    v_mul_f32 v107, v107, v134
    v_mul_f32 v108, v108, v134
    v_mul_f32 v109, v109, v134
    v_mul_f32 v110, v110, v134
    v_mul_f32 v111, v111, v134
    v_cvt_pk_bf16_f32 v52, v100, v101
    v_cvt_pk_bf16_f32 v53, v102, v103
    v_cvt_pk_bf16_f32 v54, v104, v105
    v_cvt_pk_bf16_f32 v55, v106, v107
    v_cvt_pk_bf16_f32 v56, v108, v109
    v_cvt_pk_bf16_f32 v57, v110, v111
    s_barrier
    v_mov_b32 v137, 131072
    ds_read_b32 v136, v137
    v_lshlrev_b32 v140, 2, v1
    v_add_u32 v139, 131136, v140
    ds_read_b32 v138, v139
    s_waitcnt lgkmcnt(0)
    v_readfirstlane_b32 s44, v136
    s_add_u32 s44, s44, s60
    s_cmp_eq_u32 s44, 1
    s_cbranch_scc0 L_k2_fin
    s_cmp_eq_u32 s60, 0
    s_cbranch_scc1 L_k2_fallback
L_k2_fin:
    buffer_store_dwordx2 v[52:53], v142, s[8:11], 0 offen
    buffer_store_dwordx2 v[54:55], v143, s[8:11], 0 offen
    v_cmp_eq_u32 vcc, 0, v251
    s_and_saveexec_b64 s[46:47], vcc
    buffer_store_dwordx2 v[56:57], v144, s[8:11], 0 offen
    s_mov_b64 exec, s[46:47]
    s_cmp_eq_u32 s32, 4
    s_cbranch_scc0 L_k2_kernel_end
    s_cmp_lt_u32 s2, 216
    s_cbranch_scc0 L_k2_kernel_end
    s_lshl_b32 s39, s2, 6
    s_add_u32 s39, s39, 0x390000
    v_add_u32 v137, s39, v140
    v_cmp_gt_u32 vcc, 16, v1
    s_and_saveexec_b64 s[46:47], vcc
    buffer_store_dword v138, v137, s[8:11], 0 offen
    s_branch L_k2_kernel_end
L_k2_fallback:
    s_mov_b32 s60, 1
    v_mov_b32 v10, 0
    v_mov_b32 v11, 0
    v_mov_b32 v18, 0
    v_mov_b32 v19, 0
    v_mov_b32 v140, 0xff800000
    v_mov_b32 v141, 0xff800000
    s_lshl_b32 s44, s36, 16
    s_add_u32 s45, s44, 65536
L_k2_mx:
    buffer_load_dwordx4 v[20:23], v252, s[4:7], s44 offen
    buffer_load_dwordx4 v[24:27], v252, s[4:7], s44 offen offset:1024
    s_waitcnt vmcnt(0)
    v_mfma_f32_32x32x16_bf16 v[52:67], v[20:23], v[4:7], 0
    v_mfma_f32_32x32x16_bf16 v[52:67], v[24:27], v[8:11], v[52:67]
    v_mfma_f32_32x32x16_bf16 v[68:83], v[20:23], v[12:15], 0
    v_mfma_f32_32x32x16_bf16 v[68:83], v[24:27], v[16:19], v[68:83]
    s_nop 7
    s_nop 7
    v_max3_f32 v140, v52, v53, v140
    v_max3_f32 v140, v54, v55, v140
    v_max3_f32 v140, v56, v57, v140
    v_max3_f32 v140, v58, v59, v140
    v_max3_f32 v140, v60, v61, v140
    v_max3_f32 v140, v62, v63, v140
    v_max3_f32 v140, v64, v65, v140
    v_max3_f32 v140, v66, v67, v140
    v_max3_f32 v141, v68, v69, v141
    v_max3_f32 v141, v70, v71, v141
    v_max3_f32 v141, v72, v73, v141
    v_max3_f32 v141, v74, v75, v141
    v_max3_f32 v141, v76, v77, v141
    v_max3_f32 v141, v78, v79, v141
    v_max3_f32 v141, v80, v81, v141
    v_max3_f32 v141, v82, v83, v141
    s_add_u32 s44, s44, 2048
    s_cmp_lt_u32 s44, s45
    s_cbranch_scc1 L_k2_mx
    v_mov_b32 v136, v140
    s_nop 1
    v_permlane32_swap_b32 v140, v136
    v_max_f32 v140, v140, v136
    v_mov_b32 v136, v141
    s_nop 1
    v_permlane32_swap_b32 v141, v136
    v_max_f32 v141, v141, v136
    s_lshl_b32 s44, s32, 9
    s_add_u32 s44, s44, 131328
    v_lshlrev_b32 v136, 2, v1
    v_add_u32 v137, s44, v136
    ds_write_b32 v137, v140
    ds_write_b32 v137, v141 offset:256
    s_waitcnt lgkmcnt(0)
    s_barrier
    s_xor_b32 s45, s32, 4
    s_lshl_b32 s45, s45, 9
    s_add_u32 s45, s45, 131328
    v_add_u32 v137, s45, v136
    ds_read_b32 v138, v137
    ds_read_b32 v139, v137 offset:256
    s_waitcnt lgkmcnt(0)
    v_max_f32 v140, v140, v138
    v_max_f32 v141, v141, v139
    v_sub_f32 v132, 0, v140
    v_and_b32 v133, 0xffff0000, v132
    v_sub_f32 v132, v132, v133
    v_and_b32 v134, 0xffff0000, v132
    v_sub_f32 v132, v132, v134
    v_lshrrev_b32 v133, 16, v133
    v_or_b32 v10, v133, v134
    v_lshrrev_b32 v11, 16, v132
    v_cmp_eq_u32 vcc, 0, v251
    s_nop 1
    v_cndmask_b32 v8, 0, v8, vcc
    v_cndmask_b32 v9, 0, v9, vcc
    v_cndmask_b32 v10, 0, v10, vcc
    v_cndmask_b32 v11, 0, v11, vcc
    v_sub_f32 v132, 0, v141
    v_and_b32 v133, 0xffff0000, v132
    v_sub_f32 v132, v132, v133
    v_and_b32 v134, 0xffff0000, v132
    v_sub_f32 v132, v132, v134
    v_lshrrev_b32 v133, 16, v133
    v_or_b32 v18, v133, v134
    v_lshrrev_b32 v19, 16, v132
    v_cmp_eq_u32 vcc, 0, v251
    s_nop 1
    v_cndmask_b32 v16, 0, v16, vcc
    v_cndmask_b32 v17, 0, v17, vcc
    v_cndmask_b32 v18, 0, v18, vcc
    v_cndmask_b32 v19, 0, v19, vcc
    s_add_u32 m0, s40, 0
    s_add_u32 s43, s41, 0
    buffer_load_dwordx4 v252, s[4:7], s43 offen offset:0 lds
    buffer_load_dwordx4 v252, s[4:7], s43 offen offset:1024 lds
    buffer_load_dwordx4 v252, s[4:7], s43 offen offset:2048 lds
    buffer_load_dwordx4 v252, s[4:7], s43 offen offset:3072 lds
    s_add_u32 m0, s40, 4096
    s_add_u32 s43, s41, 4096
    buffer_load_dwordx4 v252, s[4:7], s43 offen offset:0 lds
    buffer_load_dwordx4 v252, s[4:7], s43 offen offset:1024 lds
    buffer_load_dwordx4 v252, s[4:7], s43 offen offset:2048 lds
    buffer_load_dwordx4 v252, s[4:7], s43 offen offset:3072 lds
    s_branch L_k2_main
L_k2_kernel_end:
    s_endpgm
.section .rodata,"a"
.p2align 6
.amdhsa_kernel k2_kernel
  .amdhsa_next_free_vgpr 256
  .amdhsa_next_free_sgpr 102
  .amdhsa_accum_offset 256
  .amdhsa_group_segment_fixed_size 0
  .amdhsa_kernarg_size 96
  .amdhsa_user_sgpr_count 2
  .amdhsa_user_sgpr_kernarg_segment_ptr 1
  .amdhsa_system_sgpr_workgroup_id_x 1
.end_amdhsa_kernel
.text

.globl k3_kernel
.p2align 8
.type k3_kernel,@function
k3_kernel:
    s_cmp_ge_u32 s2, 256
    s_cbranch_scc1 L_k3_kernel_end
    s_load_dwordx16 s[64:79], s[0:1], 0
    s_load_dwordx8 s[80:87], s[0:1], 64
    v_and_b32 v1, 63, v0
    v_lshrrev_b32 v2, 6, v0
    s_nop 0
    v_readfirstlane_b32 s32, v2
    s_nop 3
    s_mov_b32 s53, s32
    s_waitcnt lgkmcnt(0)
    s_and_b32 s36, s2, 7
    s_lshr_b32 s37, s2, 3
    s_and_b32 s38, s37, 3
    s_lshl_b32 s36, s36, 2
    s_add_u32 s36, s36, s38
    s_lshl_b32 s33, s36, 6
    s_lshr_b32 s51, s37, 2
    s_mov_b32 s52, s36
    s_mov_b32 s55, s51
    s_mov_b32 s56, s38
    s_add_u32 s4, s86, 0x400000
    s_addc_u32 s5, s87, 0
    s_mov_b32 s6, 0x280000
    s_mov_b32 s7, 0x20000
    s_add_u32 s8, s86, 0x1200000
    s_addc_u32 s9, s87, 0
    s_mov_b32 s10, 0xc8000
    s_mov_b32 s11, 0x20000
    s_add_u32 s20, s86, 0x700000
    s_addc_u32 s21, s87, 0
    s_mov_b32 s22, 0x280000
    s_mov_b32 s23, 0x20000
    s_mov_b32 s24, s64
    s_mov_b32 s25, s65
    s_mov_b32 s26, 0x280000
    s_mov_b32 s27, 0x20000
    s_add_u32 s28, s86, 0xa00000
    s_addc_u32 s29, s87, 0
    s_mov_b32 s30, 0x20000
    s_mov_b32 s31, 0x20000
    s_mul_i32 s34, s51, 102400
    s_cmp_ge_u32 s32, 4
    s_cbranch_scc1 L_k3_kernel_prod
    s_lshr_b32 s36, s33, 4
    s_mul_i32 s37, s32, 1
    s_add_u32 s36, s36, s37
    s_mul_i32 s36, s36, 20480
    v_lshlrev_b32 v22, 4, v1
    v_add_u32 v2, s36, v22
    v_add_u32 v3, 20480, v2
    v_lshrrev_b32 v22, 5, v1
    v_lshlrev_b32 v22, 4, v22
    v_bfe_u32 v23, v1, 4, 1
    v_lshl_add_u32 v22, v23, 2, v22
    v_bfe_u32 v23, v1, 2, 2
    v_add_u32 v22, v22, v23
    v_mul_u32_u24 v23, 160, v22
    v_and_b32 v24, 3, v1
    v_lshl_add_u32 v8, v24, 3, v23
    v_add_u32 v9, 65536, v8
    v_add_u32 v10, 131072, v8
    v_and_b32 v46, 15, v1
    s_lshl_b32 s36, s32, 4
    s_add_u32 s36, s36, s33
    v_add_u32 v46, s36, v46
    v_lshrrev_b32 v48, 4, v1
    v_mul_u32_u24 v47, 1280, v46
    v_lshl_add_u32 v47, v48, 3, v47
    s_mul_i32 s37, s51, 160
    v_add_u32 v47, s37, v47
    s_lshr_b32 s36, s36, 4
    s_mul_i32 s36, s36, 20480
    v_lshl_add_u32 v49, v1, 4, s36
    s_mul_i32 s36, s51, 5
    s_add_u32 s37, s36, 0
    s_lshr_b32 s38, s37, 1
    s_lshl_b32 s38, s38, 10
    s_and_b32 s37, s37, 1
    s_lshl_b32 s37, s37, 3
    s_add_u32 s56, s38, s37
    s_add_u32 s37, s36, 1
    s_lshr_b32 s38, s37, 1
    s_lshl_b32 s38, s38, 10
    s_and_b32 s37, s37, 1
    s_lshl_b32 s37, s37, 3
    s_add_u32 s57, s38, s37
    s_add_u32 s37, s36, 2
    s_lshr_b32 s38, s37, 1
    s_lshl_b32 s38, s38, 10
    s_and_b32 s37, s37, 1
    s_lshl_b32 s37, s37, 3
    s_add_u32 s58, s38, s37
    s_add_u32 s37, s36, 3
    s_lshr_b32 s38, s37, 1
    s_lshl_b32 s38, s38, 10
    s_and_b32 s37, s37, 1
    s_lshl_b32 s37, s37, 3
    s_add_u32 s59, s38, s37
    s_add_u32 s37, s36, 4
    s_lshr_b32 s38, s37, 1
    s_lshl_b32 s38, s38, 10
    s_and_b32 s37, s37, 1
    s_lshl_b32 s37, s37, 3
    s_add_u32 s60, s38, s37
    buffer_load_dwordx2 v[36:37], v47, s[24:27], 0 offen offset:0
    buffer_load_dwordx2 v[38:39], v47, s[24:27], 0 offen offset:32
    buffer_load_dwordx2 v[40:41], v47, s[24:27], 0 offen offset:64
    buffer_load_dwordx2 v[42:43], v47, s[24:27], 0 offen offset:96
    buffer_load_dwordx2 v[44:45], v47, s[24:27], 0 offen offset:128
    s_mov_b32 s47, 0
    buffer_load_dwordx4 v[92:95], v2, s[4:7], s47 offen
    s_mov_b32 s47, 1024
    buffer_load_dwordx4 v[96:99], v2, s[4:7], s47 offen
    s_mov_b32 s47, 2048
    buffer_load_dwordx4 v[100:103], v2, s[4:7], s47 offen
    s_mov_b32 s47, 3072
    buffer_load_dwordx4 v[104:107], v2, s[4:7], s47 offen
    s_mov_b32 s47, 4096
    buffer_load_dwordx4 v[108:111], v2, s[4:7], s47 offen
    s_mov_b32 s47, 5120
    buffer_load_dwordx4 v[112:115], v2, s[4:7], s47 offen
    s_mov_b32 s47, 6144
    buffer_load_dwordx4 v[116:119], v2, s[4:7], s47 offen
    s_mov_b32 s47, 7168
    buffer_load_dwordx4 v[120:123], v2, s[4:7], s47 offen
    s_barrier
    ds_read_b64_tr_b16 v[52:53], v8 offset:0
    ds_read_b64_tr_b16 v[54:55], v8 offset:1280
    ds_read_b64_tr_b16 v[56:57], v8 offset:32
    ds_read_b64_tr_b16 v[58:59], v8 offset:1312
    ds_read_b64_tr_b16 v[60:61], v8 offset:64
    ds_read_b64_tr_b16 v[62:63], v8 offset:1344
    ds_read_b64_tr_b16 v[64:65], v8 offset:96
    ds_read_b64_tr_b16 v[66:67], v8 offset:1376
    ds_read_b64_tr_b16 v[68:69], v8 offset:128
    ds_read_b64_tr_b16 v[70:71], v8 offset:1408
    ds_read_b64_tr_b16 v[72:73], v8 offset:5120
    ds_read_b64_tr_b16 v[74:75], v8 offset:6400
    ds_read_b64_tr_b16 v[76:77], v8 offset:5152
    ds_read_b64_tr_b16 v[78:79], v8 offset:6432
    ds_read_b64_tr_b16 v[80:81], v8 offset:5184
    ds_read_b64_tr_b16 v[82:83], v8 offset:6464
    ds_read_b64_tr_b16 v[84:85], v8 offset:5216
    ds_read_b64_tr_b16 v[86:87], v8 offset:6496
    ds_read_b64_tr_b16 v[88:89], v8 offset:5248
    ds_read_b64_tr_b16 v[90:91], v8 offset:6528
    s_waitcnt vmcnt(7)
    s_mov_b32 s47, 8192
    buffer_load_dwordx4 v[124:127], v2, s[4:7], s47 offen
    s_waitcnt lgkmcnt(15)
    v_mfma_f32_16x16x32_bf16 v[16:19], v[52:55], v[92:95], 0
    s_barrier
    ds_read_b64_tr_b16 v[52:53], v8 offset:10240
    ds_read_b64_tr_b16 v[54:55], v8 offset:11520
    v_mfma_f32_16x16x32_bf16 v[20:23], v[56:59], v[92:95], 0
    ds_read_b64_tr_b16 v[56:57], v8 offset:10272
    ds_read_b64_tr_b16 v[58:59], v8 offset:11552
    s_waitcnt lgkmcnt(15)
    v_mfma_f32_16x16x32_bf16 v[24:27], v[60:63], v[92:95], 0
    ds_read_b64_tr_b16 v[60:61], v8 offset:10304
    ds_read_b64_tr_b16 v[62:63], v8 offset:11584
    v_mfma_f32_16x16x32_bf16 v[28:31], v[64:67], v[92:95], 0
    ds_read_b64_tr_b16 v[64:65], v8 offset:10336
    ds_read_b64_tr_b16 v[66:67], v8 offset:11616
    s_waitcnt lgkmcnt(15)
    v_mfma_f32_16x16x32_bf16 v[32:35], v[68:71], v[92:95], 0
    ds_read_b64_tr_b16 v[68:69], v8 offset:10368
    ds_read_b64_tr_b16 v[70:71], v8 offset:11648
    s_waitcnt vmcnt(7)
    s_mov_b32 s47, 9216
    buffer_load_dwordx4 v[92:95], v2, s[4:7], s47 offen
    v_mfma_f32_16x16x32_bf16 v[16:19], v[72:75], v[96:99], v[16:19]
    ds_read_b64_tr_b16 v[72:73], v8 offset:15360
    ds_read_b64_tr_b16 v[74:75], v8 offset:16640
    s_waitcnt lgkmcnt(15)
    v_mfma_f32_16x16x32_bf16 v[20:23], v[76:79], v[96:99], v[20:23]
    ds_read_b64_tr_b16 v[76:77], v8 offset:15392
    ds_read_b64_tr_b16 v[78:79], v8 offset:16672
    v_mfma_f32_16x16x32_bf16 v[24:27], v[80:83], v[96:99], v[24:27]
    ds_read_b64_tr_b16 v[80:81], v8 offset:15424
    ds_read_b64_tr_b16 v[82:83], v8 offset:16704
    s_waitcnt lgkmcnt(15)
    v_mfma_f32_16x16x32_bf16 v[28:31], v[84:87], v[96:99], v[28:31]
    ds_read_b64_tr_b16 v[84:85], v8 offset:15456
    ds_read_b64_tr_b16 v[86:87], v8 offset:16736
    v_mfma_f32_16x16x32_bf16 v[32:35], v[88:91], v[96:99], v[32:35]
    ds_read_b64_tr_b16 v[88:89], v8 offset:15488
    ds_read_b64_tr_b16 v[90:91], v8 offset:16768
    s_waitcnt vmcnt(7)
    s_mov_b32 s47, 10240
    buffer_load_dwordx4 v[96:99], v2, s[4:7], s47 offen
    s_waitcnt lgkmcnt(15)
    v_mfma_f32_16x16x32_bf16 v[16:19], v[52:55], v[100:103], v[16:19]
    s_barrier
    ds_read_b64_tr_b16 v[52:53], v8 offset:20480
    ds_read_b64_tr_b16 v[54:55], v8 offset:21760
    v_mfma_f32_16x16x32_bf16 v[20:23], v[56:59], v[100:103], v[20:23]
    ds_read_b64_tr_b16 v[56:57], v8 offset:20512
    ds_read_b64_tr_b16 v[58:59], v8 offset:21792
    s_waitcnt lgkmcnt(15)
    v_mfma_f32_16x16x32_bf16 v[24:27], v[60:63], v[100:103], v[24:27]
    ds_read_b64_tr_b16 v[60:61], v8 offset:20544
    ds_read_b64_tr_b16 v[62:63], v8 offset:21824
    v_mfma_f32_16x16x32_bf16 v[28:31], v[64:67], v[100:103], v[28:31]
    ds_read_b64_tr_b16 v[64:65], v8 offset:20576
    ds_read_b64_tr_b16 v[66:67], v8 offset:21856
    s_waitcnt lgkmcnt(15)
    v_mfma_f32_16x16x32_bf16 v[32:35], v[68:71], v[100:103], v[32:35]
    ds_read_b64_tr_b16 v[68:69], v8 offset:20608
    ds_read_b64_tr_b16 v[70:71], v8 offset:21888
    s_waitcnt vmcnt(7)
    s_mov_b32 s47, 11264
    buffer_load_dwordx4 v[100:103], v2, s[4:7], s47 offen
    v_mfma_f32_16x16x32_bf16 v[16:19], v[72:75], v[104:107], v[16:19]
    ds_read_b64_tr_b16 v[72:73], v8 offset:25600
    ds_read_b64_tr_b16 v[74:75], v8 offset:26880
    s_waitcnt lgkmcnt(15)
    v_mfma_f32_16x16x32_bf16 v[20:23], v[76:79], v[104:107], v[20:23]
    ds_read_b64_tr_b16 v[76:77], v8 offset:25632
    ds_read_b64_tr_b16 v[78:79], v8 offset:26912
    v_mfma_f32_16x16x32_bf16 v[24:27], v[80:83], v[104:107], v[24:27]
    ds_read_b64_tr_b16 v[80:81], v8 offset:25664
    ds_read_b64_tr_b16 v[82:83], v8 offset:26944
    s_waitcnt lgkmcnt(15)
    v_mfma_f32_16x16x32_bf16 v[28:31], v[84:87], v[104:107], v[28:31]
    ds_read_b64_tr_b16 v[84:85], v8 offset:25696
    ds_read_b64_tr_b16 v[86:87], v8 offset:26976
    v_mfma_f32_16x16x32_bf16 v[32:35], v[88:91], v[104:107], v[32:35]
    ds_read_b64_tr_b16 v[88:89], v8 offset:25728
    ds_read_b64_tr_b16 v[90:91], v8 offset:27008
    s_waitcnt vmcnt(7)
    s_mov_b32 s47, 12288
    buffer_load_dwordx4 v[104:107], v2, s[4:7], s47 offen
    s_waitcnt lgkmcnt(15)
    v_mfma_f32_16x16x32_bf16 v[16:19], v[52:55], v[108:111], v[16:19]
    s_barrier
    ds_read_b64_tr_b16 v[52:53], v8 offset:30720
    ds_read_b64_tr_b16 v[54:55], v8 offset:32000
    v_mfma_f32_16x16x32_bf16 v[20:23], v[56:59], v[108:111], v[20:23]
    ds_read_b64_tr_b16 v[56:57], v8 offset:30752
    ds_read_b64_tr_b16 v[58:59], v8 offset:32032
    s_waitcnt lgkmcnt(15)
    v_mfma_f32_16x16x32_bf16 v[24:27], v[60:63], v[108:111], v[24:27]
    ds_read_b64_tr_b16 v[60:61], v8 offset:30784
    ds_read_b64_tr_b16 v[62:63], v8 offset:32064
    v_mfma_f32_16x16x32_bf16 v[28:31], v[64:67], v[108:111], v[28:31]
    ds_read_b64_tr_b16 v[64:65], v8 offset:30816
    ds_read_b64_tr_b16 v[66:67], v8 offset:32096
    s_waitcnt lgkmcnt(15)
    v_mfma_f32_16x16x32_bf16 v[32:35], v[68:71], v[108:111], v[32:35]
    ds_read_b64_tr_b16 v[68:69], v8 offset:30848
    ds_read_b64_tr_b16 v[70:71], v8 offset:32128
    s_waitcnt vmcnt(7)
    s_mov_b32 s47, 13312
    buffer_load_dwordx4 v[108:111], v2, s[4:7], s47 offen
    v_mfma_f32_16x16x32_bf16 v[16:19], v[72:75], v[112:115], v[16:19]
    ds_read_b64_tr_b16 v[72:73], v8 offset:35840
    ds_read_b64_tr_b16 v[74:75], v8 offset:37120
    s_waitcnt lgkmcnt(15)
    v_mfma_f32_16x16x32_bf16 v[20:23], v[76:79], v[112:115], v[20:23]
    ds_read_b64_tr_b16 v[76:77], v8 offset:35872
    ds_read_b64_tr_b16 v[78:79], v8 offset:37152
    v_mfma_f32_16x16x32_bf16 v[24:27], v[80:83], v[112:115], v[24:27]
    ds_read_b64_tr_b16 v[80:81], v8 offset:35904
    ds_read_b64_tr_b16 v[82:83], v8 offset:37184
    s_waitcnt lgkmcnt(15)
    v_mfma_f32_16x16x32_bf16 v[28:31], v[84:87], v[112:115], v[28:31]
    ds_read_b64_tr_b16 v[84:85], v8 offset:35936
    ds_read_b64_tr_b16 v[86:87], v8 offset:37216
    v_mfma_f32_16x16x32_bf16 v[32:35], v[88:91], v[112:115], v[32:35]
    ds_read_b64_tr_b16 v[88:89], v8 offset:35968
    ds_read_b64_tr_b16 v[90:91], v8 offset:37248
    s_waitcnt vmcnt(7)
    s_mov_b32 s47, 14336
    buffer_load_dwordx4 v[112:115], v2, s[4:7], s47 offen
    s_waitcnt lgkmcnt(15)
    v_mfma_f32_16x16x32_bf16 v[16:19], v[52:55], v[116:119], v[16:19]
    s_barrier
    ds_read_b64_tr_b16 v[52:53], v8 offset:40960
    ds_read_b64_tr_b16 v[54:55], v8 offset:42240
    v_mfma_f32_16x16x32_bf16 v[20:23], v[56:59], v[116:119], v[20:23]
    ds_read_b64_tr_b16 v[56:57], v8 offset:40992
    ds_read_b64_tr_b16 v[58:59], v8 offset:42272
    s_waitcnt lgkmcnt(15)
    v_mfma_f32_16x16x32_bf16 v[24:27], v[60:63], v[116:119], v[24:27]
    ds_read_b64_tr_b16 v[60:61], v8 offset:41024
    ds_read_b64_tr_b16 v[62:63], v8 offset:42304
    v_mfma_f32_16x16x32_bf16 v[28:31], v[64:67], v[116:119], v[28:31]
    ds_read_b64_tr_b16 v[64:65], v8 offset:41056
    ds_read_b64_tr_b16 v[66:67], v8 offset:42336
    s_waitcnt lgkmcnt(15)
    v_mfma_f32_16x16x32_bf16 v[32:35], v[68:71], v[116:119], v[32:35]
    ds_read_b64_tr_b16 v[68:69], v8 offset:41088
    ds_read_b64_tr_b16 v[70:71], v8 offset:42368
    s_waitcnt vmcnt(7)
    s_mov_b32 s47, 15360
    buffer_load_dwordx4 v[116:119], v2, s[4:7], s47 offen
    v_mfma_f32_16x16x32_bf16 v[16:19], v[72:75], v[120:123], v[16:19]
    ds_read_b64_tr_b16 v[72:73], v8 offset:46080
    ds_read_b64_tr_b16 v[74:75], v8 offset:47360
    s_waitcnt lgkmcnt(15)
    v_mfma_f32_16x16x32_bf16 v[20:23], v[76:79], v[120:123], v[20:23]
    ds_read_b64_tr_b16 v[76:77], v8 offset:46112
    ds_read_b64_tr_b16 v[78:79], v8 offset:47392
    v_mfma_f32_16x16x32_bf16 v[24:27], v[80:83], v[120:123], v[24:27]
    ds_read_b64_tr_b16 v[80:81], v8 offset:46144
    ds_read_b64_tr_b16 v[82:83], v8 offset:47424
    s_waitcnt lgkmcnt(15)
    v_mfma_f32_16x16x32_bf16 v[28:31], v[84:87], v[120:123], v[28:31]
    ds_read_b64_tr_b16 v[84:85], v8 offset:46176
    ds_read_b64_tr_b16 v[86:87], v8 offset:47456
    v_mfma_f32_16x16x32_bf16 v[32:35], v[88:91], v[120:123], v[32:35]
    ds_read_b64_tr_b16 v[88:89], v8 offset:46208
    ds_read_b64_tr_b16 v[90:91], v8 offset:47488
    s_waitcnt vmcnt(7)
    s_mov_b32 s47, 16384
    buffer_load_dwordx4 v[120:123], v2, s[4:7], s47 offen
    s_waitcnt lgkmcnt(15)
    v_mfma_f32_16x16x32_bf16 v[16:19], v[52:55], v[124:127], v[16:19]
    s_barrier
    ds_read_b64_tr_b16 v[52:53], v8 offset:51200
    ds_read_b64_tr_b16 v[54:55], v8 offset:52480
    v_mfma_f32_16x16x32_bf16 v[20:23], v[56:59], v[124:127], v[20:23]
    ds_read_b64_tr_b16 v[56:57], v8 offset:51232
    ds_read_b64_tr_b16 v[58:59], v8 offset:52512
    s_waitcnt lgkmcnt(15)
    v_mfma_f32_16x16x32_bf16 v[24:27], v[60:63], v[124:127], v[24:27]
    ds_read_b64_tr_b16 v[60:61], v8 offset:51264
    ds_read_b64_tr_b16 v[62:63], v8 offset:52544
    v_mfma_f32_16x16x32_bf16 v[28:31], v[64:67], v[124:127], v[28:31]
    ds_read_b64_tr_b16 v[64:65], v8 offset:51296
    ds_read_b64_tr_b16 v[66:67], v8 offset:52576
    s_waitcnt lgkmcnt(15)
    v_mfma_f32_16x16x32_bf16 v[32:35], v[68:71], v[124:127], v[32:35]
    ds_read_b64_tr_b16 v[68:69], v8 offset:51328
    ds_read_b64_tr_b16 v[70:71], v8 offset:52608
    s_waitcnt vmcnt(7)
    s_mov_b32 s47, 17408
    buffer_load_dwordx4 v[124:127], v2, s[4:7], s47 offen
    v_mfma_f32_16x16x32_bf16 v[16:19], v[72:75], v[92:95], v[16:19]
    ds_read_b64_tr_b16 v[72:73], v8 offset:56320
    ds_read_b64_tr_b16 v[74:75], v8 offset:57600
    s_waitcnt lgkmcnt(15)
    v_mfma_f32_16x16x32_bf16 v[20:23], v[76:79], v[92:95], v[20:23]
    ds_read_b64_tr_b16 v[76:77], v8 offset:56352
    ds_read_b64_tr_b16 v[78:79], v8 offset:57632
    v_mfma_f32_16x16x32_bf16 v[24:27], v[80:83], v[92:95], v[24:27]
    ds_read_b64_tr_b16 v[80:81], v8 offset:56384
    ds_read_b64_tr_b16 v[82:83], v8 offset:57664
    s_waitcnt lgkmcnt(15)
    v_mfma_f32_16x16x32_bf16 v[28:31], v[84:87], v[92:95], v[28:31]
    ds_read_b64_tr_b16 v[84:85], v8 offset:56416
    ds_read_b64_tr_b16 v[86:87], v8 offset:57696
    v_mfma_f32_16x16x32_bf16 v[32:35], v[88:91], v[92:95], v[32:35]
    ds_read_b64_tr_b16 v[88:89], v8 offset:56448
    ds_read_b64_tr_b16 v[90:91], v8 offset:57728
    s_waitcnt vmcnt(7)
    s_mov_b32 s47, 18432
    buffer_load_dwordx4 v[92:95], v2, s[4:7], s47 offen
    s_waitcnt lgkmcnt(15)
    v_mfma_f32_16x16x32_bf16 v[16:19], v[52:55], v[96:99], v[16:19]
    s_barrier
    ds_read_b64_tr_b16 v[52:53], v8 offset:61440
    ds_read_b64_tr_b16 v[54:55], v8 offset:62720
    v_mfma_f32_16x16x32_bf16 v[20:23], v[56:59], v[96:99], v[20:23]
    ds_read_b64_tr_b16 v[56:57], v8 offset:61472
    ds_read_b64_tr_b16 v[58:59], v8 offset:62752
    s_waitcnt lgkmcnt(15)
    v_mfma_f32_16x16x32_bf16 v[24:27], v[60:63], v[96:99], v[24:27]
    ds_read_b64_tr_b16 v[60:61], v8 offset:61504
    ds_read_b64_tr_b16 v[62:63], v8 offset:62784
    v_mfma_f32_16x16x32_bf16 v[28:31], v[64:67], v[96:99], v[28:31]
    ds_read_b64_tr_b16 v[64:65], v8 offset:61536
    ds_read_b64_tr_b16 v[66:67], v8 offset:62816
    s_waitcnt lgkmcnt(15)
    v_mfma_f32_16x16x32_bf16 v[32:35], v[68:71], v[96:99], v[32:35]
    ds_read_b64_tr_b16 v[68:69], v8 offset:61568
    ds_read_b64_tr_b16 v[70:71], v8 offset:62848
    s_waitcnt vmcnt(7)
    s_mov_b32 s47, 19456
    buffer_load_dwordx4 v[96:99], v2, s[4:7], s47 offen
    v_mfma_f32_16x16x32_bf16 v[16:19], v[72:75], v[100:103], v[16:19]
    ds_read_b64_tr_b16 v[72:73], v9 offset:1024
    ds_read_b64_tr_b16 v[74:75], v9 offset:2304
    s_waitcnt lgkmcnt(15)
    v_mfma_f32_16x16x32_bf16 v[20:23], v[76:79], v[100:103], v[20:23]
    ds_read_b64_tr_b16 v[76:77], v9 offset:1056
    ds_read_b64_tr_b16 v[78:79], v9 offset:2336
    v_mfma_f32_16x16x32_bf16 v[24:27], v[80:83], v[100:103], v[24:27]
    ds_read_b64_tr_b16 v[80:81], v9 offset:1088
    ds_read_b64_tr_b16 v[82:83], v9 offset:2368
    s_waitcnt lgkmcnt(15)
    v_mfma_f32_16x16x32_bf16 v[28:31], v[84:87], v[100:103], v[28:31]
    ds_read_b64_tr_b16 v[84:85], v9 offset:1120
    ds_read_b64_tr_b16 v[86:87], v9 offset:2400
    v_mfma_f32_16x16x32_bf16 v[32:35], v[88:91], v[100:103], v[32:35]
    ds_read_b64_tr_b16 v[88:89], v9 offset:1152
    ds_read_b64_tr_b16 v[90:91], v9 offset:2432
    s_waitcnt vmcnt(7)
    s_waitcnt lgkmcnt(15)
    v_mfma_f32_16x16x32_bf16 v[16:19], v[52:55], v[104:107], v[16:19]
    s_barrier
    ds_read_b64_tr_b16 v[52:53], v9 offset:6144
    ds_read_b64_tr_b16 v[54:55], v9 offset:7424
    v_mfma_f32_16x16x32_bf16 v[20:23], v[56:59], v[104:107], v[20:23]
    ds_read_b64_tr_b16 v[56:57], v9 offset:6176
    ds_read_b64_tr_b16 v[58:59], v9 offset:7456
    s_waitcnt lgkmcnt(15)
    v_mfma_f32_16x16x32_bf16 v[24:27], v[60:63], v[104:107], v[24:27]
    ds_read_b64_tr_b16 v[60:61], v9 offset:6208
    ds_read_b64_tr_b16 v[62:63], v9 offset:7488
    v_mfma_f32_16x16x32_bf16 v[28:31], v[64:67], v[104:107], v[28:31]
    ds_read_b64_tr_b16 v[64:65], v9 offset:6240
    ds_read_b64_tr_b16 v[66:67], v9 offset:7520
    s_waitcnt lgkmcnt(15)
    v_mfma_f32_16x16x32_bf16 v[32:35], v[68:71], v[104:107], v[32:35]
    ds_read_b64_tr_b16 v[68:69], v9 offset:6272
    ds_read_b64_tr_b16 v[70:71], v9 offset:7552
    s_waitcnt vmcnt(6)
    v_mfma_f32_16x16x32_bf16 v[16:19], v[72:75], v[108:111], v[16:19]
    ds_read_b64_tr_b16 v[72:73], v9 offset:11264
    ds_read_b64_tr_b16 v[74:75], v9 offset:12544
    s_waitcnt lgkmcnt(15)
    v_mfma_f32_16x16x32_bf16 v[20:23], v[76:79], v[108:111], v[20:23]
    ds_read_b64_tr_b16 v[76:77], v9 offset:11296
    ds_read_b64_tr_b16 v[78:79], v9 offset:12576
    v_mfma_f32_16x16x32_bf16 v[24:27], v[80:83], v[108:111], v[24:27]
    ds_read_b64_tr_b16 v[80:81], v9 offset:11328
    ds_read_b64_tr_b16 v[82:83], v9 offset:12608
    s_waitcnt lgkmcnt(15)
    v_mfma_f32_16x16x32_bf16 v[28:31], v[84:87], v[108:111], v[28:31]
    ds_read_b64_tr_b16 v[84:85], v9 offset:11360
    ds_read_b64_tr_b16 v[86:87], v9 offset:12640
    v_mfma_f32_16x16x32_bf16 v[32:35], v[88:91], v[108:111], v[32:35]
    ds_read_b64_tr_b16 v[88:89], v9 offset:11392
    ds_read_b64_tr_b16 v[90:91], v9 offset:12672
    s_waitcnt vmcnt(5)
    s_waitcnt lgkmcnt(15)
    v_mfma_f32_16x16x32_bf16 v[16:19], v[52:55], v[112:115], v[16:19]
    s_barrier
    ds_read_b64_tr_b16 v[52:53], v9 offset:16384
    ds_read_b64_tr_b16 v[54:55], v9 offset:17664
    v_mfma_f32_16x16x32_bf16 v[20:23], v[56:59], v[112:115], v[20:23]
    ds_read_b64_tr_b16 v[56:57], v9 offset:16416
    ds_read_b64_tr_b16 v[58:59], v9 offset:17696
    s_waitcnt lgkmcnt(15)
    v_mfma_f32_16x16x32_bf16 v[24:27], v[60:63], v[112:115], v[24:27]
    ds_read_b64_tr_b16 v[60:61], v9 offset:16448
    ds_read_b64_tr_b16 v[62:63], v9 offset:17728
    v_mfma_f32_16x16x32_bf16 v[28:31], v[64:67], v[112:115], v[28:31]
    ds_read_b64_tr_b16 v[64:65], v9 offset:16480
    ds_read_b64_tr_b16 v[66:67], v9 offset:17760
    s_waitcnt lgkmcnt(15)
    v_mfma_f32_16x16x32_bf16 v[32:35], v[68:71], v[112:115], v[32:35]
    ds_read_b64_tr_b16 v[68:69], v9 offset:16512
    ds_read_b64_tr_b16 v[70:71], v9 offset:17792
    s_waitcnt vmcnt(4)
    v_mfma_f32_16x16x32_bf16 v[16:19], v[72:75], v[116:119], v[16:19]
    ds_read_b64_tr_b16 v[72:73], v9 offset:21504
    ds_read_b64_tr_b16 v[74:75], v9 offset:22784
    s_waitcnt lgkmcnt(15)
    v_mfma_f32_16x16x32_bf16 v[20:23], v[76:79], v[116:119], v[20:23]
    ds_read_b64_tr_b16 v[76:77], v9 offset:21536
    ds_read_b64_tr_b16 v[78:79], v9 offset:22816
    v_mfma_f32_16x16x32_bf16 v[24:27], v[80:83], v[116:119], v[24:27]
    ds_read_b64_tr_b16 v[80:81], v9 offset:21568
    ds_read_b64_tr_b16 v[82:83], v9 offset:22848
    s_waitcnt lgkmcnt(15)
    v_mfma_f32_16x16x32_bf16 v[28:31], v[84:87], v[116:119], v[28:31]
    ds_read_b64_tr_b16 v[84:85], v9 offset:21600
    ds_read_b64_tr_b16 v[86:87], v9 offset:22880
    v_mfma_f32_16x16x32_bf16 v[32:35], v[88:91], v[116:119], v[32:35]
    ds_read_b64_tr_b16 v[88:89], v9 offset:21632
    ds_read_b64_tr_b16 v[90:91], v9 offset:22912
    s_waitcnt vmcnt(3)
    s_waitcnt lgkmcnt(15)
    v_mfma_f32_16x16x32_bf16 v[16:19], v[52:55], v[120:123], v[16:19]
    s_barrier
    ds_read_b64_tr_b16 v[52:53], v9 offset:26624
    ds_read_b64_tr_b16 v[54:55], v9 offset:27904
    v_mfma_f32_16x16x32_bf16 v[20:23], v[56:59], v[120:123], v[20:23]
    ds_read_b64_tr_b16 v[56:57], v9 offset:26656
    ds_read_b64_tr_b16 v[58:59], v9 offset:27936
    s_waitcnt lgkmcnt(15)
    v_mfma_f32_16x16x32_bf16 v[24:27], v[60:63], v[120:123], v[24:27]
    ds_read_b64_tr_b16 v[60:61], v9 offset:26688
    ds_read_b64_tr_b16 v[62:63], v9 offset:27968
    v_mfma_f32_16x16x32_bf16 v[28:31], v[64:67], v[120:123], v[28:31]
    ds_read_b64_tr_b16 v[64:65], v9 offset:26720
    ds_read_b64_tr_b16 v[66:67], v9 offset:28000
    s_waitcnt lgkmcnt(15)
    v_mfma_f32_16x16x32_bf16 v[32:35], v[68:71], v[120:123], v[32:35]
    ds_read_b64_tr_b16 v[68:69], v9 offset:26752
    ds_read_b64_tr_b16 v[70:71], v9 offset:28032
    s_waitcnt vmcnt(2)
    v_mfma_f32_16x16x32_bf16 v[16:19], v[72:75], v[124:127], v[16:19]
    ds_read_b64_tr_b16 v[72:73], v9 offset:31744
    ds_read_b64_tr_b16 v[74:75], v9 offset:33024
    s_waitcnt lgkmcnt(15)
    v_mfma_f32_16x16x32_bf16 v[20:23], v[76:79], v[124:127], v[20:23]
    ds_read_b64_tr_b16 v[76:77], v9 offset:31776
    ds_read_b64_tr_b16 v[78:79], v9 offset:33056
    v_mfma_f32_16x16x32_bf16 v[24:27], v[80:83], v[124:127], v[24:27]
    ds_read_b64_tr_b16 v[80:81], v9 offset:31808
    ds_read_b64_tr_b16 v[82:83], v9 offset:33088
    s_waitcnt lgkmcnt(15)
    v_mfma_f32_16x16x32_bf16 v[28:31], v[84:87], v[124:127], v[28:31]
    ds_read_b64_tr_b16 v[84:85], v9 offset:31840
    ds_read_b64_tr_b16 v[86:87], v9 offset:33120
    v_mfma_f32_16x16x32_bf16 v[32:35], v[88:91], v[124:127], v[32:35]
    ds_read_b64_tr_b16 v[88:89], v9 offset:31872
    ds_read_b64_tr_b16 v[90:91], v9 offset:33152
    s_waitcnt vmcnt(1)
    s_waitcnt lgkmcnt(15)
    v_mfma_f32_16x16x32_bf16 v[16:19], v[52:55], v[92:95], v[16:19]
    v_mfma_f32_16x16x32_bf16 v[20:23], v[56:59], v[92:95], v[20:23]
    s_waitcnt lgkmcnt(14)
    v_mfma_f32_16x16x32_bf16 v[24:27], v[60:63], v[92:95], v[24:27]
    s_waitcnt lgkmcnt(12)
    v_mfma_f32_16x16x32_bf16 v[28:31], v[64:67], v[92:95], v[28:31]
    s_waitcnt lgkmcnt(10)
    v_mfma_f32_16x16x32_bf16 v[32:35], v[68:71], v[92:95], v[32:35]
    s_waitcnt vmcnt(0)
    s_waitcnt lgkmcnt(8)
    v_mfma_f32_16x16x32_bf16 v[16:19], v[72:75], v[96:99], v[16:19]
    s_waitcnt lgkmcnt(6)
    v_mfma_f32_16x16x32_bf16 v[20:23], v[76:79], v[96:99], v[20:23]
    s_waitcnt lgkmcnt(4)
    v_mfma_f32_16x16x32_bf16 v[24:27], v[80:83], v[96:99], v[24:27]
    s_waitcnt lgkmcnt(2)
    v_mfma_f32_16x16x32_bf16 v[28:31], v[84:87], v[96:99], v[28:31]
    s_waitcnt lgkmcnt(0)
    v_mfma_f32_16x16x32_bf16 v[32:35], v[88:91], v[96:99], v[32:35]
    s_nop 7
    s_waitcnt vmcnt(0)
    v_lshlrev_b32 v128, 16, v36
    v_and_b32 v129, 0xffff0000, v36
    v_add_f32 v16, v16, v128
    v_add_f32 v17, v17, v129
    v_cvt_pk_bf16_f32 v36, v16, v17
    v_lshlrev_b32 v128, 16, v37
    v_and_b32 v129, 0xffff0000, v37
    v_add_f32 v18, v18, v128
    v_add_f32 v19, v19, v129
    v_cvt_pk_bf16_f32 v37, v18, v19
    buffer_store_dwordx2 v[36:37], v49, s[20:23], s56 offen
    v_lshlrev_b32 v128, 16, v38
    v_and_b32 v129, 0xffff0000, v38
    v_add_f32 v20, v20, v128
    v_add_f32 v21, v21, v129
    v_cvt_pk_bf16_f32 v38, v20, v21
    v_lshlrev_b32 v128, 16, v39
    v_and_b32 v129, 0xffff0000, v39
    v_add_f32 v22, v22, v128
    v_add_f32 v23, v23, v129
    v_cvt_pk_bf16_f32 v39, v22, v23
    buffer_store_dwordx2 v[38:39], v49, s[20:23], s57 offen
    v_lshlrev_b32 v128, 16, v40
    v_and_b32 v129, 0xffff0000, v40
    v_add_f32 v24, v24, v128
    v_add_f32 v25, v25, v129
    v_cvt_pk_bf16_f32 v40, v24, v25
    v_lshlrev_b32 v128, 16, v41
    v_and_b32 v129, 0xffff0000, v41
    v_add_f32 v26, v26, v128
    v_add_f32 v27, v27, v129
    v_cvt_pk_bf16_f32 v41, v26, v27
    buffer_store_dwordx2 v[40:41], v49, s[20:23], s58 offen
    v_lshlrev_b32 v128, 16, v42
    v_and_b32 v129, 0xffff0000, v42
    v_add_f32 v28, v28, v128
    v_add_f32 v29, v29, v129
    v_cvt_pk_bf16_f32 v42, v28, v29
    v_lshlrev_b32 v128, 16, v43
    v_and_b32 v129, 0xffff0000, v43
    v_add_f32 v30, v30, v128
    v_add_f32 v31, v31, v129
    v_cvt_pk_bf16_f32 v43, v30, v31
    buffer_store_dwordx2 v[42:43], v49, s[20:23], s59 offen
    v_lshlrev_b32 v128, 16, v44
    v_and_b32 v129, 0xffff0000, v44
    v_add_f32 v32, v32, v128
    v_add_f32 v33, v33, v129
    v_cvt_pk_bf16_f32 v44, v32, v33
    v_lshlrev_b32 v128, 16, v45
    v_and_b32 v129, 0xffff0000, v45
    v_add_f32 v34, v34, v128
    v_add_f32 v35, v35, v129
    v_cvt_pk_bf16_f32 v45, v34, v35
    buffer_store_dwordx2 v[44:45], v49, s[20:23], s60 offen
    v_lshlrev_b32 v16, 16, v36
    v_and_b32 v17, 0xffff0000, v36
    v_lshlrev_b32 v18, 16, v37
    v_and_b32 v19, 0xffff0000, v37
    v_lshlrev_b32 v20, 16, v38
    v_and_b32 v21, 0xffff0000, v38
    v_lshlrev_b32 v22, 16, v39
    v_and_b32 v23, 0xffff0000, v39
    v_lshlrev_b32 v24, 16, v40
    v_and_b32 v25, 0xffff0000, v40
    v_lshlrev_b32 v26, 16, v41
    v_and_b32 v27, 0xffff0000, v41
    v_lshlrev_b32 v28, 16, v42
    v_and_b32 v29, 0xffff0000, v42
    v_lshlrev_b32 v30, 16, v43
    v_and_b32 v31, 0xffff0000, v43
    v_lshlrev_b32 v32, 16, v44
    v_and_b32 v33, 0xffff0000, v44
    v_lshlrev_b32 v34, 16, v45
    v_and_b32 v35, 0xffff0000, v45
    v_add_f32 v128, v16, v17
    v_add_f32 v128, v128, v18
    v_add_f32 v128, v128, v19
    v_add_f32 v128, v128, v20
    v_add_f32 v128, v128, v21
    v_add_f32 v128, v128, v22
    v_add_f32 v128, v128, v23
    v_add_f32 v128, v128, v24
    v_add_f32 v128, v128, v25
    v_add_f32 v128, v128, v26
    v_add_f32 v128, v128, v27
    v_add_f32 v128, v128, v28
    v_add_f32 v128, v128, v29
    v_add_f32 v128, v128, v30
    v_add_f32 v128, v128, v31
    v_add_f32 v128, v128, v32
    v_add_f32 v128, v128, v33
    v_add_f32 v128, v128, v34
    v_add_f32 v128, v128, v35
    ds_swizzle_b32 v131, v128 offset:0x401F
    s_waitcnt lgkmcnt(0)
    v_add_f32 v128, v128, v131
    v_mov_b32 v131, v128
    s_nop 1
    v_permlane32_swap_b32 v128, v131
    v_add_f32 v128, v128, v131
    v_mul_f32 v130, 0x3c4ccccd, v128
    v_sub_f32 v16, v16, v130
    v_mul_f32 v129, v16, v16
    v_sub_f32 v17, v17, v130
    v_fmac_f32 v129, v17, v17
    v_sub_f32 v18, v18, v130
    v_fmac_f32 v129, v18, v18
    v_sub_f32 v19, v19, v130
    v_fmac_f32 v129, v19, v19
    v_sub_f32 v20, v20, v130
    v_fmac_f32 v129, v20, v20
    v_sub_f32 v21, v21, v130
    v_fmac_f32 v129, v21, v21
    v_sub_f32 v22, v22, v130
    v_fmac_f32 v129, v22, v22
    v_sub_f32 v23, v23, v130
    v_fmac_f32 v129, v23, v23
    v_sub_f32 v24, v24, v130
    v_fmac_f32 v129, v24, v24
    v_sub_f32 v25, v25, v130
    v_fmac_f32 v129, v25, v25
    v_sub_f32 v26, v26, v130
    v_fmac_f32 v129, v26, v26
    v_sub_f32 v27, v27, v130
    v_fmac_f32 v129, v27, v27
    v_sub_f32 v28, v28, v130
    v_fmac_f32 v129, v28, v28
    v_sub_f32 v29, v29, v130
    v_fmac_f32 v129, v29, v29
    v_sub_f32 v30, v30, v130
    v_fmac_f32 v129, v30, v30
    v_sub_f32 v31, v31, v130
    v_fmac_f32 v129, v31, v31
    v_sub_f32 v32, v32, v130
    v_fmac_f32 v129, v32, v32
    v_sub_f32 v33, v33, v130
    v_fmac_f32 v129, v33, v33
    v_sub_f32 v34, v34, v130
    v_fmac_f32 v129, v34, v34
    v_sub_f32 v35, v35, v130
    v_fmac_f32 v129, v35, v35
    ds_swizzle_b32 v131, v129 offset:0x401F
    s_waitcnt lgkmcnt(0)
    v_add_f32 v129, v129, v131
    v_mov_b32 v131, v129
    s_nop 1
    v_permlane32_swap_b32 v129, v131
    v_add_f32 v129, v129, v131
    v_lshlrev_b32 v130, 6, v46
    s_lshl_b32 s36, s51, 3
    v_add_u32 v130, s36, v130
    v_cmp_eq_u32 vcc, 0, v48
    s_and_saveexec_b64 s[40:41], vcc
    buffer_store_dwordx2 v[128:129], v130, s[28:31], 0 offen
    s_branch L_k3_kernel_end
L_k3_kernel_prod:
    s_and_b32 s32, s32, 3
    s_mul_i32 s54, s55, 0
    s_mul_i32 s57, s56, 0
    s_add_u32 s54, s54, s57
    s_sub_u32 s57, s54, 10
    s_cmp_ge_u32 s54, 10
    s_cselect_b32 s54, s57, s54
    s_mov_b32 s45, 0
    s_mov_b32 s37, 0
    s_mov_b32 s38, 6554
    s_mov_b32 s39, 10
    s_mov_b32 s41, 160
    s_mov_b32 s42, s34
    s_cmp_ge_u32 s32, 1
    s_cselect_b32 s37, 64, s37
    s_cmp_ge_u32 s32, 2
    s_cselect_b32 s37, 128, s37
    s_cmp_ge_u32 s32, 3
    s_cselect_b32 s37, 192, s37
    v_add_u32 v25, s37, v1
    v_mul_lo_u32 v26, v25, s38
    v_lshrrev_b32 v26, 16, v26
    v_mul_lo_u32 v27, v26, s39
    v_sub_u32 v25, v25, v27
    v_and_b32 v27, 8, v26
    v_lshlrev_b32 v27, 1, v27
    v_and_b32 v2, 16, v26
    v_lshrrev_b32 v2, 1, v2
    v_or_b32 v27, v27, v2
    v_and_b32 v26, 0xe7, v26
    v_or_b32 v26, v26, v27
    v_mul_lo_u32 v26, v26, s41
    v_lshl_add_u32 v26, v25, 4, v26
    v_add_u32 v2, s42, v26
    s_mov_b32 s37, 256
    s_mov_b32 s38, 6554
    s_mov_b32 s39, 10
    s_mov_b32 s41, 160
    s_mov_b32 s42, s34
    s_cmp_ge_u32 s32, 1
    s_cselect_b32 s37, 320, s37
    s_cmp_ge_u32 s32, 2
    s_cselect_b32 s37, 384, s37
    s_cmp_ge_u32 s32, 3
    s_cselect_b32 s37, 448, s37
    v_add_u32 v25, s37, v1
    v_mul_lo_u32 v26, v25, s38
    v_lshrrev_b32 v26, 16, v26
    v_mul_lo_u32 v27, v26, s39
    v_sub_u32 v25, v25, v27
    v_and_b32 v27, 8, v26
    v_lshlrev_b32 v27, 1, v27
    v_and_b32 v3, 16, v26
    v_lshrrev_b32 v3, 1, v3
    v_or_b32 v27, v27, v3
    v_and_b32 v26, 0xe7, v26
    v_or_b32 v26, v26, v27
    v_mul_lo_u32 v26, v26, s41
    v_lshl_add_u32 v26, v25, 4, v26
    v_add_u32 v3, s42, v26
    s_mov_b32 s37, 512
    s_mov_b32 s38, 6554
    s_mov_b32 s39, 10
    s_mov_b32 s41, 160
    s_mov_b32 s42, s34
    s_cmp_ge_u32 s32, 1
    s_cselect_b32 s37, 576, s37
    v_add_u32 v25, s37, v1
    v_mul_lo_u32 v26, v25, s38
    v_lshrrev_b32 v26, 16, v26
    v_mul_lo_u32 v27, v26, s39
    v_sub_u32 v25, v25, v27
    v_and_b32 v27, 8, v26
    v_lshlrev_b32 v27, 1, v27
    v_and_b32 v4, 16, v26
    v_lshrrev_b32 v4, 1, v4
    v_or_b32 v27, v27, v4
    v_and_b32 v26, 0xe7, v26
    v_or_b32 v26, v26, v27
    v_mul_lo_u32 v26, v26, s41
    v_lshl_add_u32 v26, v25, 4, v26
    v_add_u32 v4, s42, v26
    s_mov_b32 s16, s8
    s_mov_b32 s17, s9
    s_mov_b32 s18, s10
    s_mov_b32 s19, s11
    s_mov_b32 s44, 8192
    s_mov_b32 s45, 10240
    s_cmp_ge_u32 s32, 1
    s_cselect_b32 s44, 9216, s44
    s_lshl_b32 s46, s32, 10
    s_cmp_ge_u32 s32, 2
    s_cbranch_scc1 L_k3_kernel_prod1
    s_lshl_b32 s47, s54, 7
    s_mul_i32 s48, s54, 10240
    s_mul_i32 s50, s45, s54
    s_add_u32 s54, s54, 1
    s_cmp_eq_u32 s54, 10
    s_cselect_b32 s54, 0, s54
    s_add_u32 m0, s46, 0
    s_nop 0
    buffer_load_dwordx4 v2, s[8:11], s48 offen lds
    s_add_u32 m0, s46, 4096
    s_nop 0
    buffer_load_dwordx4 v3, s[8:11], s48 offen lds
    s_add_u32 m0, s44, 0
    s_nop 0
    buffer_load_dwordx4 v4, s[16:19], s50 offen lds
    s_lshl_b32 s47, s54, 7
    s_mul_i32 s48, s54, 10240
    s_mul_i32 s50, s45, s54
    s_add_u32 s54, s54, 1
    s_cmp_eq_u32 s54, 10
    s_cselect_b32 s54, 0, s54
    s_add_u32 m0, s46, 10240
    s_nop 0
    buffer_load_dwordx4 v2, s[8:11], s48 offen lds
    s_add_u32 m0, s46, 14336
    s_nop 0
    buffer_load_dwordx4 v3, s[8:11], s48 offen lds
    s_add_u32 m0, s44, 10240
    s_nop 0
    buffer_load_dwordx4 v4, s[16:19], s50 offen lds
    s_lshl_b32 s47, s54, 7
    s_mul_i32 s48, s54, 10240
    s_mul_i32 s50, s45, s54
    s_add_u32 s54, s54, 1
    s_cmp_eq_u32 s54, 10
    s_cselect_b32 s54, 0, s54
    s_add_u32 m0, s46, 20480
    s_nop 0
    buffer_load_dwordx4 v2, s[8:11], s48 offen lds
    s_add_u32 m0, s46, 24576
    s_nop 0
    buffer_load_dwordx4 v3, s[8:11], s48 offen lds
    s_add_u32 m0, s44, 20480
    s_nop 0
    buffer_load_dwordx4 v4, s[16:19], s50 offen lds
    s_lshl_b32 s47, s54, 7
    s_mul_i32 s48, s54, 10240
    s_mul_i32 s50, s45, s54
    s_add_u32 s54, s54, 1
    s_cmp_eq_u32 s54, 10
    s_cselect_b32 s54, 0, s54
    s_add_u32 m0, s46, 30720
    s_nop 0
    buffer_load_dwordx4 v2, s[8:11], s48 offen lds
    s_add_u32 m0, s46, 34816
    s_nop 0
    buffer_load_dwordx4 v3, s[8:11], s48 offen lds
    s_add_u32 m0, s44, 30720
    s_nop 0
    buffer_load_dwordx4 v4, s[16:19], s50 offen lds
    s_waitcnt vmcnt(9)
    s_barrier
    s_lshl_b32 s47, s54, 7
    s_mul_i32 s48, s54, 10240
    s_mul_i32 s50, s45, s54
    s_add_u32 s54, s54, 1
    s_cmp_eq_u32 s54, 10
    s_cselect_b32 s54, 0, s54
    s_add_u32 m0, s46, 40960
    s_nop 0
    buffer_load_dwordx4 v2, s[8:11], s48 offen lds
    s_add_u32 m0, s46, 45056
    s_nop 0
    buffer_load_dwordx4 v3, s[8:11], s48 offen lds
    s_add_u32 m0, s44, 40960
    s_nop 0
    buffer_load_dwordx4 v4, s[16:19], s50 offen lds
    s_waitcnt vmcnt(9)
    s_barrier
    s_lshl_b32 s47, s54, 7
    s_mul_i32 s48, s54, 10240
    s_mul_i32 s50, s45, s54
    s_add_u32 s54, s54, 1
    s_cmp_eq_u32 s54, 10
    s_cselect_b32 s54, 0, s54
    s_add_u32 m0, s46, 51200
    s_nop 0
    buffer_load_dwordx4 v2, s[8:11], s48 offen lds
    s_add_u32 m0, s46, 55296
    s_nop 0
    buffer_load_dwordx4 v3, s[8:11], s48 offen lds
    s_add_u32 m0, s44, 51200
    s_nop 0
    buffer_load_dwordx4 v4, s[16:19], s50 offen lds
    s_waitcnt vmcnt(9)
    s_barrier
    s_lshl_b32 s47, s54, 7
    s_mul_i32 s48, s54, 10240
    s_mul_i32 s50, s45, s54
    s_add_u32 s54, s54, 1
    s_cmp_eq_u32 s54, 10
    s_cselect_b32 s54, 0, s54
    s_add_u32 m0, s46, 61440
    s_nop 0
    buffer_load_dwordx4 v2, s[8:11], s48 offen lds
    s_add_u32 m0, s46, 65536
    s_nop 0
    buffer_load_dwordx4 v3, s[8:11], s48 offen lds
    s_add_u32 m0, s44, 61440
    s_nop 0
    buffer_load_dwordx4 v4, s[16:19], s50 offen lds
    s_waitcnt vmcnt(9)
    s_barrier
    s_lshl_b32 s47, s54, 7
    s_mul_i32 s48, s54, 10240
    s_mul_i32 s50, s45, s54
    s_add_u32 s54, s54, 1
    s_cmp_eq_u32 s54, 10
    s_cselect_b32 s54, 0, s54
    s_add_u32 m0, s46, 71680
    s_nop 0
    buffer_load_dwordx4 v2, s[8:11], s48 offen lds
    s_add_u32 m0, s46, 75776
    s_nop 0
    buffer_load_dwordx4 v3, s[8:11], s48 offen lds
    s_add_u32 m0, s44, 71680
    s_nop 0
    buffer_load_dwordx4 v4, s[16:19], s50 offen lds
    s_waitcnt vmcnt(9)
    s_barrier
    s_lshl_b32 s47, s54, 7
    s_mul_i32 s48, s54, 10240
    s_mul_i32 s50, s45, s54
    s_add_u32 s54, s54, 1
    s_cmp_eq_u32 s54, 10
    s_cselect_b32 s54, 0, s54
    s_add_u32 m0, s46, 81920
    s_nop 0
    buffer_load_dwordx4 v2, s[8:11], s48 offen lds
    s_add_u32 m0, s46, 86016
    s_nop 0
    buffer_load_dwordx4 v3, s[8:11], s48 offen lds
    s_add_u32 m0, s44, 81920
    s_nop 0
    buffer_load_dwordx4 v4, s[16:19], s50 offen lds
    s_waitcnt vmcnt(9)
    s_barrier
    s_lshl_b32 s47, s54, 7
    s_mul_i32 s48, s54, 10240
    s_mul_i32 s50, s45, s54
    s_add_u32 s54, s54, 1
    s_cmp_eq_u32 s54, 10
    s_cselect_b32 s54, 0, s54
    s_add_u32 m0, s46, 92160
    s_nop 0
    buffer_load_dwordx4 v2, s[8:11], s48 offen lds
    s_add_u32 m0, s46, 96256
    s_nop 0
    buffer_load_dwordx4 v3, s[8:11], s48 offen lds
    s_add_u32 m0, s44, 92160
    s_nop 0
    buffer_load_dwordx4 v4, s[16:19], s50 offen lds
    s_waitcnt vmcnt(9)
    s_barrier
    s_waitcnt vmcnt(6)
    s_barrier
    s_waitcnt vmcnt(3)
    s_barrier
    s_waitcnt vmcnt(0)
    s_barrier
    s_branch L_k3_kernel_end
L_k3_kernel_prod1:
    s_lshl_b32 s47, s54, 7
    s_mul_i32 s48, s54, 10240
    s_mul_i32 s50, s45, s54
    s_add_u32 s54, s54, 1
    s_cmp_eq_u32 s54, 10
    s_cselect_b32 s54, 0, s54
    s_add_u32 m0, s46, 0
    s_nop 0
    buffer_load_dwordx4 v2, s[8:11], s48 offen lds
    s_add_u32 m0, s46, 4096
    s_nop 0
    buffer_load_dwordx4 v3, s[8:11], s48 offen lds
    s_lshl_b32 s47, s54, 7
    s_mul_i32 s48, s54, 10240
    s_mul_i32 s50, s45, s54
    s_add_u32 s54, s54, 1
    s_cmp_eq_u32 s54, 10
    s_cselect_b32 s54, 0, s54
    s_add_u32 m0, s46, 10240
    s_nop 0
    buffer_load_dwordx4 v2, s[8:11], s48 offen lds
    s_add_u32 m0, s46, 14336
    s_nop 0
    buffer_load_dwordx4 v3, s[8:11], s48 offen lds
    s_lshl_b32 s47, s54, 7
    s_mul_i32 s48, s54, 10240
    s_mul_i32 s50, s45, s54
    s_add_u32 s54, s54, 1
    s_cmp_eq_u32 s54, 10
    s_cselect_b32 s54, 0, s54
    s_add_u32 m0, s46, 20480
    s_nop 0
    buffer_load_dwordx4 v2, s[8:11], s48 offen lds
    s_add_u32 m0, s46, 24576
    s_nop 0
    buffer_load_dwordx4 v3, s[8:11], s48 offen lds
    s_lshl_b32 s47, s54, 7
    s_mul_i32 s48, s54, 10240
    s_mul_i32 s50, s45, s54
    s_add_u32 s54, s54, 1
    s_cmp_eq_u32 s54, 10
    s_cselect_b32 s54, 0, s54
    s_add_u32 m0, s46, 30720
    s_nop 0
    buffer_load_dwordx4 v2, s[8:11], s48 offen lds
    s_add_u32 m0, s46, 34816
    s_nop 0
    buffer_load_dwordx4 v3, s[8:11], s48 offen lds
    s_waitcnt vmcnt(6)
    s_barrier
    s_lshl_b32 s47, s54, 7
    s_mul_i32 s48, s54, 10240
    s_mul_i32 s50, s45, s54
    s_add_u32 s54, s54, 1
    s_cmp_eq_u32 s54, 10
    s_cselect_b32 s54, 0, s54
    s_add_u32 m0, s46, 40960
    s_nop 0
    buffer_load_dwordx4 v2, s[8:11], s48 offen lds
    s_add_u32 m0, s46, 45056
    s_nop 0
    buffer_load_dwordx4 v3, s[8:11], s48 offen lds
    s_waitcnt vmcnt(6)
    s_barrier
    s_lshl_b32 s47, s54, 7
    s_mul_i32 s48, s54, 10240
    s_mul_i32 s50, s45, s54
    s_add_u32 s54, s54, 1
    s_cmp_eq_u32 s54, 10
    s_cselect_b32 s54, 0, s54
    s_add_u32 m0, s46, 51200
    s_nop 0
    buffer_load_dwordx4 v2, s[8:11], s48 offen lds
    s_add_u32 m0, s46, 55296
    s_nop 0
    buffer_load_dwordx4 v3, s[8:11], s48 offen lds
    s_waitcnt vmcnt(6)
    s_barrier
    s_lshl_b32 s47, s54, 7
    s_mul_i32 s48, s54, 10240
    s_mul_i32 s50, s45, s54
    s_add_u32 s54, s54, 1
    s_cmp_eq_u32 s54, 10
    s_cselect_b32 s54, 0, s54
    s_add_u32 m0, s46, 61440
    s_nop 0
    buffer_load_dwordx4 v2, s[8:11], s48 offen lds
    s_add_u32 m0, s46, 65536
    s_nop 0
    buffer_load_dwordx4 v3, s[8:11], s48 offen lds
    s_waitcnt vmcnt(6)
    s_barrier
    s_lshl_b32 s47, s54, 7
    s_mul_i32 s48, s54, 10240
    s_mul_i32 s50, s45, s54
    s_add_u32 s54, s54, 1
    s_cmp_eq_u32 s54, 10
    s_cselect_b32 s54, 0, s54
    s_add_u32 m0, s46, 71680
    s_nop 0
    buffer_load_dwordx4 v2, s[8:11], s48 offen lds
    s_add_u32 m0, s46, 75776
    s_nop 0
    buffer_load_dwordx4 v3, s[8:11], s48 offen lds
    s_waitcnt vmcnt(6)
    s_barrier
    s_lshl_b32 s47, s54, 7
    s_mul_i32 s48, s54, 10240
    s_mul_i32 s50, s45, s54
    s_add_u32 s54, s54, 1
    s_cmp_eq_u32 s54, 10
    s_cselect_b32 s54, 0, s54
    s_add_u32 m0, s46, 81920
    s_nop 0
    buffer_load_dwordx4 v2, s[8:11], s48 offen lds
    s_add_u32 m0, s46, 86016
    s_nop 0
    buffer_load_dwordx4 v3, s[8:11], s48 offen lds
    s_waitcnt vmcnt(6)
    s_barrier
    s_lshl_b32 s47, s54, 7
    s_mul_i32 s48, s54, 10240
    s_mul_i32 s50, s45, s54
    s_add_u32 s54, s54, 1
    s_cmp_eq_u32 s54, 10
    s_cselect_b32 s54, 0, s54
    s_add_u32 m0, s46, 92160
    s_nop 0
    buffer_load_dwordx4 v2, s[8:11], s48 offen lds
    s_add_u32 m0, s46, 96256
    s_nop 0
    buffer_load_dwordx4 v3, s[8:11], s48 offen lds
    s_waitcnt vmcnt(6)
    s_barrier
    s_waitcnt vmcnt(4)
    s_barrier
    s_waitcnt vmcnt(2)
    s_barrier
    s_waitcnt vmcnt(0)
    s_barrier
    s_branch L_k3_kernel_end
L_k3_kernel_end:
    s_endpgm
.section .rodata,"a"
.p2align 6
.amdhsa_kernel k3_kernel
  .amdhsa_next_free_vgpr 136
  .amdhsa_next_free_sgpr 102
  .amdhsa_accum_offset 136
  .amdhsa_group_segment_fixed_size 0
  .amdhsa_kernarg_size 96
  .amdhsa_user_sgpr_count 2
  .amdhsa_user_sgpr_kernarg_segment_ptr 1
  .amdhsa_system_sgpr_workgroup_id_x 1
.end_amdhsa_kernel
.text

.globl k4_kernel
.p2align 8
.type k4_kernel,@function
k4_kernel:
    s_cmp_ge_u32 s2, 256
    s_cbranch_scc1 L_k4_kernel_end
    s_load_dwordx16 s[64:79], s[0:1], 0
    s_load_dwordx8 s[80:87], s[0:1], 64
    v_and_b32 v1, 63, v0
    v_lshrrev_b32 v2, 6, v0
    s_nop 0
    v_readfirstlane_b32 s32, v2
    s_nop 3
    s_mov_b32 s53, s32
    s_waitcnt lgkmcnt(0)
    s_and_b32 s36, s2, 7
    s_lshr_b32 s37, s2, 3
    s_and_b32 s38, s36, 1
    s_lshl_b32 s38, s38, 3
    s_and_b32 s39, s37, 7
    s_add_u32 s38, s38, s39
    s_lshl_b32 s33, s38, 7
    s_lshr_b32 s36, s36, 1
    s_lshl_b32 s36, s36, 2
    s_lshr_b32 s37, s37, 3
    s_add_u32 s51, s36, s37
    s_add_u32 s4, s86, 0x700000
    s_addc_u32 s5, s87, 0
    s_mov_b32 s6, 0x280000
    s_mov_b32 s7, 0x20000
    s_add_u32 s8, s86, 0x1520000
    s_addc_u32 s9, s87, 0
    s_mov_b32 s10, 0x230000
    s_mov_b32 s11, 0x20000
    s_add_u32 s12, s86, 0x1750000
    s_addc_u32 s13, s87, 0
    s_mov_b32 s14, 0x230000
    s_mov_b32 s15, 0x20000
    s_add_u32 s20, s86, 0xb00000
    s_addc_u32 s21, s87, 0
    s_mov_b32 s22, 0x6c0000
    s_mov_b32 s23, 0x20000
    s_add_u32 s24, s86, 0xa00000
    s_addc_u32 s25, s87, 0
    s_mov_b32 s26, 0x20000
    s_mov_b32 s27, 0x20000
    s_add_u32 s28, s86, 0x390000
    s_addc_u32 s29, s87, 0
    s_mov_b32 s30, 0x3600
    s_mov_b32 s31, 0x20000
    s_mul_i32 s34, s51, 143360
    s_mov_b32 s35, s34
    s_mov_b32 s55, s39
    s_mov_b32 s56, s37
    s_cmp_ge_u32 s32, 4
    s_cbranch_scc1 L_k4_kernel_prod
    v_and_b32 v2, 15, v1
    s_lshl_b32 s36, s32, 5
    s_add_u32 s36, s36, s33
    v_add_u32 v2, s36, v2
    v_add_u32 v3, 16, v2
    v_lshrrev_b32 v4, 4, v1
    v_lshlrev_b32 v9, 6, v2
    buffer_load_dwordx4 v[200:203], v9, s[24:27], 0 offen offset:0
    buffer_load_dwordx4 v[204:207], v9, s[24:27], 0 offen offset:16
    buffer_load_dwordx4 v[208:211], v9, s[24:27], 0 offen offset:32
    buffer_load_dwordx4 v[212:215], v9, s[24:27], 0 offen offset:48
    v_lshlrev_b32 v9, 6, v3
    buffer_load_dwordx4 v[216:219], v9, s[24:27], 0 offen offset:0
    buffer_load_dwordx4 v[220:223], v9, s[24:27], 0 offen offset:16
    buffer_load_dwordx4 v[224:227], v9, s[24:27], 0 offen offset:32
    buffer_load_dwordx4 v[228:231], v9, s[24:27], 0 offen offset:48
    s_mul_i32 s36, s51, 448
    v_lshlrev_b32 v9, 2, v0
    v_add_u32 v240, s36, v9
    v_add_u32 v241, 6464, v240
    v_cmp_gt_u32 vcc, 112, v0
    s_nop 1
    v_cndmask_b32 v240, v241, v240, vcc
    buffer_load_dword v241, v240, s[28:31], 0 offen
    v_add_u32 v240, 143360, v9
    s_lshr_b32 s36, s33, 4
    s_mul_i32 s37, s32, 2
    s_add_u32 s36, s36, s37
    s_mul_i32 s36, s36, 20480
    v_lshlrev_b32 v30, 4, v1
    v_add_u32 v10, s36, v30
    v_add_u32 v11, 20480, v10
    v_lshrrev_b32 v30, 5, v1
    v_lshlrev_b32 v30, 4, v30
    v_bfe_u32 v31, v1, 4, 1
    v_lshl_add_u32 v30, v31, 2, v30
    v_bfe_u32 v31, v1, 2, 2
    v_add_u32 v30, v30, v31
    v_mul_u32_u24 v31, 224, v30
    v_and_b32 v32, 3, v1
    v_lshl_add_u32 v16, v32, 3, v31
    v_add_u32 v17, 65536, v16
    v_add_u32 v18, 131072, v16
    v_mul_u32_u24 v31, 224, v30
    v_and_b32 v32, 3, v1
    v_lshl_add_u32 v19, v32, 3, v31
    v_add_u32 v20, 65536, v19
    v_add_u32 v21, 131072, v19
    s_waitcnt vmcnt(0)
    ds_write_b32 v240, v241
    v_add_f32 v232, v200, v202
    v_add_f32 v232, v232, v204
    v_add_f32 v232, v232, v206
    v_add_f32 v232, v232, v208
    v_add_f32 v232, v232, v210
    v_add_f32 v232, v232, v212
    v_add_f32 v232, v232, v214
    v_mul_f32 v5, 0x3acccccd, v232
    v_add_f32 v233, v201, v203
    v_add_f32 v233, v233, v205
    v_add_f32 v233, v233, v207
    v_add_f32 v233, v233, v209
    v_add_f32 v233, v233, v211
    v_add_f32 v233, v233, v213
    v_add_f32 v233, v233, v215
    v_mov_b32 v235, 0x3c4ccccd
    v_mov_b32 v236, 0x42a00000
    v_fma_f32 v234, v200, v235, -v5
    v_mul_f32 v234, v234, v234
    v_fmac_f32 v233, v234, v236
    v_fma_f32 v234, v202, v235, -v5
    v_mul_f32 v234, v234, v234
    v_fmac_f32 v233, v234, v236
    v_fma_f32 v234, v204, v235, -v5
    v_mul_f32 v234, v234, v234
    v_fmac_f32 v233, v234, v236
    v_fma_f32 v234, v206, v235, -v5
    v_mul_f32 v234, v234, v234
    v_fmac_f32 v233, v234, v236
    v_fma_f32 v234, v208, v235, -v5
    v_mul_f32 v234, v234, v234
    v_fmac_f32 v233, v234, v236
    v_fma_f32 v234, v210, v235, -v5
    v_mul_f32 v234, v234, v234
    v_fmac_f32 v233, v234, v236
    v_fma_f32 v234, v212, v235, -v5
    v_mul_f32 v234, v234, v234
    v_fmac_f32 v233, v234, v236
    v_fma_f32 v234, v214, v235, -v5
    v_mul_f32 v234, v234, v234
    v_fmac_f32 v233, v234, v236
    v_mul_f32 v233, 0x3acccccd, v233
    v_cvt_pk_bf16_f32 v233, v233, v233
    v_lshlrev_b32 v233, 16, v233
    v_add_f32 v233, 0x3727c5ac, v233
    v_cvt_pk_bf16_f32 v233, v233, v233
    v_lshlrev_b32 v233, 16, v233
    v_sqrt_f32 v233, v233
    v_cvt_pk_bf16_f32 v5, v5, v5
    v_lshlrev_b32 v5, 16, v5
    v_cvt_pk_bf16_f32 v233, v233, v233
    v_lshlrev_b32 v233, 16, v233
    v_mul_f32 v233, v233, v233
    v_rcp_f32 v7, v233
    v_add_f32 v232, v216, v218
    v_add_f32 v232, v232, v220
    v_add_f32 v232, v232, v222
    v_add_f32 v232, v232, v224
    v_add_f32 v232, v232, v226
    v_add_f32 v232, v232, v228
    v_add_f32 v232, v232, v230
    v_mul_f32 v6, 0x3acccccd, v232
    v_add_f32 v233, v217, v219
    v_add_f32 v233, v233, v221
    v_add_f32 v233, v233, v223
    v_add_f32 v233, v233, v225
    v_add_f32 v233, v233, v227
    v_add_f32 v233, v233, v229
    v_add_f32 v233, v233, v231
    v_mov_b32 v235, 0x3c4ccccd
    v_mov_b32 v236, 0x42a00000
    v_fma_f32 v234, v216, v235, -v6
    v_mul_f32 v234, v234, v234
    v_fmac_f32 v233, v234, v236
    v_fma_f32 v234, v218, v235, -v6
    v_mul_f32 v234, v234, v234
    v_fmac_f32 v233, v234, v236
    v_fma_f32 v234, v220, v235, -v6
    v_mul_f32 v234, v234, v234
    v_fmac_f32 v233, v234, v236
    v_fma_f32 v234, v222, v235, -v6
    v_mul_f32 v234, v234, v234
    v_fmac_f32 v233, v234, v236
    v_fma_f32 v234, v224, v235, -v6
    v_mul_f32 v234, v234, v234
    v_fmac_f32 v233, v234, v236
    v_fma_f32 v234, v226, v235, -v6
    v_mul_f32 v234, v234, v234
    v_fmac_f32 v233, v234, v236
    v_fma_f32 v234, v228, v235, -v6
    v_mul_f32 v234, v234, v234
    v_fmac_f32 v233, v234, v236
    v_fma_f32 v234, v230, v235, -v6
    v_mul_f32 v234, v234, v234
    v_fmac_f32 v233, v234, v236
    v_mul_f32 v233, 0x3acccccd, v233
    v_cvt_pk_bf16_f32 v233, v233, v233
    v_lshlrev_b32 v233, 16, v233
    v_add_f32 v233, 0x3727c5ac, v233
    v_cvt_pk_bf16_f32 v233, v233, v233
    v_lshlrev_b32 v233, 16, v233
    v_sqrt_f32 v233, v233
    v_cvt_pk_bf16_f32 v6, v6, v6
    v_lshlrev_b32 v6, 16, v6
    v_cvt_pk_bf16_f32 v233, v233, v233
    v_lshlrev_b32 v233, 16, v233
    v_mul_f32 v233, v233, v233
    v_rcp_f32 v8, v233
    s_mov_b32 s47, 0
    buffer_load_dwordx4 v[192:195], v10, s[4:7], s47 offen
    buffer_load_dwordx4 v[196:199], v11, s[4:7], s47 offen
    s_mov_b32 s47, 1024
    buffer_load_dwordx4 v[200:203], v10, s[4:7], s47 offen
    buffer_load_dwordx4 v[204:207], v11, s[4:7], s47 offen
    s_mov_b32 s47, 2048
    buffer_load_dwordx4 v[208:211], v10, s[4:7], s47 offen
    buffer_load_dwordx4 v[212:215], v11, s[4:7], s47 offen
    s_mov_b32 s47, 3072
    buffer_load_dwordx4 v[216:219], v10, s[4:7], s47 offen
    buffer_load_dwordx4 v[220:223], v11, s[4:7], s47 offen
    s_waitcnt lgkmcnt(0)
    s_barrier
    ds_read_b64_tr_b16 v[136:137], v16 offset:0
    ds_read_b64_tr_b16 v[138:139], v16 offset:1792
    ds_read_b64_tr_b16 v[140:141], v16 offset:32
    ds_read_b64_tr_b16 v[142:143], v16 offset:1824
    ds_read_b64_tr_b16 v[144:145], v16 offset:64
    ds_read_b64_tr_b16 v[146:147], v16 offset:1856
    ds_read_b64_tr_b16 v[148:149], v16 offset:96
    ds_read_b64_tr_b16 v[150:151], v16 offset:1888
    ds_read_b64_tr_b16 v[152:153], v16 offset:128
    ds_read_b64_tr_b16 v[154:155], v16 offset:1920
    ds_read_b64_tr_b16 v[156:157], v16 offset:160
    ds_read_b64_tr_b16 v[158:159], v16 offset:1952
    ds_read_b64_tr_b16 v[160:161], v16 offset:192
    ds_read_b64_tr_b16 v[162:163], v16 offset:1984
    ds_read_b64_tr_b16 v[164:165], v19 offset:14336
    ds_read_b64_tr_b16 v[166:167], v19 offset:16128
    ds_read_b64_tr_b16 v[168:169], v19 offset:14368
    ds_read_b64_tr_b16 v[170:171], v19 offset:16160
    ds_read_b64_tr_b16 v[172:173], v19 offset:14400
    ds_read_b64_tr_b16 v[174:175], v19 offset:16192
    ds_read_b64_tr_b16 v[176:177], v19 offset:14432
    ds_read_b64_tr_b16 v[178:179], v19 offset:16224
    ds_read_b64_tr_b16 v[180:181], v19 offset:14464
    ds_read_b64_tr_b16 v[182:183], v19 offset:16256
    ds_read_b64_tr_b16 v[184:185], v19 offset:14496
    ds_read_b64_tr_b16 v[186:187], v19 offset:16288
    ds_read_b64_tr_b16 v[188:189], v19 offset:14528
    ds_read_b64_tr_b16 v[190:191], v19 offset:16320
    s_waitcnt vmcnt(6)
    s_mov_b32 s47, 4096
    buffer_load_dwordx4 v[224:227], v10, s[4:7], s47 offen
    buffer_load_dwordx4 v[228:231], v11, s[4:7], s47 offen
    s_waitcnt lgkmcnt(15)
    v_mfma_f32_16x16x32_bf16 v[24:27], v[136:139], v[192:195], 0
    v_mfma_f32_16x16x32_bf16 v[80:83], v[136:139], v[196:199], 0
    ds_read_b64_tr_b16 v[136:137], v16 offset:7168
    ds_read_b64_tr_b16 v[138:139], v16 offset:8960
    v_mfma_f32_16x16x32_bf16 v[28:31], v[140:143], v[192:195], 0
    v_mfma_f32_16x16x32_bf16 v[84:87], v[140:143], v[196:199], 0
    ds_read_b64_tr_b16 v[140:141], v16 offset:7200
    ds_read_b64_tr_b16 v[142:143], v16 offset:8992
    v_mfma_f32_16x16x32_bf16 v[32:35], v[144:147], v[192:195], 0
    v_mfma_f32_16x16x32_bf16 v[88:91], v[144:147], v[196:199], 0
    ds_read_b64_tr_b16 v[144:145], v16 offset:7232
    ds_read_b64_tr_b16 v[146:147], v16 offset:9024
    v_mfma_f32_16x16x32_bf16 v[36:39], v[148:151], v[192:195], 0
    v_mfma_f32_16x16x32_bf16 v[92:95], v[148:151], v[196:199], 0
    ds_read_b64_tr_b16 v[148:149], v16 offset:7264
    ds_read_b64_tr_b16 v[150:151], v16 offset:9056
    v_mfma_f32_16x16x32_bf16 v[40:43], v[152:155], v[192:195], 0
    v_mfma_f32_16x16x32_bf16 v[96:99], v[152:155], v[196:199], 0
    ds_read_b64_tr_b16 v[152:153], v16 offset:7296
    ds_read_b64_tr_b16 v[154:155], v16 offset:9088
    v_mfma_f32_16x16x32_bf16 v[44:47], v[156:159], v[192:195], 0
    v_mfma_f32_16x16x32_bf16 v[100:103], v[156:159], v[196:199], 0
    ds_read_b64_tr_b16 v[156:157], v16 offset:7328
    ds_read_b64_tr_b16 v[158:159], v16 offset:9120
    s_waitcnt lgkmcnt(15)
    v_mfma_f32_16x16x32_bf16 v[48:51], v[160:163], v[192:195], 0
    v_mfma_f32_16x16x32_bf16 v[104:107], v[160:163], v[196:199], 0
    ds_read_b64_tr_b16 v[160:161], v16 offset:7360
    ds_read_b64_tr_b16 v[162:163], v16 offset:9152
    v_mfma_f32_16x16x32_bf16 v[52:55], v[164:167], v[192:195], 0
    v_mfma_f32_16x16x32_bf16 v[108:111], v[164:167], v[196:199], 0
    ds_read_b64_tr_b16 v[164:165], v19 offset:21504
    ds_read_b64_tr_b16 v[166:167], v19 offset:23296
    v_mfma_f32_16x16x32_bf16 v[56:59], v[168:171], v[192:195], 0
    v_mfma_f32_16x16x32_bf16 v[112:115], v[168:171], v[196:199], 0
    ds_read_b64_tr_b16 v[168:169], v19 offset:21536
    ds_read_b64_tr_b16 v[170:171], v19 offset:23328
    v_mfma_f32_16x16x32_bf16 v[60:63], v[172:175], v[192:195], 0
    v_mfma_f32_16x16x32_bf16 v[116:119], v[172:175], v[196:199], 0
    ds_read_b64_tr_b16 v[172:173], v19 offset:21568
    ds_read_b64_tr_b16 v[174:175], v19 offset:23360
    v_mfma_f32_16x16x32_bf16 v[64:67], v[176:179], v[192:195], 0
    v_mfma_f32_16x16x32_bf16 v[120:123], v[176:179], v[196:199], 0
    ds_read_b64_tr_b16 v[176:177], v19 offset:21600
    ds_read_b64_tr_b16 v[178:179], v19 offset:23392
    v_mfma_f32_16x16x32_bf16 v[68:71], v[180:183], v[192:195], 0
    v_mfma_f32_16x16x32_bf16 v[124:127], v[180:183], v[196:199], 0
    ds_read_b64_tr_b16 v[180:181], v19 offset:21632
    ds_read_b64_tr_b16 v[182:183], v19 offset:23424
    s_waitcnt lgkmcnt(15)
    v_mfma_f32_16x16x32_bf16 v[72:75], v[184:187], v[192:195], 0
    v_mfma_f32_16x16x32_bf16 v[128:131], v[184:187], v[196:199], 0
    ds_read_b64_tr_b16 v[184:185], v19 offset:21664
    ds_read_b64_tr_b16 v[186:187], v19 offset:23456
    v_mfma_f32_16x16x32_bf16 v[76:79], v[188:191], v[192:195], 0
    v_mfma_f32_16x16x32_bf16 v[132:135], v[188:191], v[196:199], 0
    ds_read_b64_tr_b16 v[188:189], v19 offset:21696
    ds_read_b64_tr_b16 v[190:191], v19 offset:23488
    s_waitcnt vmcnt(6)
    s_mov_b32 s47, 5120
    buffer_load_dwordx4 v[192:195], v10, s[4:7], s47 offen
    buffer_load_dwordx4 v[196:199], v11, s[4:7], s47 offen
    v_mfma_f32_16x16x32_bf16 v[24:27], v[136:139], v[200:203], v[24:27]
    v_mfma_f32_16x16x32_bf16 v[80:83], v[136:139], v[204:207], v[80:83]
    v_mfma_f32_16x16x32_bf16 v[28:31], v[140:143], v[200:203], v[28:31]
    v_mfma_f32_16x16x32_bf16 v[84:87], v[140:143], v[204:207], v[84:87]
    v_mfma_f32_16x16x32_bf16 v[32:35], v[144:147], v[200:203], v[32:35]
    v_mfma_f32_16x16x32_bf16 v[88:91], v[144:147], v[204:207], v[88:91]
    v_mfma_f32_16x16x32_bf16 v[36:39], v[148:151], v[200:203], v[36:39]
    v_mfma_f32_16x16x32_bf16 v[92:95], v[148:151], v[204:207], v[92:95]
    s_waitcnt lgkmcnt(15)
    v_mfma_f32_16x16x32_bf16 v[40:43], v[152:155], v[200:203], v[40:43]
    v_mfma_f32_16x16x32_bf16 v[96:99], v[152:155], v[204:207], v[96:99]
    s_waitcnt lgkmcnt(0)
    s_barrier
    ds_read_b64_tr_b16 v[136:137], v16 offset:28672
    ds_read_b64_tr_b16 v[138:139], v16 offset:30464
    ds_read_b64_tr_b16 v[140:141], v16 offset:28704
    ds_read_b64_tr_b16 v[142:143], v16 offset:30496
    ds_read_b64_tr_b16 v[144:145], v16 offset:28736
    ds_read_b64_tr_b16 v[146:147], v16 offset:30528
    ds_read_b64_tr_b16 v[148:149], v16 offset:28768
    ds_read_b64_tr_b16 v[150:151], v16 offset:30560
    ds_read_b64_tr_b16 v[152:153], v16 offset:28800
    ds_read_b64_tr_b16 v[154:155], v16 offset:30592
    v_mfma_f32_16x16x32_bf16 v[44:47], v[156:159], v[200:203], v[44:47]
    v_mfma_f32_16x16x32_bf16 v[100:103], v[156:159], v[204:207], v[100:103]
    ds_read_b64_tr_b16 v[156:157], v16 offset:28832
    ds_read_b64_tr_b16 v[158:159], v16 offset:30624
    v_mfma_f32_16x16x32_bf16 v[48:51], v[160:163], v[200:203], v[48:51]
    v_mfma_f32_16x16x32_bf16 v[104:107], v[160:163], v[204:207], v[104:107]
    ds_read_b64_tr_b16 v[160:161], v16 offset:28864
    ds_read_b64_tr_b16 v[162:163], v16 offset:30656
    v_mfma_f32_16x16x32_bf16 v[52:55], v[164:167], v[200:203], v[52:55]
    v_mfma_f32_16x16x32_bf16 v[108:111], v[164:167], v[204:207], v[108:111]
    ds_read_b64_tr_b16 v[164:165], v19 offset:43008
    ds_read_b64_tr_b16 v[166:167], v19 offset:44800
    v_mfma_f32_16x16x32_bf16 v[56:59], v[168:171], v[200:203], v[56:59]
    v_mfma_f32_16x16x32_bf16 v[112:115], v[168:171], v[204:207], v[112:115]
    ds_read_b64_tr_b16 v[168:169], v19 offset:43040
    ds_read_b64_tr_b16 v[170:171], v19 offset:44832
    v_mfma_f32_16x16x32_bf16 v[60:63], v[172:175], v[200:203], v[60:63]
    v_mfma_f32_16x16x32_bf16 v[116:119], v[172:175], v[204:207], v[116:119]
    ds_read_b64_tr_b16 v[172:173], v19 offset:43072
    ds_read_b64_tr_b16 v[174:175], v19 offset:44864
    v_mfma_f32_16x16x32_bf16 v[64:67], v[176:179], v[200:203], v[64:67]
    v_mfma_f32_16x16x32_bf16 v[120:123], v[176:179], v[204:207], v[120:123]
    ds_read_b64_tr_b16 v[176:177], v19 offset:43104
    ds_read_b64_tr_b16 v[178:179], v19 offset:44896
    v_mfma_f32_16x16x32_bf16 v[68:71], v[180:183], v[200:203], v[68:71]
    v_mfma_f32_16x16x32_bf16 v[124:127], v[180:183], v[204:207], v[124:127]
    ds_read_b64_tr_b16 v[180:181], v19 offset:43136
    ds_read_b64_tr_b16 v[182:183], v19 offset:44928
    v_mfma_f32_16x16x32_bf16 v[72:75], v[184:187], v[200:203], v[72:75]
    v_mfma_f32_16x16x32_bf16 v[128:131], v[184:187], v[204:207], v[128:131]
    ds_read_b64_tr_b16 v[184:185], v19 offset:43168
    ds_read_b64_tr_b16 v[186:187], v19 offset:44960
    v_mfma_f32_16x16x32_bf16 v[76:79], v[188:191], v[200:203], v[76:79]
    v_mfma_f32_16x16x32_bf16 v[132:135], v[188:191], v[204:207], v[132:135]
    ds_read_b64_tr_b16 v[188:189], v19 offset:43200
    ds_read_b64_tr_b16 v[190:191], v19 offset:44992
    s_waitcnt vmcnt(6)
    s_mov_b32 s47, 6144
    buffer_load_dwordx4 v[200:203], v10, s[4:7], s47 offen
    buffer_load_dwordx4 v[204:207], v11, s[4:7], s47 offen
    s_waitcnt lgkmcnt(15)
    v_mfma_f32_16x16x32_bf16 v[24:27], v[136:139], v[208:211], v[24:27]
    v_mfma_f32_16x16x32_bf16 v[80:83], v[136:139], v[212:215], v[80:83]
    ds_read_b64_tr_b16 v[136:137], v16 offset:35840
    ds_read_b64_tr_b16 v[138:139], v16 offset:37632
    v_mfma_f32_16x16x32_bf16 v[28:31], v[140:143], v[208:211], v[28:31]
    v_mfma_f32_16x16x32_bf16 v[84:87], v[140:143], v[212:215], v[84:87]
    ds_read_b64_tr_b16 v[140:141], v16 offset:35872
    ds_read_b64_tr_b16 v[142:143], v16 offset:37664
    v_mfma_f32_16x16x32_bf16 v[32:35], v[144:147], v[208:211], v[32:35]
    v_mfma_f32_16x16x32_bf16 v[88:91], v[144:147], v[212:215], v[88:91]
    ds_read_b64_tr_b16 v[144:145], v16 offset:35904
    ds_read_b64_tr_b16 v[146:147], v16 offset:37696
    v_mfma_f32_16x16x32_bf16 v[36:39], v[148:151], v[208:211], v[36:39]
    v_mfma_f32_16x16x32_bf16 v[92:95], v[148:151], v[212:215], v[92:95]
    ds_read_b64_tr_b16 v[148:149], v16 offset:35936
    ds_read_b64_tr_b16 v[150:151], v16 offset:37728
    v_mfma_f32_16x16x32_bf16 v[40:43], v[152:155], v[208:211], v[40:43]
    v_mfma_f32_16x16x32_bf16 v[96:99], v[152:155], v[212:215], v[96:99]
    ds_read_b64_tr_b16 v[152:153], v16 offset:35968
    ds_read_b64_tr_b16 v[154:155], v16 offset:37760
    v_mfma_f32_16x16x32_bf16 v[44:47], v[156:159], v[208:211], v[44:47]
    v_mfma_f32_16x16x32_bf16 v[100:103], v[156:159], v[212:215], v[100:103]
    ds_read_b64_tr_b16 v[156:157], v16 offset:36000
    ds_read_b64_tr_b16 v[158:159], v16 offset:37792
    s_waitcnt lgkmcnt(15)
    v_mfma_f32_16x16x32_bf16 v[48:51], v[160:163], v[208:211], v[48:51]
    v_mfma_f32_16x16x32_bf16 v[104:107], v[160:163], v[212:215], v[104:107]
    ds_read_b64_tr_b16 v[160:161], v16 offset:36032
    ds_read_b64_tr_b16 v[162:163], v16 offset:37824
    v_mfma_f32_16x16x32_bf16 v[52:55], v[164:167], v[208:211], v[52:55]
    v_mfma_f32_16x16x32_bf16 v[108:111], v[164:167], v[212:215], v[108:111]
    ds_read_b64_tr_b16 v[164:165], v19 offset:50176
    ds_read_b64_tr_b16 v[166:167], v19 offset:51968
    v_mfma_f32_16x16x32_bf16 v[56:59], v[168:171], v[208:211], v[56:59]
    v_mfma_f32_16x16x32_bf16 v[112:115], v[168:171], v[212:215], v[112:115]
    ds_read_b64_tr_b16 v[168:169], v19 offset:50208
    ds_read_b64_tr_b16 v[170:171], v19 offset:52000
    v_mfma_f32_16x16x32_bf16 v[60:63], v[172:175], v[208:211], v[60:63]
    v_mfma_f32_16x16x32_bf16 v[116:119], v[172:175], v[212:215], v[116:119]
    ds_read_b64_tr_b16 v[172:173], v19 offset:50240
    ds_read_b64_tr_b16 v[174:175], v19 offset:52032
    v_mfma_f32_16x16x32_bf16 v[64:67], v[176:179], v[208:211], v[64:67]
    v_mfma_f32_16x16x32_bf16 v[120:123], v[176:179], v[212:215], v[120:123]
    ds_read_b64_tr_b16 v[176:177], v19 offset:50272
    ds_read_b64_tr_b16 v[178:179], v19 offset:52064
    v_mfma_f32_16x16x32_bf16 v[68:71], v[180:183], v[208:211], v[68:71]
    v_mfma_f32_16x16x32_bf16 v[124:127], v[180:183], v[212:215], v[124:127]
    ds_read_b64_tr_b16 v[180:181], v19 offset:50304
    ds_read_b64_tr_b16 v[182:183], v19 offset:52096
    s_waitcnt lgkmcnt(15)
    v_mfma_f32_16x16x32_bf16 v[72:75], v[184:187], v[208:211], v[72:75]
    v_mfma_f32_16x16x32_bf16 v[128:131], v[184:187], v[212:215], v[128:131]
    ds_read_b64_tr_b16 v[184:185], v19 offset:50336
    ds_read_b64_tr_b16 v[186:187], v19 offset:52128
    v_mfma_f32_16x16x32_bf16 v[76:79], v[188:191], v[208:211], v[76:79]
    v_mfma_f32_16x16x32_bf16 v[132:135], v[188:191], v[212:215], v[132:135]
    ds_read_b64_tr_b16 v[188:189], v19 offset:50368
    ds_read_b64_tr_b16 v[190:191], v19 offset:52160
    s_waitcnt vmcnt(6)
    s_mov_b32 s47, 7168
    buffer_load_dwordx4 v[208:211], v10, s[4:7], s47 offen
    buffer_load_dwordx4 v[212:215], v11, s[4:7], s47 offen
    v_mfma_f32_16x16x32_bf16 v[24:27], v[136:139], v[216:219], v[24:27]
    v_mfma_f32_16x16x32_bf16 v[80:83], v[136:139], v[220:223], v[80:83]
    v_mfma_f32_16x16x32_bf16 v[28:31], v[140:143], v[216:219], v[28:31]
    v_mfma_f32_16x16x32_bf16 v[84:87], v[140:143], v[220:223], v[84:87]
    v_mfma_f32_16x16x32_bf16 v[32:35], v[144:147], v[216:219], v[32:35]
    v_mfma_f32_16x16x32_bf16 v[88:91], v[144:147], v[220:223], v[88:91]
    v_mfma_f32_16x16x32_bf16 v[36:39], v[148:151], v[216:219], v[36:39]
    v_mfma_f32_16x16x32_bf16 v[92:95], v[148:151], v[220:223], v[92:95]
    s_waitcnt lgkmcnt(15)
    v_mfma_f32_16x16x32_bf16 v[40:43], v[152:155], v[216:219], v[40:43]
    v_mfma_f32_16x16x32_bf16 v[96:99], v[152:155], v[220:223], v[96:99]
    s_waitcnt lgkmcnt(0)
    s_barrier
    ds_read_b64_tr_b16 v[136:137], v16 offset:57344
    ds_read_b64_tr_b16 v[138:139], v16 offset:59136
    ds_read_b64_tr_b16 v[140:141], v16 offset:57376
    ds_read_b64_tr_b16 v[142:143], v16 offset:59168
    ds_read_b64_tr_b16 v[144:145], v16 offset:57408
    ds_read_b64_tr_b16 v[146:147], v16 offset:59200
    ds_read_b64_tr_b16 v[148:149], v16 offset:57440
    ds_read_b64_tr_b16 v[150:151], v16 offset:59232
    ds_read_b64_tr_b16 v[152:153], v16 offset:57472
    ds_read_b64_tr_b16 v[154:155], v16 offset:59264
    v_mfma_f32_16x16x32_bf16 v[44:47], v[156:159], v[216:219], v[44:47]
    v_mfma_f32_16x16x32_bf16 v[100:103], v[156:159], v[220:223], v[100:103]
    ds_read_b64_tr_b16 v[156:157], v16 offset:57504
    ds_read_b64_tr_b16 v[158:159], v16 offset:59296
    v_mfma_f32_16x16x32_bf16 v[48:51], v[160:163], v[216:219], v[48:51]
    v_mfma_f32_16x16x32_bf16 v[104:107], v[160:163], v[220:223], v[104:107]
    ds_read_b64_tr_b16 v[160:161], v16 offset:57536
    ds_read_b64_tr_b16 v[162:163], v16 offset:59328
    v_mfma_f32_16x16x32_bf16 v[52:55], v[164:167], v[216:219], v[52:55]
    v_mfma_f32_16x16x32_bf16 v[108:111], v[164:167], v[220:223], v[108:111]
    ds_read_b64_tr_b16 v[164:165], v20 offset:6144
    ds_read_b64_tr_b16 v[166:167], v20 offset:7936
    v_mfma_f32_16x16x32_bf16 v[56:59], v[168:171], v[216:219], v[56:59]
    v_mfma_f32_16x16x32_bf16 v[112:115], v[168:171], v[220:223], v[112:115]
    ds_read_b64_tr_b16 v[168:169], v20 offset:6176
    ds_read_b64_tr_b16 v[170:171], v20 offset:7968
    v_mfma_f32_16x16x32_bf16 v[60:63], v[172:175], v[216:219], v[60:63]
    v_mfma_f32_16x16x32_bf16 v[116:119], v[172:175], v[220:223], v[116:119]
    ds_read_b64_tr_b16 v[172:173], v20 offset:6208
    ds_read_b64_tr_b16 v[174:175], v20 offset:8000
    v_mfma_f32_16x16x32_bf16 v[64:67], v[176:179], v[216:219], v[64:67]
    v_mfma_f32_16x16x32_bf16 v[120:123], v[176:179], v[220:223], v[120:123]
    ds_read_b64_tr_b16 v[176:177], v20 offset:6240
    ds_read_b64_tr_b16 v[178:179], v20 offset:8032
    v_mfma_f32_16x16x32_bf16 v[68:71], v[180:183], v[216:219], v[68:71]
    v_mfma_f32_16x16x32_bf16 v[124:127], v[180:183], v[220:223], v[124:127]
    ds_read_b64_tr_b16 v[180:181], v20 offset:6272
    ds_read_b64_tr_b16 v[182:183], v20 offset:8064
    v_mfma_f32_16x16x32_bf16 v[72:75], v[184:187], v[216:219], v[72:75]
    v_mfma_f32_16x16x32_bf16 v[128:131], v[184:187], v[220:223], v[128:131]
    ds_read_b64_tr_b16 v[184:185], v20 offset:6304
    ds_read_b64_tr_b16 v[186:187], v20 offset:8096
    v_mfma_f32_16x16x32_bf16 v[76:79], v[188:191], v[216:219], v[76:79]
    v_mfma_f32_16x16x32_bf16 v[132:135], v[188:191], v[220:223], v[132:135]
    ds_read_b64_tr_b16 v[188:189], v20 offset:6336
    ds_read_b64_tr_b16 v[190:191], v20 offset:8128
    s_waitcnt vmcnt(6)
    s_mov_b32 s47, 8192
    buffer_load_dwordx4 v[216:219], v10, s[4:7], s47 offen
    buffer_load_dwordx4 v[220:223], v11, s[4:7], s47 offen
    s_waitcnt lgkmcnt(15)
    v_mfma_f32_16x16x32_bf16 v[24:27], v[136:139], v[224:227], v[24:27]
    v_mfma_f32_16x16x32_bf16 v[80:83], v[136:139], v[228:231], v[80:83]
    ds_read_b64_tr_b16 v[136:137], v16 offset:64512
    ds_read_b64_tr_b16 v[138:139], v17 offset:768
    v_mfma_f32_16x16x32_bf16 v[28:31], v[140:143], v[224:227], v[28:31]
    v_mfma_f32_16x16x32_bf16 v[84:87], v[140:143], v[228:231], v[84:87]
    ds_read_b64_tr_b16 v[140:141], v16 offset:64544
    ds_read_b64_tr_b16 v[142:143], v17 offset:800
    v_mfma_f32_16x16x32_bf16 v[32:35], v[144:147], v[224:227], v[32:35]
    v_mfma_f32_16x16x32_bf16 v[88:91], v[144:147], v[228:231], v[88:91]
    ds_read_b64_tr_b16 v[144:145], v16 offset:64576
    ds_read_b64_tr_b16 v[146:147], v17 offset:832
    v_mfma_f32_16x16x32_bf16 v[36:39], v[148:151], v[224:227], v[36:39]
    v_mfma_f32_16x16x32_bf16 v[92:95], v[148:151], v[228:231], v[92:95]
    ds_read_b64_tr_b16 v[148:149], v16 offset:64608
    ds_read_b64_tr_b16 v[150:151], v17 offset:864
    v_mfma_f32_16x16x32_bf16 v[40:43], v[152:155], v[224:227], v[40:43]
    v_mfma_f32_16x16x32_bf16 v[96:99], v[152:155], v[228:231], v[96:99]
    ds_read_b64_tr_b16 v[152:153], v16 offset:64640
    ds_read_b64_tr_b16 v[154:155], v17 offset:896
    v_mfma_f32_16x16x32_bf16 v[44:47], v[156:159], v[224:227], v[44:47]
    v_mfma_f32_16x16x32_bf16 v[100:103], v[156:159], v[228:231], v[100:103]
    ds_read_b64_tr_b16 v[156:157], v16 offset:64672
    ds_read_b64_tr_b16 v[158:159], v17 offset:928
    s_waitcnt lgkmcnt(15)
    v_mfma_f32_16x16x32_bf16 v[48:51], v[160:163], v[224:227], v[48:51]
    v_mfma_f32_16x16x32_bf16 v[104:107], v[160:163], v[228:231], v[104:107]
    ds_read_b64_tr_b16 v[160:161], v16 offset:64704
    ds_read_b64_tr_b16 v[162:163], v17 offset:960
    v_mfma_f32_16x16x32_bf16 v[52:55], v[164:167], v[224:227], v[52:55]
    v_mfma_f32_16x16x32_bf16 v[108:111], v[164:167], v[228:231], v[108:111]
    ds_read_b64_tr_b16 v[164:165], v20 offset:13312
    ds_read_b64_tr_b16 v[166:167], v20 offset:15104
    v_mfma_f32_16x16x32_bf16 v[56:59], v[168:171], v[224:227], v[56:59]
    v_mfma_f32_16x16x32_bf16 v[112:115], v[168:171], v[228:231], v[112:115]
    ds_read_b64_tr_b16 v[168:169], v20 offset:13344
    ds_read_b64_tr_b16 v[170:171], v20 offset:15136
    v_mfma_f32_16x16x32_bf16 v[60:63], v[172:175], v[224:227], v[60:63]
    v_mfma_f32_16x16x32_bf16 v[116:119], v[172:175], v[228:231], v[116:119]
    ds_read_b64_tr_b16 v[172:173], v20 offset:13376
    ds_read_b64_tr_b16 v[174:175], v20 offset:15168
    v_mfma_f32_16x16x32_bf16 v[64:67], v[176:179], v[224:227], v[64:67]
    v_mfma_f32_16x16x32_bf16 v[120:123], v[176:179], v[228:231], v[120:123]
    ds_read_b64_tr_b16 v[176:177], v20 offset:13408
    ds_read_b64_tr_b16 v[178:179], v20 offset:15200
    v_mfma_f32_16x16x32_bf16 v[68:71], v[180:183], v[224:227], v[68:71]
    v_mfma_f32_16x16x32_bf16 v[124:127], v[180:183], v[228:231], v[124:127]
    ds_read_b64_tr_b16 v[180:181], v20 offset:13440
    ds_read_b64_tr_b16 v[182:183], v20 offset:15232
    s_waitcnt lgkmcnt(15)
    v_mfma_f32_16x16x32_bf16 v[72:75], v[184:187], v[224:227], v[72:75]
    v_mfma_f32_16x16x32_bf16 v[128:131], v[184:187], v[228:231], v[128:131]
    ds_read_b64_tr_b16 v[184:185], v20 offset:13472
    ds_read_b64_tr_b16 v[186:187], v20 offset:15264
    v_mfma_f32_16x16x32_bf16 v[76:79], v[188:191], v[224:227], v[76:79]
    v_mfma_f32_16x16x32_bf16 v[132:135], v[188:191], v[228:231], v[132:135]
    ds_read_b64_tr_b16 v[188:189], v20 offset:13504
    ds_read_b64_tr_b16 v[190:191], v20 offset:15296
    s_waitcnt vmcnt(6)
    s_mov_b32 s47, 9216
    buffer_load_dwordx4 v[224:227], v10, s[4:7], s47 offen
    buffer_load_dwordx4 v[228:231], v11, s[4:7], s47 offen
    v_mfma_f32_16x16x32_bf16 v[24:27], v[136:139], v[192:195], v[24:27]
    v_mfma_f32_16x16x32_bf16 v[80:83], v[136:139], v[196:199], v[80:83]
    v_mfma_f32_16x16x32_bf16 v[28:31], v[140:143], v[192:195], v[28:31]
    v_mfma_f32_16x16x32_bf16 v[84:87], v[140:143], v[196:199], v[84:87]
    v_mfma_f32_16x16x32_bf16 v[32:35], v[144:147], v[192:195], v[32:35]
    v_mfma_f32_16x16x32_bf16 v[88:91], v[144:147], v[196:199], v[88:91]
    v_mfma_f32_16x16x32_bf16 v[36:39], v[148:151], v[192:195], v[36:39]
    v_mfma_f32_16x16x32_bf16 v[92:95], v[148:151], v[196:199], v[92:95]
    s_waitcnt lgkmcnt(15)
    v_mfma_f32_16x16x32_bf16 v[40:43], v[152:155], v[192:195], v[40:43]
    v_mfma_f32_16x16x32_bf16 v[96:99], v[152:155], v[196:199], v[96:99]
    s_waitcnt lgkmcnt(0)
    s_barrier
    ds_read_b64_tr_b16 v[136:137], v17 offset:20480
    ds_read_b64_tr_b16 v[138:139], v17 offset:22272
    ds_read_b64_tr_b16 v[140:141], v17 offset:20512
    ds_read_b64_tr_b16 v[142:143], v17 offset:22304
    ds_read_b64_tr_b16 v[144:145], v17 offset:20544
    ds_read_b64_tr_b16 v[146:147], v17 offset:22336
    ds_read_b64_tr_b16 v[148:149], v17 offset:20576
    ds_read_b64_tr_b16 v[150:151], v17 offset:22368
    ds_read_b64_tr_b16 v[152:153], v17 offset:20608
    ds_read_b64_tr_b16 v[154:155], v17 offset:22400
    v_mfma_f32_16x16x32_bf16 v[44:47], v[156:159], v[192:195], v[44:47]
    v_mfma_f32_16x16x32_bf16 v[100:103], v[156:159], v[196:199], v[100:103]
    ds_read_b64_tr_b16 v[156:157], v17 offset:20640
    ds_read_b64_tr_b16 v[158:159], v17 offset:22432
    v_mfma_f32_16x16x32_bf16 v[48:51], v[160:163], v[192:195], v[48:51]
    v_mfma_f32_16x16x32_bf16 v[104:107], v[160:163], v[196:199], v[104:107]
    ds_read_b64_tr_b16 v[160:161], v17 offset:20672
    ds_read_b64_tr_b16 v[162:163], v17 offset:22464
    v_mfma_f32_16x16x32_bf16 v[52:55], v[164:167], v[192:195], v[52:55]
    v_mfma_f32_16x16x32_bf16 v[108:111], v[164:167], v[196:199], v[108:111]
    ds_read_b64_tr_b16 v[164:165], v20 offset:34816
    ds_read_b64_tr_b16 v[166:167], v20 offset:36608
    v_mfma_f32_16x16x32_bf16 v[56:59], v[168:171], v[192:195], v[56:59]
    v_mfma_f32_16x16x32_bf16 v[112:115], v[168:171], v[196:199], v[112:115]
    ds_read_b64_tr_b16 v[168:169], v20 offset:34848
    ds_read_b64_tr_b16 v[170:171], v20 offset:36640
    v_mfma_f32_16x16x32_bf16 v[60:63], v[172:175], v[192:195], v[60:63]
    v_mfma_f32_16x16x32_bf16 v[116:119], v[172:175], v[196:199], v[116:119]
    ds_read_b64_tr_b16 v[172:173], v20 offset:34880
    ds_read_b64_tr_b16 v[174:175], v20 offset:36672
    v_mfma_f32_16x16x32_bf16 v[64:67], v[176:179], v[192:195], v[64:67]
    v_mfma_f32_16x16x32_bf16 v[120:123], v[176:179], v[196:199], v[120:123]
    ds_read_b64_tr_b16 v[176:177], v20 offset:34912
    ds_read_b64_tr_b16 v[178:179], v20 offset:36704
    v_mfma_f32_16x16x32_bf16 v[68:71], v[180:183], v[192:195], v[68:71]
    v_mfma_f32_16x16x32_bf16 v[124:127], v[180:183], v[196:199], v[124:127]
    ds_read_b64_tr_b16 v[180:181], v20 offset:34944
    ds_read_b64_tr_b16 v[182:183], v20 offset:36736
    v_mfma_f32_16x16x32_bf16 v[72:75], v[184:187], v[192:195], v[72:75]
    v_mfma_f32_16x16x32_bf16 v[128:131], v[184:187], v[196:199], v[128:131]
    ds_read_b64_tr_b16 v[184:185], v20 offset:34976
    ds_read_b64_tr_b16 v[186:187], v20 offset:36768
    v_mfma_f32_16x16x32_bf16 v[76:79], v[188:191], v[192:195], v[76:79]
    v_mfma_f32_16x16x32_bf16 v[132:135], v[188:191], v[196:199], v[132:135]
    ds_read_b64_tr_b16 v[188:189], v20 offset:35008
    ds_read_b64_tr_b16 v[190:191], v20 offset:36800
    s_waitcnt vmcnt(6)
    s_mov_b32 s47, 10240
    buffer_load_dwordx4 v[192:195], v10, s[4:7], s47 offen
    buffer_load_dwordx4 v[196:199], v11, s[4:7], s47 offen
    s_waitcnt lgkmcnt(15)
    v_mfma_f32_16x16x32_bf16 v[24:27], v[136:139], v[200:203], v[24:27]
    v_mfma_f32_16x16x32_bf16 v[80:83], v[136:139], v[204:207], v[80:83]
    ds_read_b64_tr_b16 v[136:137], v17 offset:27648
    ds_read_b64_tr_b16 v[138:139], v17 offset:29440
    v_mfma_f32_16x16x32_bf16 v[28:31], v[140:143], v[200:203], v[28:31]
    v_mfma_f32_16x16x32_bf16 v[84:87], v[140:143], v[204:207], v[84:87]
    ds_read_b64_tr_b16 v[140:141], v17 offset:27680
    ds_read_b64_tr_b16 v[142:143], v17 offset:29472
    v_mfma_f32_16x16x32_bf16 v[32:35], v[144:147], v[200:203], v[32:35]
    v_mfma_f32_16x16x32_bf16 v[88:91], v[144:147], v[204:207], v[88:91]
    ds_read_b64_tr_b16 v[144:145], v17 offset:27712
    ds_read_b64_tr_b16 v[146:147], v17 offset:29504
    v_mfma_f32_16x16x32_bf16 v[36:39], v[148:151], v[200:203], v[36:39]
    v_mfma_f32_16x16x32_bf16 v[92:95], v[148:151], v[204:207], v[92:95]
    ds_read_b64_tr_b16 v[148:149], v17 offset:27744
    ds_read_b64_tr_b16 v[150:151], v17 offset:29536
    v_mfma_f32_16x16x32_bf16 v[40:43], v[152:155], v[200:203], v[40:43]
    v_mfma_f32_16x16x32_bf16 v[96:99], v[152:155], v[204:207], v[96:99]
    ds_read_b64_tr_b16 v[152:153], v17 offset:27776
    ds_read_b64_tr_b16 v[154:155], v17 offset:29568
    v_mfma_f32_16x16x32_bf16 v[44:47], v[156:159], v[200:203], v[44:47]
    v_mfma_f32_16x16x32_bf16 v[100:103], v[156:159], v[204:207], v[100:103]
    ds_read_b64_tr_b16 v[156:157], v17 offset:27808
    ds_read_b64_tr_b16 v[158:159], v17 offset:29600
    s_waitcnt lgkmcnt(15)
    v_mfma_f32_16x16x32_bf16 v[48:51], v[160:163], v[200:203], v[48:51]
    v_mfma_f32_16x16x32_bf16 v[104:107], v[160:163], v[204:207], v[104:107]
    ds_read_b64_tr_b16 v[160:161], v17 offset:27840
    ds_read_b64_tr_b16 v[162:163], v17 offset:29632
    v_mfma_f32_16x16x32_bf16 v[52:55], v[164:167], v[200:203], v[52:55]
    v_mfma_f32_16x16x32_bf16 v[108:111], v[164:167], v[204:207], v[108:111]
    ds_read_b64_tr_b16 v[164:165], v20 offset:41984
    ds_read_b64_tr_b16 v[166:167], v20 offset:43776
    v_mfma_f32_16x16x32_bf16 v[56:59], v[168:171], v[200:203], v[56:59]
    v_mfma_f32_16x16x32_bf16 v[112:115], v[168:171], v[204:207], v[112:115]
    ds_read_b64_tr_b16 v[168:169], v20 offset:42016
    ds_read_b64_tr_b16 v[170:171], v20 offset:43808
    v_mfma_f32_16x16x32_bf16 v[60:63], v[172:175], v[200:203], v[60:63]
    v_mfma_f32_16x16x32_bf16 v[116:119], v[172:175], v[204:207], v[116:119]
    ds_read_b64_tr_b16 v[172:173], v20 offset:42048
    ds_read_b64_tr_b16 v[174:175], v20 offset:43840
    v_mfma_f32_16x16x32_bf16 v[64:67], v[176:179], v[200:203], v[64:67]
    v_mfma_f32_16x16x32_bf16 v[120:123], v[176:179], v[204:207], v[120:123]
    ds_read_b64_tr_b16 v[176:177], v20 offset:42080
    ds_read_b64_tr_b16 v[178:179], v20 offset:43872
    v_mfma_f32_16x16x32_bf16 v[68:71], v[180:183], v[200:203], v[68:71]
    v_mfma_f32_16x16x32_bf16 v[124:127], v[180:183], v[204:207], v[124:127]
    ds_read_b64_tr_b16 v[180:181], v20 offset:42112
    ds_read_b64_tr_b16 v[182:183], v20 offset:43904
    s_waitcnt lgkmcnt(15)
    v_mfma_f32_16x16x32_bf16 v[72:75], v[184:187], v[200:203], v[72:75]
    v_mfma_f32_16x16x32_bf16 v[128:131], v[184:187], v[204:207], v[128:131]
    ds_read_b64_tr_b16 v[184:185], v20 offset:42144
    ds_read_b64_tr_b16 v[186:187], v20 offset:43936
    v_mfma_f32_16x16x32_bf16 v[76:79], v[188:191], v[200:203], v[76:79]
    v_mfma_f32_16x16x32_bf16 v[132:135], v[188:191], v[204:207], v[132:135]
    ds_read_b64_tr_b16 v[188:189], v20 offset:42176
    ds_read_b64_tr_b16 v[190:191], v20 offset:43968
    s_waitcnt vmcnt(6)
    s_mov_b32 s47, 11264
    buffer_load_dwordx4 v[200:203], v10, s[4:7], s47 offen
    buffer_load_dwordx4 v[204:207], v11, s[4:7], s47 offen
    v_mfma_f32_16x16x32_bf16 v[24:27], v[136:139], v[208:211], v[24:27]
    v_mfma_f32_16x16x32_bf16 v[80:83], v[136:139], v[212:215], v[80:83]
    v_mfma_f32_16x16x32_bf16 v[28:31], v[140:143], v[208:211], v[28:31]
    v_mfma_f32_16x16x32_bf16 v[84:87], v[140:143], v[212:215], v[84:87]
    v_mfma_f32_16x16x32_bf16 v[32:35], v[144:147], v[208:211], v[32:35]
    v_mfma_f32_16x16x32_bf16 v[88:91], v[144:147], v[212:215], v[88:91]
    v_mfma_f32_16x16x32_bf16 v[36:39], v[148:151], v[208:211], v[36:39]
    v_mfma_f32_16x16x32_bf16 v[92:95], v[148:151], v[212:215], v[92:95]
    s_waitcnt lgkmcnt(15)
    v_mfma_f32_16x16x32_bf16 v[40:43], v[152:155], v[208:211], v[40:43]
    v_mfma_f32_16x16x32_bf16 v[96:99], v[152:155], v[212:215], v[96:99]
    s_waitcnt lgkmcnt(0)
    s_barrier
    ds_read_b64_tr_b16 v[136:137], v17 offset:49152
    ds_read_b64_tr_b16 v[138:139], v17 offset:50944
    ds_read_b64_tr_b16 v[140:141], v17 offset:49184
    ds_read_b64_tr_b16 v[142:143], v17 offset:50976
    ds_read_b64_tr_b16 v[144:145], v17 offset:49216
    ds_read_b64_tr_b16 v[146:147], v17 offset:51008
    ds_read_b64_tr_b16 v[148:149], v17 offset:49248
    ds_read_b64_tr_b16 v[150:151], v17 offset:51040
    ds_read_b64_tr_b16 v[152:153], v17 offset:49280
    ds_read_b64_tr_b16 v[154:155], v17 offset:51072
    v_mfma_f32_16x16x32_bf16 v[44:47], v[156:159], v[208:211], v[44:47]
    v_mfma_f32_16x16x32_bf16 v[100:103], v[156:159], v[212:215], v[100:103]
    ds_read_b64_tr_b16 v[156:157], v17 offset:49312
    ds_read_b64_tr_b16 v[158:159], v17 offset:51104
    v_mfma_f32_16x16x32_bf16 v[48:51], v[160:163], v[208:211], v[48:51]
    v_mfma_f32_16x16x32_bf16 v[104:107], v[160:163], v[212:215], v[104:107]
    ds_read_b64_tr_b16 v[160:161], v17 offset:49344
    ds_read_b64_tr_b16 v[162:163], v17 offset:51136
    v_mfma_f32_16x16x32_bf16 v[52:55], v[164:167], v[208:211], v[52:55]
    v_mfma_f32_16x16x32_bf16 v[108:111], v[164:167], v[212:215], v[108:111]
    ds_read_b64_tr_b16 v[164:165], v20 offset:63488
    ds_read_b64_tr_b16 v[166:167], v20 offset:65280
    v_mfma_f32_16x16x32_bf16 v[56:59], v[168:171], v[208:211], v[56:59]
    v_mfma_f32_16x16x32_bf16 v[112:115], v[168:171], v[212:215], v[112:115]
    ds_read_b64_tr_b16 v[168:169], v20 offset:63520
    ds_read_b64_tr_b16 v[170:171], v20 offset:65312
    v_mfma_f32_16x16x32_bf16 v[60:63], v[172:175], v[208:211], v[60:63]
    v_mfma_f32_16x16x32_bf16 v[116:119], v[172:175], v[212:215], v[116:119]
    ds_read_b64_tr_b16 v[172:173], v20 offset:63552
    ds_read_b64_tr_b16 v[174:175], v20 offset:65344
    v_mfma_f32_16x16x32_bf16 v[64:67], v[176:179], v[208:211], v[64:67]
    v_mfma_f32_16x16x32_bf16 v[120:123], v[176:179], v[212:215], v[120:123]
    ds_read_b64_tr_b16 v[176:177], v20 offset:63584
    ds_read_b64_tr_b16 v[178:179], v20 offset:65376
    v_mfma_f32_16x16x32_bf16 v[68:71], v[180:183], v[208:211], v[68:71]
    v_mfma_f32_16x16x32_bf16 v[124:127], v[180:183], v[212:215], v[124:127]
    ds_read_b64_tr_b16 v[180:181], v20 offset:63616
    ds_read_b64_tr_b16 v[182:183], v20 offset:65408
    v_mfma_f32_16x16x32_bf16 v[72:75], v[184:187], v[208:211], v[72:75]
    v_mfma_f32_16x16x32_bf16 v[128:131], v[184:187], v[212:215], v[128:131]
    ds_read_b64_tr_b16 v[184:185], v20 offset:63648
    ds_read_b64_tr_b16 v[186:187], v20 offset:65440
    v_mfma_f32_16x16x32_bf16 v[76:79], v[188:191], v[208:211], v[76:79]
    v_mfma_f32_16x16x32_bf16 v[132:135], v[188:191], v[212:215], v[132:135]
    ds_read_b64_tr_b16 v[188:189], v20 offset:63680
    ds_read_b64_tr_b16 v[190:191], v20 offset:65472
    s_waitcnt vmcnt(6)
    s_mov_b32 s47, 12288
    buffer_load_dwordx4 v[208:211], v10, s[4:7], s47 offen
    buffer_load_dwordx4 v[212:215], v11, s[4:7], s47 offen
    s_waitcnt lgkmcnt(15)
    v_mfma_f32_16x16x32_bf16 v[24:27], v[136:139], v[216:219], v[24:27]
    v_mfma_f32_16x16x32_bf16 v[80:83], v[136:139], v[220:223], v[80:83]
    ds_read_b64_tr_b16 v[136:137], v17 offset:56320
    ds_read_b64_tr_b16 v[138:139], v17 offset:58112
    v_mfma_f32_16x16x32_bf16 v[28:31], v[140:143], v[216:219], v[28:31]
    v_mfma_f32_16x16x32_bf16 v[84:87], v[140:143], v[220:223], v[84:87]
    ds_read_b64_tr_b16 v[140:141], v17 offset:56352
    ds_read_b64_tr_b16 v[142:143], v17 offset:58144
    v_mfma_f32_16x16x32_bf16 v[32:35], v[144:147], v[216:219], v[32:35]
    v_mfma_f32_16x16x32_bf16 v[88:91], v[144:147], v[220:223], v[88:91]
    ds_read_b64_tr_b16 v[144:145], v17 offset:56384
    ds_read_b64_tr_b16 v[146:147], v17 offset:58176
    v_mfma_f32_16x16x32_bf16 v[36:39], v[148:151], v[216:219], v[36:39]
    v_mfma_f32_16x16x32_bf16 v[92:95], v[148:151], v[220:223], v[92:95]
    ds_read_b64_tr_b16 v[148:149], v17 offset:56416
    ds_read_b64_tr_b16 v[150:151], v17 offset:58208
    v_mfma_f32_16x16x32_bf16 v[40:43], v[152:155], v[216:219], v[40:43]
    v_mfma_f32_16x16x32_bf16 v[96:99], v[152:155], v[220:223], v[96:99]
    ds_read_b64_tr_b16 v[152:153], v17 offset:56448
    ds_read_b64_tr_b16 v[154:155], v17 offset:58240
    v_mfma_f32_16x16x32_bf16 v[44:47], v[156:159], v[216:219], v[44:47]
    v_mfma_f32_16x16x32_bf16 v[100:103], v[156:159], v[220:223], v[100:103]
    ds_read_b64_tr_b16 v[156:157], v17 offset:56480
    ds_read_b64_tr_b16 v[158:159], v17 offset:58272
    s_waitcnt lgkmcnt(15)
    v_mfma_f32_16x16x32_bf16 v[48:51], v[160:163], v[216:219], v[48:51]
    v_mfma_f32_16x16x32_bf16 v[104:107], v[160:163], v[220:223], v[104:107]
    ds_read_b64_tr_b16 v[160:161], v17 offset:56512
    ds_read_b64_tr_b16 v[162:163], v17 offset:58304
    v_mfma_f32_16x16x32_bf16 v[52:55], v[164:167], v[216:219], v[52:55]
    v_mfma_f32_16x16x32_bf16 v[108:111], v[164:167], v[220:223], v[108:111]
    ds_read_b64_tr_b16 v[164:165], v21 offset:5120
    ds_read_b64_tr_b16 v[166:167], v21 offset:6912
    v_mfma_f32_16x16x32_bf16 v[56:59], v[168:171], v[216:219], v[56:59]
    v_mfma_f32_16x16x32_bf16 v[112:115], v[168:171], v[220:223], v[112:115]
    ds_read_b64_tr_b16 v[168:169], v21 offset:5152
    ds_read_b64_tr_b16 v[170:171], v21 offset:6944
    v_mfma_f32_16x16x32_bf16 v[60:63], v[172:175], v[216:219], v[60:63]
    v_mfma_f32_16x16x32_bf16 v[116:119], v[172:175], v[220:223], v[116:119]
    ds_read_b64_tr_b16 v[172:173], v21 offset:5184
    ds_read_b64_tr_b16 v[174:175], v21 offset:6976
    v_mfma_f32_16x16x32_bf16 v[64:67], v[176:179], v[216:219], v[64:67]
    v_mfma_f32_16x16x32_bf16 v[120:123], v[176:179], v[220:223], v[120:123]
    ds_read_b64_tr_b16 v[176:177], v21 offset:5216
    ds_read_b64_tr_b16 v[178:179], v21 offset:7008
    v_mfma_f32_16x16x32_bf16 v[68:71], v[180:183], v[216:219], v[68:71]
    v_mfma_f32_16x16x32_bf16 v[124:127], v[180:183], v[220:223], v[124:127]
    ds_read_b64_tr_b16 v[180:181], v21 offset:5248
    ds_read_b64_tr_b16 v[182:183], v21 offset:7040
    s_waitcnt lgkmcnt(15)
    v_mfma_f32_16x16x32_bf16 v[72:75], v[184:187], v[216:219], v[72:75]
    v_mfma_f32_16x16x32_bf16 v[128:131], v[184:187], v[220:223], v[128:131]
    ds_read_b64_tr_b16 v[184:185], v21 offset:5280
    ds_read_b64_tr_b16 v[186:187], v21 offset:7072
    v_mfma_f32_16x16x32_bf16 v[76:79], v[188:191], v[216:219], v[76:79]
    v_mfma_f32_16x16x32_bf16 v[132:135], v[188:191], v[220:223], v[132:135]
    ds_read_b64_tr_b16 v[188:189], v21 offset:5312
    ds_read_b64_tr_b16 v[190:191], v21 offset:7104
    s_waitcnt vmcnt(6)
    s_mov_b32 s47, 13312
    buffer_load_dwordx4 v[216:219], v10, s[4:7], s47 offen
    buffer_load_dwordx4 v[220:223], v11, s[4:7], s47 offen
    v_mfma_f32_16x16x32_bf16 v[24:27], v[136:139], v[224:227], v[24:27]
    v_mfma_f32_16x16x32_bf16 v[80:83], v[136:139], v[228:231], v[80:83]
    v_mfma_f32_16x16x32_bf16 v[28:31], v[140:143], v[224:227], v[28:31]
    v_mfma_f32_16x16x32_bf16 v[84:87], v[140:143], v[228:231], v[84:87]
    v_mfma_f32_16x16x32_bf16 v[32:35], v[144:147], v[224:227], v[32:35]
    v_mfma_f32_16x16x32_bf16 v[88:91], v[144:147], v[228:231], v[88:91]
    v_mfma_f32_16x16x32_bf16 v[36:39], v[148:151], v[224:227], v[36:39]
    v_mfma_f32_16x16x32_bf16 v[92:95], v[148:151], v[228:231], v[92:95]
    s_waitcnt lgkmcnt(15)
    v_mfma_f32_16x16x32_bf16 v[40:43], v[152:155], v[224:227], v[40:43]
    v_mfma_f32_16x16x32_bf16 v[96:99], v[152:155], v[228:231], v[96:99]
    s_waitcnt lgkmcnt(0)
    s_barrier
    ds_read_b64_tr_b16 v[136:137], v16 offset:0
    ds_read_b64_tr_b16 v[138:139], v16 offset:1792
    ds_read_b64_tr_b16 v[140:141], v16 offset:32
    ds_read_b64_tr_b16 v[142:143], v16 offset:1824
    ds_read_b64_tr_b16 v[144:145], v16 offset:64
    ds_read_b64_tr_b16 v[146:147], v16 offset:1856
    ds_read_b64_tr_b16 v[148:149], v16 offset:96
    ds_read_b64_tr_b16 v[150:151], v16 offset:1888
    ds_read_b64_tr_b16 v[152:153], v16 offset:128
    ds_read_b64_tr_b16 v[154:155], v16 offset:1920
    v_mfma_f32_16x16x32_bf16 v[44:47], v[156:159], v[224:227], v[44:47]
    v_mfma_f32_16x16x32_bf16 v[100:103], v[156:159], v[228:231], v[100:103]
    ds_read_b64_tr_b16 v[156:157], v16 offset:160
    ds_read_b64_tr_b16 v[158:159], v16 offset:1952
    v_mfma_f32_16x16x32_bf16 v[48:51], v[160:163], v[224:227], v[48:51]
    v_mfma_f32_16x16x32_bf16 v[104:107], v[160:163], v[228:231], v[104:107]
    ds_read_b64_tr_b16 v[160:161], v16 offset:192
    ds_read_b64_tr_b16 v[162:163], v16 offset:1984
    v_mfma_f32_16x16x32_bf16 v[52:55], v[164:167], v[224:227], v[52:55]
    v_mfma_f32_16x16x32_bf16 v[108:111], v[164:167], v[228:231], v[108:111]
    ds_read_b64_tr_b16 v[164:165], v19 offset:14336
    ds_read_b64_tr_b16 v[166:167], v19 offset:16128
    v_mfma_f32_16x16x32_bf16 v[56:59], v[168:171], v[224:227], v[56:59]
    v_mfma_f32_16x16x32_bf16 v[112:115], v[168:171], v[228:231], v[112:115]
    ds_read_b64_tr_b16 v[168:169], v19 offset:14368
    ds_read_b64_tr_b16 v[170:171], v19 offset:16160
    v_mfma_f32_16x16x32_bf16 v[60:63], v[172:175], v[224:227], v[60:63]
    v_mfma_f32_16x16x32_bf16 v[116:119], v[172:175], v[228:231], v[116:119]
    ds_read_b64_tr_b16 v[172:173], v19 offset:14400
    ds_read_b64_tr_b16 v[174:175], v19 offset:16192
    v_mfma_f32_16x16x32_bf16 v[64:67], v[176:179], v[224:227], v[64:67]
    v_mfma_f32_16x16x32_bf16 v[120:123], v[176:179], v[228:231], v[120:123]
    ds_read_b64_tr_b16 v[176:177], v19 offset:14432
    ds_read_b64_tr_b16 v[178:179], v19 offset:16224
    v_mfma_f32_16x16x32_bf16 v[68:71], v[180:183], v[224:227], v[68:71]
    v_mfma_f32_16x16x32_bf16 v[124:127], v[180:183], v[228:231], v[124:127]
    ds_read_b64_tr_b16 v[180:181], v19 offset:14464
    ds_read_b64_tr_b16 v[182:183], v19 offset:16256
    v_mfma_f32_16x16x32_bf16 v[72:75], v[184:187], v[224:227], v[72:75]
    v_mfma_f32_16x16x32_bf16 v[128:131], v[184:187], v[228:231], v[128:131]
    ds_read_b64_tr_b16 v[184:185], v19 offset:14496
    ds_read_b64_tr_b16 v[186:187], v19 offset:16288
    v_mfma_f32_16x16x32_bf16 v[76:79], v[188:191], v[224:227], v[76:79]
    v_mfma_f32_16x16x32_bf16 v[132:135], v[188:191], v[228:231], v[132:135]
    ds_read_b64_tr_b16 v[188:189], v19 offset:14528
    ds_read_b64_tr_b16 v[190:191], v19 offset:16320
    s_waitcnt vmcnt(6)
    s_mov_b32 s47, 14336
    buffer_load_dwordx4 v[224:227], v10, s[4:7], s47 offen
    buffer_load_dwordx4 v[228:231], v11, s[4:7], s47 offen
    s_waitcnt lgkmcnt(15)
    v_mfma_f32_16x16x32_bf16 v[24:27], v[136:139], v[192:195], v[24:27]
    v_mfma_f32_16x16x32_bf16 v[80:83], v[136:139], v[196:199], v[80:83]
    ds_read_b64_tr_b16 v[136:137], v16 offset:7168
    ds_read_b64_tr_b16 v[138:139], v16 offset:8960
    v_mfma_f32_16x16x32_bf16 v[28:31], v[140:143], v[192:195], v[28:31]
    v_mfma_f32_16x16x32_bf16 v[84:87], v[140:143], v[196:199], v[84:87]
    ds_read_b64_tr_b16 v[140:141], v16 offset:7200
    ds_read_b64_tr_b16 v[142:143], v16 offset:8992
    v_mfma_f32_16x16x32_bf16 v[32:35], v[144:147], v[192:195], v[32:35]
    v_mfma_f32_16x16x32_bf16 v[88:91], v[144:147], v[196:199], v[88:91]
    ds_read_b64_tr_b16 v[144:145], v16 offset:7232
    ds_read_b64_tr_b16 v[146:147], v16 offset:9024
    v_mfma_f32_16x16x32_bf16 v[36:39], v[148:151], v[192:195], v[36:39]
    v_mfma_f32_16x16x32_bf16 v[92:95], v[148:151], v[196:199], v[92:95]
    ds_read_b64_tr_b16 v[148:149], v16 offset:7264
    ds_read_b64_tr_b16 v[150:151], v16 offset:9056
    v_mfma_f32_16x16x32_bf16 v[40:43], v[152:155], v[192:195], v[40:43]
    v_mfma_f32_16x16x32_bf16 v[96:99], v[152:155], v[196:199], v[96:99]
    ds_read_b64_tr_b16 v[152:153], v16 offset:7296
    ds_read_b64_tr_b16 v[154:155], v16 offset:9088
    v_mfma_f32_16x16x32_bf16 v[44:47], v[156:159], v[192:195], v[44:47]
    v_mfma_f32_16x16x32_bf16 v[100:103], v[156:159], v[196:199], v[100:103]
    ds_read_b64_tr_b16 v[156:157], v16 offset:7328
    ds_read_b64_tr_b16 v[158:159], v16 offset:9120
    s_waitcnt lgkmcnt(15)
    v_mfma_f32_16x16x32_bf16 v[48:51], v[160:163], v[192:195], v[48:51]
    v_mfma_f32_16x16x32_bf16 v[104:107], v[160:163], v[196:199], v[104:107]
    ds_read_b64_tr_b16 v[160:161], v16 offset:7360
    ds_read_b64_tr_b16 v[162:163], v16 offset:9152
    v_mfma_f32_16x16x32_bf16 v[52:55], v[164:167], v[192:195], v[52:55]
    v_mfma_f32_16x16x32_bf16 v[108:111], v[164:167], v[196:199], v[108:111]
    ds_read_b64_tr_b16 v[164:165], v19 offset:21504
    ds_read_b64_tr_b16 v[166:167], v19 offset:23296
    v_mfma_f32_16x16x32_bf16 v[56:59], v[168:171], v[192:195], v[56:59]
    v_mfma_f32_16x16x32_bf16 v[112:115], v[168:171], v[196:199], v[112:115]
    ds_read_b64_tr_b16 v[168:169], v19 offset:21536
    ds_read_b64_tr_b16 v[170:171], v19 offset:23328
    v_mfma_f32_16x16x32_bf16 v[60:63], v[172:175], v[192:195], v[60:63]
    v_mfma_f32_16x16x32_bf16 v[116:119], v[172:175], v[196:199], v[116:119]
    ds_read_b64_tr_b16 v[172:173], v19 offset:21568
    ds_read_b64_tr_b16 v[174:175], v19 offset:23360
    v_mfma_f32_16x16x32_bf16 v[64:67], v[176:179], v[192:195], v[64:67]
    v_mfma_f32_16x16x32_bf16 v[120:123], v[176:179], v[196:199], v[120:123]
    ds_read_b64_tr_b16 v[176:177], v19 offset:21600
    ds_read_b64_tr_b16 v[178:179], v19 offset:23392
    v_mfma_f32_16x16x32_bf16 v[68:71], v[180:183], v[192:195], v[68:71]
    v_mfma_f32_16x16x32_bf16 v[124:127], v[180:183], v[196:199], v[124:127]
    ds_read_b64_tr_b16 v[180:181], v19 offset:21632
    ds_read_b64_tr_b16 v[182:183], v19 offset:23424
    s_waitcnt lgkmcnt(15)
    v_mfma_f32_16x16x32_bf16 v[72:75], v[184:187], v[192:195], v[72:75]
    v_mfma_f32_16x16x32_bf16 v[128:131], v[184:187], v[196:199], v[128:131]
    ds_read_b64_tr_b16 v[184:185], v19 offset:21664
    ds_read_b64_tr_b16 v[186:187], v19 offset:23456
    v_mfma_f32_16x16x32_bf16 v[76:79], v[188:191], v[192:195], v[76:79]
    v_mfma_f32_16x16x32_bf16 v[132:135], v[188:191], v[196:199], v[132:135]
    ds_read_b64_tr_b16 v[188:189], v19 offset:21696
    ds_read_b64_tr_b16 v[190:191], v19 offset:23488
    s_waitcnt vmcnt(6)
    s_mov_b32 s47, 15360
    buffer_load_dwordx4 v[192:195], v10, s[4:7], s47 offen
    buffer_load_dwordx4 v[196:199], v11, s[4:7], s47 offen
    v_mfma_f32_16x16x32_bf16 v[24:27], v[136:139], v[200:203], v[24:27]
    v_mfma_f32_16x16x32_bf16 v[80:83], v[136:139], v[204:207], v[80:83]
    v_mfma_f32_16x16x32_bf16 v[28:31], v[140:143], v[200:203], v[28:31]
    v_mfma_f32_16x16x32_bf16 v[84:87], v[140:143], v[204:207], v[84:87]
    v_mfma_f32_16x16x32_bf16 v[32:35], v[144:147], v[200:203], v[32:35]
    v_mfma_f32_16x16x32_bf16 v[88:91], v[144:147], v[204:207], v[88:91]
    v_mfma_f32_16x16x32_bf16 v[36:39], v[148:151], v[200:203], v[36:39]
    v_mfma_f32_16x16x32_bf16 v[92:95], v[148:151], v[204:207], v[92:95]
    s_waitcnt lgkmcnt(15)
    v_mfma_f32_16x16x32_bf16 v[40:43], v[152:155], v[200:203], v[40:43]
    v_mfma_f32_16x16x32_bf16 v[96:99], v[152:155], v[204:207], v[96:99]
    s_waitcnt lgkmcnt(0)
    s_barrier
    ds_read_b64_tr_b16 v[136:137], v16 offset:28672
    ds_read_b64_tr_b16 v[138:139], v16 offset:30464
    ds_read_b64_tr_b16 v[140:141], v16 offset:28704
    ds_read_b64_tr_b16 v[142:143], v16 offset:30496
    ds_read_b64_tr_b16 v[144:145], v16 offset:28736
    ds_read_b64_tr_b16 v[146:147], v16 offset:30528
    ds_read_b64_tr_b16 v[148:149], v16 offset:28768
    ds_read_b64_tr_b16 v[150:151], v16 offset:30560
    ds_read_b64_tr_b16 v[152:153], v16 offset:28800
    ds_read_b64_tr_b16 v[154:155], v16 offset:30592
    v_mfma_f32_16x16x32_bf16 v[44:47], v[156:159], v[200:203], v[44:47]
    v_mfma_f32_16x16x32_bf16 v[100:103], v[156:159], v[204:207], v[100:103]
    ds_read_b64_tr_b16 v[156:157], v16 offset:28832
    ds_read_b64_tr_b16 v[158:159], v16 offset:30624
    v_mfma_f32_16x16x32_bf16 v[48:51], v[160:163], v[200:203], v[48:51]
    v_mfma_f32_16x16x32_bf16 v[104:107], v[160:163], v[204:207], v[104:107]
    ds_read_b64_tr_b16 v[160:161], v16 offset:28864
    ds_read_b64_tr_b16 v[162:163], v16 offset:30656
    v_mfma_f32_16x16x32_bf16 v[52:55], v[164:167], v[200:203], v[52:55]
    v_mfma_f32_16x16x32_bf16 v[108:111], v[164:167], v[204:207], v[108:111]
    ds_read_b64_tr_b16 v[164:165], v19 offset:43008
    ds_read_b64_tr_b16 v[166:167], v19 offset:44800
    v_mfma_f32_16x16x32_bf16 v[56:59], v[168:171], v[200:203], v[56:59]
    v_mfma_f32_16x16x32_bf16 v[112:115], v[168:171], v[204:207], v[112:115]
    ds_read_b64_tr_b16 v[168:169], v19 offset:43040
    ds_read_b64_tr_b16 v[170:171], v19 offset:44832
    v_mfma_f32_16x16x32_bf16 v[60:63], v[172:175], v[200:203], v[60:63]
    v_mfma_f32_16x16x32_bf16 v[116:119], v[172:175], v[204:207], v[116:119]
    ds_read_b64_tr_b16 v[172:173], v19 offset:43072
    ds_read_b64_tr_b16 v[174:175], v19 offset:44864
    v_mfma_f32_16x16x32_bf16 v[64:67], v[176:179], v[200:203], v[64:67]
    v_mfma_f32_16x16x32_bf16 v[120:123], v[176:179], v[204:207], v[120:123]
    ds_read_b64_tr_b16 v[176:177], v19 offset:43104
    ds_read_b64_tr_b16 v[178:179], v19 offset:44896
    v_mfma_f32_16x16x32_bf16 v[68:71], v[180:183], v[200:203], v[68:71]
    v_mfma_f32_16x16x32_bf16 v[124:127], v[180:183], v[204:207], v[124:127]
    ds_read_b64_tr_b16 v[180:181], v19 offset:43136
    ds_read_b64_tr_b16 v[182:183], v19 offset:44928
    v_mfma_f32_16x16x32_bf16 v[72:75], v[184:187], v[200:203], v[72:75]
    v_mfma_f32_16x16x32_bf16 v[128:131], v[184:187], v[204:207], v[128:131]
    ds_read_b64_tr_b16 v[184:185], v19 offset:43168
    ds_read_b64_tr_b16 v[186:187], v19 offset:44960
    v_mfma_f32_16x16x32_bf16 v[76:79], v[188:191], v[200:203], v[76:79]
    v_mfma_f32_16x16x32_bf16 v[132:135], v[188:191], v[204:207], v[132:135]
    ds_read_b64_tr_b16 v[188:189], v19 offset:43200
    ds_read_b64_tr_b16 v[190:191], v19 offset:44992
    s_waitcnt vmcnt(6)
    s_mov_b32 s47, 16384
    buffer_load_dwordx4 v[200:203], v10, s[4:7], s47 offen
    buffer_load_dwordx4 v[204:207], v11, s[4:7], s47 offen
    s_waitcnt lgkmcnt(15)
    v_mfma_f32_16x16x32_bf16 v[24:27], v[136:139], v[208:211], v[24:27]
    v_mfma_f32_16x16x32_bf16 v[80:83], v[136:139], v[212:215], v[80:83]
    ds_read_b64_tr_b16 v[136:137], v16 offset:35840
    ds_read_b64_tr_b16 v[138:139], v16 offset:37632
    v_mfma_f32_16x16x32_bf16 v[28:31], v[140:143], v[208:211], v[28:31]
    v_mfma_f32_16x16x32_bf16 v[84:87], v[140:143], v[212:215], v[84:87]
    ds_read_b64_tr_b16 v[140:141], v16 offset:35872
    ds_read_b64_tr_b16 v[142:143], v16 offset:37664
    v_mfma_f32_16x16x32_bf16 v[32:35], v[144:147], v[208:211], v[32:35]
    v_mfma_f32_16x16x32_bf16 v[88:91], v[144:147], v[212:215], v[88:91]
    ds_read_b64_tr_b16 v[144:145], v16 offset:35904
    ds_read_b64_tr_b16 v[146:147], v16 offset:37696
    v_mfma_f32_16x16x32_bf16 v[36:39], v[148:151], v[208:211], v[36:39]
    v_mfma_f32_16x16x32_bf16 v[92:95], v[148:151], v[212:215], v[92:95]
    ds_read_b64_tr_b16 v[148:149], v16 offset:35936
    ds_read_b64_tr_b16 v[150:151], v16 offset:37728
    v_mfma_f32_16x16x32_bf16 v[40:43], v[152:155], v[208:211], v[40:43]
    v_mfma_f32_16x16x32_bf16 v[96:99], v[152:155], v[212:215], v[96:99]
    ds_read_b64_tr_b16 v[152:153], v16 offset:35968
    ds_read_b64_tr_b16 v[154:155], v16 offset:37760
    v_mfma_f32_16x16x32_bf16 v[44:47], v[156:159], v[208:211], v[44:47]
    v_mfma_f32_16x16x32_bf16 v[100:103], v[156:159], v[212:215], v[100:103]
    ds_read_b64_tr_b16 v[156:157], v16 offset:36000
    ds_read_b64_tr_b16 v[158:159], v16 offset:37792
    s_waitcnt lgkmcnt(15)
    v_mfma_f32_16x16x32_bf16 v[48:51], v[160:163], v[208:211], v[48:51]
    v_mfma_f32_16x16x32_bf16 v[104:107], v[160:163], v[212:215], v[104:107]
    ds_read_b64_tr_b16 v[160:161], v16 offset:36032
    ds_read_b64_tr_b16 v[162:163], v16 offset:37824
    v_mfma_f32_16x16x32_bf16 v[52:55], v[164:167], v[208:211], v[52:55]
    v_mfma_f32_16x16x32_bf16 v[108:111], v[164:167], v[212:215], v[108:111]
    ds_read_b64_tr_b16 v[164:165], v19 offset:50176
    ds_read_b64_tr_b16 v[166:167], v19 offset:51968
    v_mfma_f32_16x16x32_bf16 v[56:59], v[168:171], v[208:211], v[56:59]
    v_mfma_f32_16x16x32_bf16 v[112:115], v[168:171], v[212:215], v[112:115]
    ds_read_b64_tr_b16 v[168:169], v19 offset:50208
    ds_read_b64_tr_b16 v[170:171], v19 offset:52000
    v_mfma_f32_16x16x32_bf16 v[60:63], v[172:175], v[208:211], v[60:63]
    v_mfma_f32_16x16x32_bf16 v[116:119], v[172:175], v[212:215], v[116:119]
    ds_read_b64_tr_b16 v[172:173], v19 offset:50240
    ds_read_b64_tr_b16 v[174:175], v19 offset:52032
    v_mfma_f32_16x16x32_bf16 v[64:67], v[176:179], v[208:211], v[64:67]
    v_mfma_f32_16x16x32_bf16 v[120:123], v[176:179], v[212:215], v[120:123]
    ds_read_b64_tr_b16 v[176:177], v19 offset:50272
    ds_read_b64_tr_b16 v[178:179], v19 offset:52064
    v_mfma_f32_16x16x32_bf16 v[68:71], v[180:183], v[208:211], v[68:71]
    v_mfma_f32_16x16x32_bf16 v[124:127], v[180:183], v[212:215], v[124:127]
    ds_read_b64_tr_b16 v[180:181], v19 offset:50304
    ds_read_b64_tr_b16 v[182:183], v19 offset:52096
    s_waitcnt lgkmcnt(15)
    v_mfma_f32_16x16x32_bf16 v[72:75], v[184:187], v[208:211], v[72:75]
    v_mfma_f32_16x16x32_bf16 v[128:131], v[184:187], v[212:215], v[128:131]
    ds_read_b64_tr_b16 v[184:185], v19 offset:50336
    ds_read_b64_tr_b16 v[186:187], v19 offset:52128
    v_mfma_f32_16x16x32_bf16 v[76:79], v[188:191], v[208:211], v[76:79]
    v_mfma_f32_16x16x32_bf16 v[132:135], v[188:191], v[212:215], v[132:135]
    ds_read_b64_tr_b16 v[188:189], v19 offset:50368
    ds_read_b64_tr_b16 v[190:191], v19 offset:52160
    s_waitcnt vmcnt(6)
    s_mov_b32 s47, 17408
    buffer_load_dwordx4 v[208:211], v10, s[4:7], s47 offen
    buffer_load_dwordx4 v[212:215], v11, s[4:7], s47 offen
    v_mfma_f32_16x16x32_bf16 v[24:27], v[136:139], v[216:219], v[24:27]
    v_mfma_f32_16x16x32_bf16 v[80:83], v[136:139], v[220:223], v[80:83]
    v_mfma_f32_16x16x32_bf16 v[28:31], v[140:143], v[216:219], v[28:31]
    v_mfma_f32_16x16x32_bf16 v[84:87], v[140:143], v[220:223], v[84:87]
    v_mfma_f32_16x16x32_bf16 v[32:35], v[144:147], v[216:219], v[32:35]
    v_mfma_f32_16x16x32_bf16 v[88:91], v[144:147], v[220:223], v[88:91]
    v_mfma_f32_16x16x32_bf16 v[36:39], v[148:151], v[216:219], v[36:39]
    v_mfma_f32_16x16x32_bf16 v[92:95], v[148:151], v[220:223], v[92:95]
    s_waitcnt lgkmcnt(15)
    v_mfma_f32_16x16x32_bf16 v[40:43], v[152:155], v[216:219], v[40:43]
    v_mfma_f32_16x16x32_bf16 v[96:99], v[152:155], v[220:223], v[96:99]
    s_waitcnt lgkmcnt(0)
    s_barrier
    ds_read_b64_tr_b16 v[136:137], v16 offset:57344
    ds_read_b64_tr_b16 v[138:139], v16 offset:59136
    ds_read_b64_tr_b16 v[140:141], v16 offset:57376
    ds_read_b64_tr_b16 v[142:143], v16 offset:59168
    ds_read_b64_tr_b16 v[144:145], v16 offset:57408
    ds_read_b64_tr_b16 v[146:147], v16 offset:59200
    ds_read_b64_tr_b16 v[148:149], v16 offset:57440
    ds_read_b64_tr_b16 v[150:151], v16 offset:59232
    ds_read_b64_tr_b16 v[152:153], v16 offset:57472
    ds_read_b64_tr_b16 v[154:155], v16 offset:59264
    v_mfma_f32_16x16x32_bf16 v[44:47], v[156:159], v[216:219], v[44:47]
    v_mfma_f32_16x16x32_bf16 v[100:103], v[156:159], v[220:223], v[100:103]
    ds_read_b64_tr_b16 v[156:157], v16 offset:57504
    ds_read_b64_tr_b16 v[158:159], v16 offset:59296
    v_mfma_f32_16x16x32_bf16 v[48:51], v[160:163], v[216:219], v[48:51]
    v_mfma_f32_16x16x32_bf16 v[104:107], v[160:163], v[220:223], v[104:107]
    ds_read_b64_tr_b16 v[160:161], v16 offset:57536
    ds_read_b64_tr_b16 v[162:163], v16 offset:59328
    v_mfma_f32_16x16x32_bf16 v[52:55], v[164:167], v[216:219], v[52:55]
    v_mfma_f32_16x16x32_bf16 v[108:111], v[164:167], v[220:223], v[108:111]
    ds_read_b64_tr_b16 v[164:165], v20 offset:6144
    ds_read_b64_tr_b16 v[166:167], v20 offset:7936
    v_mfma_f32_16x16x32_bf16 v[56:59], v[168:171], v[216:219], v[56:59]
    v_mfma_f32_16x16x32_bf16 v[112:115], v[168:171], v[220:223], v[112:115]
    ds_read_b64_tr_b16 v[168:169], v20 offset:6176
    ds_read_b64_tr_b16 v[170:171], v20 offset:7968
    v_mfma_f32_16x16x32_bf16 v[60:63], v[172:175], v[216:219], v[60:63]
    v_mfma_f32_16x16x32_bf16 v[116:119], v[172:175], v[220:223], v[116:119]
    ds_read_b64_tr_b16 v[172:173], v20 offset:6208
    ds_read_b64_tr_b16 v[174:175], v20 offset:8000
    v_mfma_f32_16x16x32_bf16 v[64:67], v[176:179], v[216:219], v[64:67]
    v_mfma_f32_16x16x32_bf16 v[120:123], v[176:179], v[220:223], v[120:123]
    ds_read_b64_tr_b16 v[176:177], v20 offset:6240
    ds_read_b64_tr_b16 v[178:179], v20 offset:8032
    v_mfma_f32_16x16x32_bf16 v[68:71], v[180:183], v[216:219], v[68:71]
    v_mfma_f32_16x16x32_bf16 v[124:127], v[180:183], v[220:223], v[124:127]
    ds_read_b64_tr_b16 v[180:181], v20 offset:6272
    ds_read_b64_tr_b16 v[182:183], v20 offset:8064
    v_mfma_f32_16x16x32_bf16 v[72:75], v[184:187], v[216:219], v[72:75]
    v_mfma_f32_16x16x32_bf16 v[128:131], v[184:187], v[220:223], v[128:131]
    ds_read_b64_tr_b16 v[184:185], v20 offset:6304
    ds_read_b64_tr_b16 v[186:187], v20 offset:8096
    v_mfma_f32_16x16x32_bf16 v[76:79], v[188:191], v[216:219], v[76:79]
    v_mfma_f32_16x16x32_bf16 v[132:135], v[188:191], v[220:223], v[132:135]
    ds_read_b64_tr_b16 v[188:189], v20 offset:6336
    ds_read_b64_tr_b16 v[190:191], v20 offset:8128
    s_waitcnt vmcnt(6)
    s_mov_b32 s47, 18432
    buffer_load_dwordx4 v[216:219], v10, s[4:7], s47 offen
    buffer_load_dwordx4 v[220:223], v11, s[4:7], s47 offen
    s_waitcnt lgkmcnt(15)
    v_mfma_f32_16x16x32_bf16 v[24:27], v[136:139], v[224:227], v[24:27]
    v_mfma_f32_16x16x32_bf16 v[80:83], v[136:139], v[228:231], v[80:83]
    ds_read_b64_tr_b16 v[136:137], v16 offset:64512
    ds_read_b64_tr_b16 v[138:139], v17 offset:768
    v_mfma_f32_16x16x32_bf16 v[28:31], v[140:143], v[224:227], v[28:31]
    v_mfma_f32_16x16x32_bf16 v[84:87], v[140:143], v[228:231], v[84:87]
    ds_read_b64_tr_b16 v[140:141], v16 offset:64544
    ds_read_b64_tr_b16 v[142:143], v17 offset:800
    v_mfma_f32_16x16x32_bf16 v[32:35], v[144:147], v[224:227], v[32:35]
    v_mfma_f32_16x16x32_bf16 v[88:91], v[144:147], v[228:231], v[88:91]
    ds_read_b64_tr_b16 v[144:145], v16 offset:64576
    ds_read_b64_tr_b16 v[146:147], v17 offset:832
    v_mfma_f32_16x16x32_bf16 v[36:39], v[148:151], v[224:227], v[36:39]
    v_mfma_f32_16x16x32_bf16 v[92:95], v[148:151], v[228:231], v[92:95]
    ds_read_b64_tr_b16 v[148:149], v16 offset:64608
    ds_read_b64_tr_b16 v[150:151], v17 offset:864
    v_mfma_f32_16x16x32_bf16 v[40:43], v[152:155], v[224:227], v[40:43]
    v_mfma_f32_16x16x32_bf16 v[96:99], v[152:155], v[228:231], v[96:99]
    ds_read_b64_tr_b16 v[152:153], v16 offset:64640
    ds_read_b64_tr_b16 v[154:155], v17 offset:896
    v_mfma_f32_16x16x32_bf16 v[44:47], v[156:159], v[224:227], v[44:47]
    v_mfma_f32_16x16x32_bf16 v[100:103], v[156:159], v[228:231], v[100:103]
    ds_read_b64_tr_b16 v[156:157], v16 offset:64672
    ds_read_b64_tr_b16 v[158:159], v17 offset:928
    s_waitcnt lgkmcnt(15)
    v_mfma_f32_16x16x32_bf16 v[48:51], v[160:163], v[224:227], v[48:51]
    v_mfma_f32_16x16x32_bf16 v[104:107], v[160:163], v[228:231], v[104:107]
    ds_read_b64_tr_b16 v[160:161], v16 offset:64704
    ds_read_b64_tr_b16 v[162:163], v17 offset:960
    v_mfma_f32_16x16x32_bf16 v[52:55], v[164:167], v[224:227], v[52:55]
    v_mfma_f32_16x16x32_bf16 v[108:111], v[164:167], v[228:231], v[108:111]
    ds_read_b64_tr_b16 v[164:165], v20 offset:13312
    ds_read_b64_tr_b16 v[166:167], v20 offset:15104
    v_mfma_f32_16x16x32_bf16 v[56:59], v[168:171], v[224:227], v[56:59]
    v_mfma_f32_16x16x32_bf16 v[112:115], v[168:171], v[228:231], v[112:115]
    ds_read_b64_tr_b16 v[168:169], v20 offset:13344
    ds_read_b64_tr_b16 v[170:171], v20 offset:15136
    v_mfma_f32_16x16x32_bf16 v[60:63], v[172:175], v[224:227], v[60:63]
    v_mfma_f32_16x16x32_bf16 v[116:119], v[172:175], v[228:231], v[116:119]
    ds_read_b64_tr_b16 v[172:173], v20 offset:13376
    ds_read_b64_tr_b16 v[174:175], v20 offset:15168
    v_mfma_f32_16x16x32_bf16 v[64:67], v[176:179], v[224:227], v[64:67]
    v_mfma_f32_16x16x32_bf16 v[120:123], v[176:179], v[228:231], v[120:123]
    ds_read_b64_tr_b16 v[176:177], v20 offset:13408
    ds_read_b64_tr_b16 v[178:179], v20 offset:15200
    v_mfma_f32_16x16x32_bf16 v[68:71], v[180:183], v[224:227], v[68:71]
    v_mfma_f32_16x16x32_bf16 v[124:127], v[180:183], v[228:231], v[124:127]
    ds_read_b64_tr_b16 v[180:181], v20 offset:13440
    ds_read_b64_tr_b16 v[182:183], v20 offset:15232
    s_waitcnt lgkmcnt(15)
    v_mfma_f32_16x16x32_bf16 v[72:75], v[184:187], v[224:227], v[72:75]
    v_mfma_f32_16x16x32_bf16 v[128:131], v[184:187], v[228:231], v[128:131]
    ds_read_b64_tr_b16 v[184:185], v20 offset:13472
    ds_read_b64_tr_b16 v[186:187], v20 offset:15264
    v_mfma_f32_16x16x32_bf16 v[76:79], v[188:191], v[224:227], v[76:79]
    v_mfma_f32_16x16x32_bf16 v[132:135], v[188:191], v[228:231], v[132:135]
    ds_read_b64_tr_b16 v[188:189], v20 offset:13504
    ds_read_b64_tr_b16 v[190:191], v20 offset:15296
    s_waitcnt vmcnt(6)
    s_mov_b32 s47, 19456
    buffer_load_dwordx4 v[224:227], v10, s[4:7], s47 offen
    buffer_load_dwordx4 v[228:231], v11, s[4:7], s47 offen
    v_mfma_f32_16x16x32_bf16 v[24:27], v[136:139], v[192:195], v[24:27]
    v_mfma_f32_16x16x32_bf16 v[80:83], v[136:139], v[196:199], v[80:83]
    v_mfma_f32_16x16x32_bf16 v[28:31], v[140:143], v[192:195], v[28:31]
    v_mfma_f32_16x16x32_bf16 v[84:87], v[140:143], v[196:199], v[84:87]
    v_mfma_f32_16x16x32_bf16 v[32:35], v[144:147], v[192:195], v[32:35]
    v_mfma_f32_16x16x32_bf16 v[88:91], v[144:147], v[196:199], v[88:91]
    v_mfma_f32_16x16x32_bf16 v[36:39], v[148:151], v[192:195], v[36:39]
    v_mfma_f32_16x16x32_bf16 v[92:95], v[148:151], v[196:199], v[92:95]
    s_waitcnt lgkmcnt(15)
    v_mfma_f32_16x16x32_bf16 v[40:43], v[152:155], v[192:195], v[40:43]
    v_mfma_f32_16x16x32_bf16 v[96:99], v[152:155], v[196:199], v[96:99]
    s_waitcnt lgkmcnt(0)
    s_barrier
    ds_read_b64_tr_b16 v[136:137], v17 offset:20480
    ds_read_b64_tr_b16 v[138:139], v17 offset:22272
    ds_read_b64_tr_b16 v[140:141], v17 offset:20512
    ds_read_b64_tr_b16 v[142:143], v17 offset:22304
    ds_read_b64_tr_b16 v[144:145], v17 offset:20544
    ds_read_b64_tr_b16 v[146:147], v17 offset:22336
    ds_read_b64_tr_b16 v[148:149], v17 offset:20576
    ds_read_b64_tr_b16 v[150:151], v17 offset:22368
    ds_read_b64_tr_b16 v[152:153], v17 offset:20608
    ds_read_b64_tr_b16 v[154:155], v17 offset:22400
    v_mfma_f32_16x16x32_bf16 v[44:47], v[156:159], v[192:195], v[44:47]
    v_mfma_f32_16x16x32_bf16 v[100:103], v[156:159], v[196:199], v[100:103]
    ds_read_b64_tr_b16 v[156:157], v17 offset:20640
    ds_read_b64_tr_b16 v[158:159], v17 offset:22432
    v_mfma_f32_16x16x32_bf16 v[48:51], v[160:163], v[192:195], v[48:51]
    v_mfma_f32_16x16x32_bf16 v[104:107], v[160:163], v[196:199], v[104:107]
    ds_read_b64_tr_b16 v[160:161], v17 offset:20672
    ds_read_b64_tr_b16 v[162:163], v17 offset:22464
    v_mfma_f32_16x16x32_bf16 v[52:55], v[164:167], v[192:195], v[52:55]
    v_mfma_f32_16x16x32_bf16 v[108:111], v[164:167], v[196:199], v[108:111]
    ds_read_b64_tr_b16 v[164:165], v20 offset:34816
    ds_read_b64_tr_b16 v[166:167], v20 offset:36608
    v_mfma_f32_16x16x32_bf16 v[56:59], v[168:171], v[192:195], v[56:59]
    v_mfma_f32_16x16x32_bf16 v[112:115], v[168:171], v[196:199], v[112:115]
    ds_read_b64_tr_b16 v[168:169], v20 offset:34848
    ds_read_b64_tr_b16 v[170:171], v20 offset:36640
    v_mfma_f32_16x16x32_bf16 v[60:63], v[172:175], v[192:195], v[60:63]
    v_mfma_f32_16x16x32_bf16 v[116:119], v[172:175], v[196:199], v[116:119]
    ds_read_b64_tr_b16 v[172:173], v20 offset:34880
    ds_read_b64_tr_b16 v[174:175], v20 offset:36672
    v_mfma_f32_16x16x32_bf16 v[64:67], v[176:179], v[192:195], v[64:67]
    v_mfma_f32_16x16x32_bf16 v[120:123], v[176:179], v[196:199], v[120:123]
    ds_read_b64_tr_b16 v[176:177], v20 offset:34912
    ds_read_b64_tr_b16 v[178:179], v20 offset:36704
    v_mfma_f32_16x16x32_bf16 v[68:71], v[180:183], v[192:195], v[68:71]
    v_mfma_f32_16x16x32_bf16 v[124:127], v[180:183], v[196:199], v[124:127]
    ds_read_b64_tr_b16 v[180:181], v20 offset:34944
    ds_read_b64_tr_b16 v[182:183], v20 offset:36736
    v_mfma_f32_16x16x32_bf16 v[72:75], v[184:187], v[192:195], v[72:75]
    v_mfma_f32_16x16x32_bf16 v[128:131], v[184:187], v[196:199], v[128:131]
    ds_read_b64_tr_b16 v[184:185], v20 offset:34976
    ds_read_b64_tr_b16 v[186:187], v20 offset:36768
    v_mfma_f32_16x16x32_bf16 v[76:79], v[188:191], v[192:195], v[76:79]
    v_mfma_f32_16x16x32_bf16 v[132:135], v[188:191], v[196:199], v[132:135]
    ds_read_b64_tr_b16 v[188:189], v20 offset:35008
    ds_read_b64_tr_b16 v[190:191], v20 offset:36800
    s_waitcnt vmcnt(6)
    s_waitcnt lgkmcnt(15)
    v_mfma_f32_16x16x32_bf16 v[24:27], v[136:139], v[200:203], v[24:27]
    v_mfma_f32_16x16x32_bf16 v[80:83], v[136:139], v[204:207], v[80:83]
    ds_read_b64_tr_b16 v[136:137], v17 offset:27648
    ds_read_b64_tr_b16 v[138:139], v17 offset:29440
    v_mfma_f32_16x16x32_bf16 v[28:31], v[140:143], v[200:203], v[28:31]
    v_mfma_f32_16x16x32_bf16 v[84:87], v[140:143], v[204:207], v[84:87]
    ds_read_b64_tr_b16 v[140:141], v17 offset:27680
    ds_read_b64_tr_b16 v[142:143], v17 offset:29472
    v_mfma_f32_16x16x32_bf16 v[32:35], v[144:147], v[200:203], v[32:35]
    v_mfma_f32_16x16x32_bf16 v[88:91], v[144:147], v[204:207], v[88:91]
    ds_read_b64_tr_b16 v[144:145], v17 offset:27712
    ds_read_b64_tr_b16 v[146:147], v17 offset:29504
    v_mfma_f32_16x16x32_bf16 v[36:39], v[148:151], v[200:203], v[36:39]
    v_mfma_f32_16x16x32_bf16 v[92:95], v[148:151], v[204:207], v[92:95]
    ds_read_b64_tr_b16 v[148:149], v17 offset:27744
    ds_read_b64_tr_b16 v[150:151], v17 offset:29536
    v_mfma_f32_16x16x32_bf16 v[40:43], v[152:155], v[200:203], v[40:43]
    v_mfma_f32_16x16x32_bf16 v[96:99], v[152:155], v[204:207], v[96:99]
    ds_read_b64_tr_b16 v[152:153], v17 offset:27776
    ds_read_b64_tr_b16 v[154:155], v17 offset:29568
    v_mfma_f32_16x16x32_bf16 v[44:47], v[156:159], v[200:203], v[44:47]
    v_mfma_f32_16x16x32_bf16 v[100:103], v[156:159], v[204:207], v[100:103]
    ds_read_b64_tr_b16 v[156:157], v17 offset:27808
    ds_read_b64_tr_b16 v[158:159], v17 offset:29600
    s_waitcnt lgkmcnt(15)
    v_mfma_f32_16x16x32_bf16 v[48:51], v[160:163], v[200:203], v[48:51]
    v_mfma_f32_16x16x32_bf16 v[104:107], v[160:163], v[204:207], v[104:107]
    ds_read_b64_tr_b16 v[160:161], v17 offset:27840
    ds_read_b64_tr_b16 v[162:163], v17 offset:29632
    v_mfma_f32_16x16x32_bf16 v[52:55], v[164:167], v[200:203], v[52:55]
    v_mfma_f32_16x16x32_bf16 v[108:111], v[164:167], v[204:207], v[108:111]
    ds_read_b64_tr_b16 v[164:165], v20 offset:41984
    ds_read_b64_tr_b16 v[166:167], v20 offset:43776
    v_mfma_f32_16x16x32_bf16 v[56:59], v[168:171], v[200:203], v[56:59]
    v_mfma_f32_16x16x32_bf16 v[112:115], v[168:171], v[204:207], v[112:115]
    ds_read_b64_tr_b16 v[168:169], v20 offset:42016
    ds_read_b64_tr_b16 v[170:171], v20 offset:43808
    v_mfma_f32_16x16x32_bf16 v[60:63], v[172:175], v[200:203], v[60:63]
    v_mfma_f32_16x16x32_bf16 v[116:119], v[172:175], v[204:207], v[116:119]
    ds_read_b64_tr_b16 v[172:173], v20 offset:42048
    ds_read_b64_tr_b16 v[174:175], v20 offset:43840
    v_mfma_f32_16x16x32_bf16 v[64:67], v[176:179], v[200:203], v[64:67]
    v_mfma_f32_16x16x32_bf16 v[120:123], v[176:179], v[204:207], v[120:123]
    ds_read_b64_tr_b16 v[176:177], v20 offset:42080
    ds_read_b64_tr_b16 v[178:179], v20 offset:43872
    v_mfma_f32_16x16x32_bf16 v[68:71], v[180:183], v[200:203], v[68:71]
    v_mfma_f32_16x16x32_bf16 v[124:127], v[180:183], v[204:207], v[124:127]
    ds_read_b64_tr_b16 v[180:181], v20 offset:42112
    ds_read_b64_tr_b16 v[182:183], v20 offset:43904
    s_waitcnt lgkmcnt(15)
    v_mfma_f32_16x16x32_bf16 v[72:75], v[184:187], v[200:203], v[72:75]
    v_mfma_f32_16x16x32_bf16 v[128:131], v[184:187], v[204:207], v[128:131]
    ds_read_b64_tr_b16 v[184:185], v20 offset:42144
    ds_read_b64_tr_b16 v[186:187], v20 offset:43936
    v_mfma_f32_16x16x32_bf16 v[76:79], v[188:191], v[200:203], v[76:79]
    v_mfma_f32_16x16x32_bf16 v[132:135], v[188:191], v[204:207], v[132:135]
    ds_read_b64_tr_b16 v[188:189], v20 offset:42176
    ds_read_b64_tr_b16 v[190:191], v20 offset:43968
    s_waitcnt vmcnt(4)
    v_mfma_f32_16x16x32_bf16 v[24:27], v[136:139], v[208:211], v[24:27]
    v_mfma_f32_16x16x32_bf16 v[80:83], v[136:139], v[212:215], v[80:83]
    v_mfma_f32_16x16x32_bf16 v[28:31], v[140:143], v[208:211], v[28:31]
    v_mfma_f32_16x16x32_bf16 v[84:87], v[140:143], v[212:215], v[84:87]
    v_mfma_f32_16x16x32_bf16 v[32:35], v[144:147], v[208:211], v[32:35]
    v_mfma_f32_16x16x32_bf16 v[88:91], v[144:147], v[212:215], v[88:91]
    v_mfma_f32_16x16x32_bf16 v[36:39], v[148:151], v[208:211], v[36:39]
    v_mfma_f32_16x16x32_bf16 v[92:95], v[148:151], v[212:215], v[92:95]
    s_waitcnt lgkmcnt(15)
    v_mfma_f32_16x16x32_bf16 v[40:43], v[152:155], v[208:211], v[40:43]
    v_mfma_f32_16x16x32_bf16 v[96:99], v[152:155], v[212:215], v[96:99]
    s_waitcnt lgkmcnt(0)
    s_barrier
    ds_read_b64_tr_b16 v[136:137], v17 offset:49152
    ds_read_b64_tr_b16 v[138:139], v17 offset:50944
    ds_read_b64_tr_b16 v[140:141], v17 offset:49184
    ds_read_b64_tr_b16 v[142:143], v17 offset:50976
    ds_read_b64_tr_b16 v[144:145], v17 offset:49216
    ds_read_b64_tr_b16 v[146:147], v17 offset:51008
    ds_read_b64_tr_b16 v[148:149], v17 offset:49248
    ds_read_b64_tr_b16 v[150:151], v17 offset:51040
    ds_read_b64_tr_b16 v[152:153], v17 offset:49280
    ds_read_b64_tr_b16 v[154:155], v17 offset:51072
    v_mfma_f32_16x16x32_bf16 v[44:47], v[156:159], v[208:211], v[44:47]
    v_mfma_f32_16x16x32_bf16 v[100:103], v[156:159], v[212:215], v[100:103]
    ds_read_b64_tr_b16 v[156:157], v17 offset:49312
    ds_read_b64_tr_b16 v[158:159], v17 offset:51104
    v_mfma_f32_16x16x32_bf16 v[48:51], v[160:163], v[208:211], v[48:51]
    v_mfma_f32_16x16x32_bf16 v[104:107], v[160:163], v[212:215], v[104:107]
    ds_read_b64_tr_b16 v[160:161], v17 offset:49344
    ds_read_b64_tr_b16 v[162:163], v17 offset:51136
    v_mfma_f32_16x16x32_bf16 v[52:55], v[164:167], v[208:211], v[52:55]
    v_mfma_f32_16x16x32_bf16 v[108:111], v[164:167], v[212:215], v[108:111]
    ds_read_b64_tr_b16 v[164:165], v20 offset:63488
    ds_read_b64_tr_b16 v[166:167], v20 offset:65280
    v_mfma_f32_16x16x32_bf16 v[56:59], v[168:171], v[208:211], v[56:59]
    v_mfma_f32_16x16x32_bf16 v[112:115], v[168:171], v[212:215], v[112:115]
    ds_read_b64_tr_b16 v[168:169], v20 offset:63520
    ds_read_b64_tr_b16 v[170:171], v20 offset:65312
    v_mfma_f32_16x16x32_bf16 v[60:63], v[172:175], v[208:211], v[60:63]
    v_mfma_f32_16x16x32_bf16 v[116:119], v[172:175], v[212:215], v[116:119]
    ds_read_b64_tr_b16 v[172:173], v20 offset:63552
    ds_read_b64_tr_b16 v[174:175], v20 offset:65344
    v_mfma_f32_16x16x32_bf16 v[64:67], v[176:179], v[208:211], v[64:67]
    v_mfma_f32_16x16x32_bf16 v[120:123], v[176:179], v[212:215], v[120:123]
    ds_read_b64_tr_b16 v[176:177], v20 offset:63584
    ds_read_b64_tr_b16 v[178:179], v20 offset:65376
    v_mfma_f32_16x16x32_bf16 v[68:71], v[180:183], v[208:211], v[68:71]
    v_mfma_f32_16x16x32_bf16 v[124:127], v[180:183], v[212:215], v[124:127]
    ds_read_b64_tr_b16 v[180:181], v20 offset:63616
    ds_read_b64_tr_b16 v[182:183], v20 offset:65408
    v_mfma_f32_16x16x32_bf16 v[72:75], v[184:187], v[208:211], v[72:75]
    v_mfma_f32_16x16x32_bf16 v[128:131], v[184:187], v[212:215], v[128:131]
    ds_read_b64_tr_b16 v[184:185], v20 offset:63648
    ds_read_b64_tr_b16 v[186:187], v20 offset:65440
    v_mfma_f32_16x16x32_bf16 v[76:79], v[188:191], v[208:211], v[76:79]
    v_mfma_f32_16x16x32_bf16 v[132:135], v[188:191], v[212:215], v[132:135]
    ds_read_b64_tr_b16 v[188:189], v20 offset:63680
    ds_read_b64_tr_b16 v[190:191], v20 offset:65472
    s_waitcnt vmcnt(2)
    s_waitcnt lgkmcnt(15)
    v_mfma_f32_16x16x32_bf16 v[24:27], v[136:139], v[216:219], v[24:27]
    v_mfma_f32_16x16x32_bf16 v[80:83], v[136:139], v[220:223], v[80:83]
    ds_read_b64_tr_b16 v[136:137], v17 offset:56320
    ds_read_b64_tr_b16 v[138:139], v17 offset:58112
    v_mfma_f32_16x16x32_bf16 v[28:31], v[140:143], v[216:219], v[28:31]
    v_mfma_f32_16x16x32_bf16 v[84:87], v[140:143], v[220:223], v[84:87]
    ds_read_b64_tr_b16 v[140:141], v17 offset:56352
    ds_read_b64_tr_b16 v[142:143], v17 offset:58144
    v_mfma_f32_16x16x32_bf16 v[32:35], v[144:147], v[216:219], v[32:35]
    v_mfma_f32_16x16x32_bf16 v[88:91], v[144:147], v[220:223], v[88:91]
    ds_read_b64_tr_b16 v[144:145], v17 offset:56384
    ds_read_b64_tr_b16 v[146:147], v17 offset:58176
    v_mfma_f32_16x16x32_bf16 v[36:39], v[148:151], v[216:219], v[36:39]
    v_mfma_f32_16x16x32_bf16 v[92:95], v[148:151], v[220:223], v[92:95]
    ds_read_b64_tr_b16 v[148:149], v17 offset:56416
    ds_read_b64_tr_b16 v[150:151], v17 offset:58208
    v_mfma_f32_16x16x32_bf16 v[40:43], v[152:155], v[216:219], v[40:43]
    v_mfma_f32_16x16x32_bf16 v[96:99], v[152:155], v[220:223], v[96:99]
    ds_read_b64_tr_b16 v[152:153], v17 offset:56448
    ds_read_b64_tr_b16 v[154:155], v17 offset:58240
    v_mfma_f32_16x16x32_bf16 v[44:47], v[156:159], v[216:219], v[44:47]
    v_mfma_f32_16x16x32_bf16 v[100:103], v[156:159], v[220:223], v[100:103]
    ds_read_b64_tr_b16 v[156:157], v17 offset:56480
    ds_read_b64_tr_b16 v[158:159], v17 offset:58272
    s_waitcnt lgkmcnt(15)
    v_mfma_f32_16x16x32_bf16 v[48:51], v[160:163], v[216:219], v[48:51]
    v_mfma_f32_16x16x32_bf16 v[104:107], v[160:163], v[220:223], v[104:107]
    ds_read_b64_tr_b16 v[160:161], v17 offset:56512
    ds_read_b64_tr_b16 v[162:163], v17 offset:58304
    v_mfma_f32_16x16x32_bf16 v[52:55], v[164:167], v[216:219], v[52:55]
    v_mfma_f32_16x16x32_bf16 v[108:111], v[164:167], v[220:223], v[108:111]
    ds_read_b64_tr_b16 v[164:165], v21 offset:5120
    ds_read_b64_tr_b16 v[166:167], v21 offset:6912
    v_mfma_f32_16x16x32_bf16 v[56:59], v[168:171], v[216:219], v[56:59]
    v_mfma_f32_16x16x32_bf16 v[112:115], v[168:171], v[220:223], v[112:115]
    ds_read_b64_tr_b16 v[168:169], v21 offset:5152
    ds_read_b64_tr_b16 v[170:171], v21 offset:6944
    v_mfma_f32_16x16x32_bf16 v[60:63], v[172:175], v[216:219], v[60:63]
    v_mfma_f32_16x16x32_bf16 v[116:119], v[172:175], v[220:223], v[116:119]
    ds_read_b64_tr_b16 v[172:173], v21 offset:5184
    ds_read_b64_tr_b16 v[174:175], v21 offset:6976
    v_mfma_f32_16x16x32_bf16 v[64:67], v[176:179], v[216:219], v[64:67]
    v_mfma_f32_16x16x32_bf16 v[120:123], v[176:179], v[220:223], v[120:123]
    ds_read_b64_tr_b16 v[176:177], v21 offset:5216
    ds_read_b64_tr_b16 v[178:179], v21 offset:7008
    v_mfma_f32_16x16x32_bf16 v[68:71], v[180:183], v[216:219], v[68:71]
    v_mfma_f32_16x16x32_bf16 v[124:127], v[180:183], v[220:223], v[124:127]
    ds_read_b64_tr_b16 v[180:181], v21 offset:5248
    ds_read_b64_tr_b16 v[182:183], v21 offset:7040
    s_waitcnt lgkmcnt(15)
    v_mfma_f32_16x16x32_bf16 v[72:75], v[184:187], v[216:219], v[72:75]
    v_mfma_f32_16x16x32_bf16 v[128:131], v[184:187], v[220:223], v[128:131]
    ds_read_b64_tr_b16 v[184:185], v21 offset:5280
    ds_read_b64_tr_b16 v[186:187], v21 offset:7072
    v_mfma_f32_16x16x32_bf16 v[76:79], v[188:191], v[216:219], v[76:79]
    v_mfma_f32_16x16x32_bf16 v[132:135], v[188:191], v[220:223], v[132:135]
    ds_read_b64_tr_b16 v[188:189], v21 offset:5312
    ds_read_b64_tr_b16 v[190:191], v21 offset:7104
    s_waitcnt vmcnt(0)
    v_mfma_f32_16x16x32_bf16 v[24:27], v[136:139], v[224:227], v[24:27]
    v_mfma_f32_16x16x32_bf16 v[80:83], v[136:139], v[228:231], v[80:83]
    v_mfma_f32_16x16x32_bf16 v[28:31], v[140:143], v[224:227], v[28:31]
    v_mfma_f32_16x16x32_bf16 v[84:87], v[140:143], v[228:231], v[84:87]
    v_mfma_f32_16x16x32_bf16 v[32:35], v[144:147], v[224:227], v[32:35]
    v_mfma_f32_16x16x32_bf16 v[88:91], v[144:147], v[228:231], v[88:91]
    v_mfma_f32_16x16x32_bf16 v[36:39], v[148:151], v[224:227], v[36:39]
    v_mfma_f32_16x16x32_bf16 v[92:95], v[148:151], v[228:231], v[92:95]
    s_waitcnt lgkmcnt(15)
    v_mfma_f32_16x16x32_bf16 v[40:43], v[152:155], v[224:227], v[40:43]
    v_mfma_f32_16x16x32_bf16 v[96:99], v[152:155], v[228:231], v[96:99]
    v_mfma_f32_16x16x32_bf16 v[44:47], v[156:159], v[224:227], v[44:47]
    v_mfma_f32_16x16x32_bf16 v[100:103], v[156:159], v[228:231], v[100:103]
    s_waitcnt lgkmcnt(14)
    v_mfma_f32_16x16x32_bf16 v[48:51], v[160:163], v[224:227], v[48:51]
    v_mfma_f32_16x16x32_bf16 v[104:107], v[160:163], v[228:231], v[104:107]
    s_waitcnt lgkmcnt(12)
    v_mfma_f32_16x16x32_bf16 v[52:55], v[164:167], v[224:227], v[52:55]
    v_mfma_f32_16x16x32_bf16 v[108:111], v[164:167], v[228:231], v[108:111]
    s_waitcnt lgkmcnt(10)
    v_mfma_f32_16x16x32_bf16 v[56:59], v[168:171], v[224:227], v[56:59]
    v_mfma_f32_16x16x32_bf16 v[112:115], v[168:171], v[228:231], v[112:115]
    s_waitcnt lgkmcnt(8)
    v_mfma_f32_16x16x32_bf16 v[60:63], v[172:175], v[224:227], v[60:63]
    v_mfma_f32_16x16x32_bf16 v[116:119], v[172:175], v[228:231], v[116:119]
    s_waitcnt lgkmcnt(6)
    v_mfma_f32_16x16x32_bf16 v[64:67], v[176:179], v[224:227], v[64:67]
    v_mfma_f32_16x16x32_bf16 v[120:123], v[176:179], v[228:231], v[120:123]
    s_waitcnt lgkmcnt(4)
    v_mfma_f32_16x16x32_bf16 v[68:71], v[180:183], v[224:227], v[68:71]
    v_mfma_f32_16x16x32_bf16 v[124:127], v[180:183], v[228:231], v[124:127]
    s_waitcnt lgkmcnt(2)
    v_mfma_f32_16x16x32_bf16 v[72:75], v[184:187], v[224:227], v[72:75]
    v_mfma_f32_16x16x32_bf16 v[128:131], v[184:187], v[228:231], v[128:131]
    s_waitcnt lgkmcnt(0)
    v_mfma_f32_16x16x32_bf16 v[76:79], v[188:191], v[224:227], v[76:79]
    v_mfma_f32_16x16x32_bf16 v[132:135], v[188:191], v[228:231], v[132:135]
    s_lshr_b32 s36, s33, 4
    s_lshl_b32 s37, s32, 1
    s_add_u32 s36, s36, s37
    s_mul_i32 s36, s36, 55296
    v_lshl_add_u32 v136, v1, 4, s36
    v_add_u32 v137, 55296, v136
    s_mul_i32 s36, s51, 7
    s_lshr_b32 s38, s36, 1
    s_lshl_b32 s56, s38, 10
    v_lshlrev_b32 v138, 4, v4
    v_add_u32 v138, 143360, v138
    ds_read_b128 v[140:143], v138 offset:0
    ds_read_b128 v[144:147], v138 offset:448
    ds_read_b128 v[148:151], v138 offset:64
    ds_read_b128 v[152:155], v138 offset:512
    ds_read_b128 v[156:159], v138 offset:128
    ds_read_b128 v[160:163], v138 offset:576
    ds_read_b128 v[164:167], v138 offset:192
    ds_read_b128 v[168:171], v138 offset:640
    ds_read_b128 v[172:175], v138 offset:256
    ds_read_b128 v[176:179], v138 offset:704
    ds_read_b128 v[180:183], v138 offset:320
    ds_read_b128 v[184:187], v138 offset:768
    ds_read_b128 v[188:191], v138 offset:384
    ds_read_b128 v[192:195], v138 offset:832
    s_nop 7
    v_mov_b32 v196, v5
    v_mov_b32 v197, v5
    v_mov_b32 v200, v7
    v_mov_b32 v201, v7
    v_mov_b32 v198, v6
    v_mov_b32 v199, v6
    v_mov_b32 v202, v8
    v_mov_b32 v203, v8
    s_waitcnt lgkmcnt(0)
    s_bitcmp1_b32 s51, 0
    s_cbranch_scc1 L_k4_odd
    s_add_u32 s57, s56, 0
    v_pk_fma_f32 v[28:29], v[196:197], v[148:149], v[28:29] neg_lo:[1,0,0] neg_hi:[1,0,0]
    v_pk_fma_f32 v[56:57], v[196:197], v[152:153], v[56:57] neg_lo:[1,0,0] neg_hi:[1,0,0]
    v_pk_fma_f32 v[30:31], v[196:197], v[150:151], v[30:31] neg_lo:[1,0,0] neg_hi:[1,0,0]
    v_pk_fma_f32 v[58:59], v[196:197], v[154:155], v[58:59] neg_lo:[1,0,0] neg_hi:[1,0,0]
    v_pk_mul_f32 v[28:29], v[28:29], v[56:57]
    v_pk_mul_f32 v[30:31], v[30:31], v[58:59]
    v_pk_mul_f32 v[28:29], v[28:29], v[200:201]
    v_pk_mul_f32 v[30:31], v[30:31], v[200:201]
    v_cvt_pk_bf16_f32 v204, v28, v29
    v_cvt_pk_bf16_f32 v205, v30, v31
    v_pk_fma_f32 v[24:25], v[196:197], v[140:141], v[24:25] neg_lo:[1,0,0] neg_hi:[1,0,0]
    v_pk_fma_f32 v[52:53], v[196:197], v[144:145], v[52:53] neg_lo:[1,0,0] neg_hi:[1,0,0]
    v_pk_fma_f32 v[26:27], v[196:197], v[142:143], v[26:27] neg_lo:[1,0,0] neg_hi:[1,0,0]
    v_pk_fma_f32 v[54:55], v[196:197], v[146:147], v[54:55] neg_lo:[1,0,0] neg_hi:[1,0,0]
    v_pk_mul_f32 v[24:25], v[24:25], v[52:53]
    v_pk_mul_f32 v[26:27], v[26:27], v[54:55]
    v_pk_mul_f32 v[24:25], v[24:25], v[200:201]
    v_pk_mul_f32 v[26:27], v[26:27], v[200:201]
    v_cvt_pk_bf16_f32 v52, v24, v25
    v_cvt_pk_bf16_f32 v53, v26, v27
    v_mov_b32 v54, v204
    v_mov_b32 v55, v205
    buffer_store_dwordx4 v[52:55], v136, s[20:23], s57 offen sc1
    v_pk_fma_f32 v[84:85], v[198:199], v[148:149], v[84:85] neg_lo:[1,0,0] neg_hi:[1,0,0]
    v_pk_fma_f32 v[112:113], v[198:199], v[152:153], v[112:113] neg_lo:[1,0,0] neg_hi:[1,0,0]
    v_pk_fma_f32 v[86:87], v[198:199], v[150:151], v[86:87] neg_lo:[1,0,0] neg_hi:[1,0,0]
    v_pk_fma_f32 v[114:115], v[198:199], v[154:155], v[114:115] neg_lo:[1,0,0] neg_hi:[1,0,0]
    v_pk_mul_f32 v[84:85], v[84:85], v[112:113]
    v_pk_mul_f32 v[86:87], v[86:87], v[114:115]
    v_pk_mul_f32 v[84:85], v[84:85], v[202:203]
    v_pk_mul_f32 v[86:87], v[86:87], v[202:203]
    v_cvt_pk_bf16_f32 v206, v84, v85
    v_cvt_pk_bf16_f32 v207, v86, v87
    v_pk_fma_f32 v[80:81], v[198:199], v[140:141], v[80:81] neg_lo:[1,0,0] neg_hi:[1,0,0]
    v_pk_fma_f32 v[108:109], v[198:199], v[144:145], v[108:109] neg_lo:[1,0,0] neg_hi:[1,0,0]
    v_pk_fma_f32 v[82:83], v[198:199], v[142:143], v[82:83] neg_lo:[1,0,0] neg_hi:[1,0,0]
    v_pk_fma_f32 v[110:111], v[198:199], v[146:147], v[110:111] neg_lo:[1,0,0] neg_hi:[1,0,0]
    v_pk_mul_f32 v[80:81], v[80:81], v[108:109]
    v_pk_mul_f32 v[82:83], v[82:83], v[110:111]
    v_pk_mul_f32 v[80:81], v[80:81], v[202:203]
    v_pk_mul_f32 v[82:83], v[82:83], v[202:203]
    v_cvt_pk_bf16_f32 v108, v80, v81
    v_cvt_pk_bf16_f32 v109, v82, v83
    v_mov_b32 v110, v206
    v_mov_b32 v111, v207
    buffer_store_dwordx4 v[108:111], v137, s[20:23], s57 offen sc1
    s_add_u32 s57, s56, 1024
    v_pk_fma_f32 v[36:37], v[196:197], v[164:165], v[36:37] neg_lo:[1,0,0] neg_hi:[1,0,0]
    v_pk_fma_f32 v[64:65], v[196:197], v[168:169], v[64:65] neg_lo:[1,0,0] neg_hi:[1,0,0]
    v_pk_fma_f32 v[38:39], v[196:197], v[166:167], v[38:39] neg_lo:[1,0,0] neg_hi:[1,0,0]
    v_pk_fma_f32 v[66:67], v[196:197], v[170:171], v[66:67] neg_lo:[1,0,0] neg_hi:[1,0,0]
    v_pk_mul_f32 v[36:37], v[36:37], v[64:65]
    v_pk_mul_f32 v[38:39], v[38:39], v[66:67]
    v_pk_mul_f32 v[36:37], v[36:37], v[200:201]
    v_pk_mul_f32 v[38:39], v[38:39], v[200:201]
    v_cvt_pk_bf16_f32 v204, v36, v37
    v_cvt_pk_bf16_f32 v205, v38, v39
    v_pk_fma_f32 v[32:33], v[196:197], v[156:157], v[32:33] neg_lo:[1,0,0] neg_hi:[1,0,0]
    v_pk_fma_f32 v[60:61], v[196:197], v[160:161], v[60:61] neg_lo:[1,0,0] neg_hi:[1,0,0]
    v_pk_fma_f32 v[34:35], v[196:197], v[158:159], v[34:35] neg_lo:[1,0,0] neg_hi:[1,0,0]
    v_pk_fma_f32 v[62:63], v[196:197], v[162:163], v[62:63] neg_lo:[1,0,0] neg_hi:[1,0,0]
    v_pk_mul_f32 v[32:33], v[32:33], v[60:61]
    v_pk_mul_f32 v[34:35], v[34:35], v[62:63]
    v_pk_mul_f32 v[32:33], v[32:33], v[200:201]
    v_pk_mul_f32 v[34:35], v[34:35], v[200:201]
    v_cvt_pk_bf16_f32 v60, v32, v33
    v_cvt_pk_bf16_f32 v61, v34, v35
    v_mov_b32 v62, v204
    v_mov_b32 v63, v205
    buffer_store_dwordx4 v[60:63], v136, s[20:23], s57 offen sc1
    v_pk_fma_f32 v[92:93], v[198:199], v[164:165], v[92:93] neg_lo:[1,0,0] neg_hi:[1,0,0]
    v_pk_fma_f32 v[120:121], v[198:199], v[168:169], v[120:121] neg_lo:[1,0,0] neg_hi:[1,0,0]
    v_pk_fma_f32 v[94:95], v[198:199], v[166:167], v[94:95] neg_lo:[1,0,0] neg_hi:[1,0,0]
    v_pk_fma_f32 v[122:123], v[198:199], v[170:171], v[122:123] neg_lo:[1,0,0] neg_hi:[1,0,0]
    v_pk_mul_f32 v[92:93], v[92:93], v[120:121]
    v_pk_mul_f32 v[94:95], v[94:95], v[122:123]
    v_pk_mul_f32 v[92:93], v[92:93], v[202:203]
    v_pk_mul_f32 v[94:95], v[94:95], v[202:203]
    v_cvt_pk_bf16_f32 v206, v92, v93
    v_cvt_pk_bf16_f32 v207, v94, v95
    v_pk_fma_f32 v[88:89], v[198:199], v[156:157], v[88:89] neg_lo:[1,0,0] neg_hi:[1,0,0]
    v_pk_fma_f32 v[116:117], v[198:199], v[160:161], v[116:117] neg_lo:[1,0,0] neg_hi:[1,0,0]
    v_pk_fma_f32 v[90:91], v[198:199], v[158:159], v[90:91] neg_lo:[1,0,0] neg_hi:[1,0,0]
    v_pk_fma_f32 v[118:119], v[198:199], v[162:163], v[118:119] neg_lo:[1,0,0] neg_hi:[1,0,0]
    v_pk_mul_f32 v[88:89], v[88:89], v[116:117]
    v_pk_mul_f32 v[90:91], v[90:91], v[118:119]
    v_pk_mul_f32 v[88:89], v[88:89], v[202:203]
    v_pk_mul_f32 v[90:91], v[90:91], v[202:203]
    v_cvt_pk_bf16_f32 v116, v88, v89
    v_cvt_pk_bf16_f32 v117, v90, v91
    v_mov_b32 v118, v206
    v_mov_b32 v119, v207
    buffer_store_dwordx4 v[116:119], v137, s[20:23], s57 offen sc1
    s_add_u32 s57, s56, 2048
    v_pk_fma_f32 v[44:45], v[196:197], v[180:181], v[44:45] neg_lo:[1,0,0] neg_hi:[1,0,0]
    v_pk_fma_f32 v[72:73], v[196:197], v[184:185], v[72:73] neg_lo:[1,0,0] neg_hi:[1,0,0]
    v_pk_fma_f32 v[46:47], v[196:197], v[182:183], v[46:47] neg_lo:[1,0,0] neg_hi:[1,0,0]
    v_pk_fma_f32 v[74:75], v[196:197], v[186:187], v[74:75] neg_lo:[1,0,0] neg_hi:[1,0,0]
    v_pk_mul_f32 v[44:45], v[44:45], v[72:73]
    v_pk_mul_f32 v[46:47], v[46:47], v[74:75]
    v_pk_mul_f32 v[44:45], v[44:45], v[200:201]
    v_pk_mul_f32 v[46:47], v[46:47], v[200:201]
    v_cvt_pk_bf16_f32 v204, v44, v45
    v_cvt_pk_bf16_f32 v205, v46, v47
    v_pk_fma_f32 v[40:41], v[196:197], v[172:173], v[40:41] neg_lo:[1,0,0] neg_hi:[1,0,0]
    v_pk_fma_f32 v[68:69], v[196:197], v[176:177], v[68:69] neg_lo:[1,0,0] neg_hi:[1,0,0]
    v_pk_fma_f32 v[42:43], v[196:197], v[174:175], v[42:43] neg_lo:[1,0,0] neg_hi:[1,0,0]
    v_pk_fma_f32 v[70:71], v[196:197], v[178:179], v[70:71] neg_lo:[1,0,0] neg_hi:[1,0,0]
    v_pk_mul_f32 v[40:41], v[40:41], v[68:69]
    v_pk_mul_f32 v[42:43], v[42:43], v[70:71]
    v_pk_mul_f32 v[40:41], v[40:41], v[200:201]
    v_pk_mul_f32 v[42:43], v[42:43], v[200:201]
    v_cvt_pk_bf16_f32 v68, v40, v41
    v_cvt_pk_bf16_f32 v69, v42, v43
    v_mov_b32 v70, v204
    v_mov_b32 v71, v205
    buffer_store_dwordx4 v[68:71], v136, s[20:23], s57 offen sc1
    v_pk_fma_f32 v[100:101], v[198:199], v[180:181], v[100:101] neg_lo:[1,0,0] neg_hi:[1,0,0]
    v_pk_fma_f32 v[128:129], v[198:199], v[184:185], v[128:129] neg_lo:[1,0,0] neg_hi:[1,0,0]
    v_pk_fma_f32 v[102:103], v[198:199], v[182:183], v[102:103] neg_lo:[1,0,0] neg_hi:[1,0,0]
    v_pk_fma_f32 v[130:131], v[198:199], v[186:187], v[130:131] neg_lo:[1,0,0] neg_hi:[1,0,0]
    v_pk_mul_f32 v[100:101], v[100:101], v[128:129]
    v_pk_mul_f32 v[102:103], v[102:103], v[130:131]
    v_pk_mul_f32 v[100:101], v[100:101], v[202:203]
    v_pk_mul_f32 v[102:103], v[102:103], v[202:203]
    v_cvt_pk_bf16_f32 v206, v100, v101
    v_cvt_pk_bf16_f32 v207, v102, v103
    v_pk_fma_f32 v[96:97], v[198:199], v[172:173], v[96:97] neg_lo:[1,0,0] neg_hi:[1,0,0]
    v_pk_fma_f32 v[124:125], v[198:199], v[176:177], v[124:125] neg_lo:[1,0,0] neg_hi:[1,0,0]
    v_pk_fma_f32 v[98:99], v[198:199], v[174:175], v[98:99] neg_lo:[1,0,0] neg_hi:[1,0,0]
    v_pk_fma_f32 v[126:127], v[198:199], v[178:179], v[126:127] neg_lo:[1,0,0] neg_hi:[1,0,0]
    v_pk_mul_f32 v[96:97], v[96:97], v[124:125]
    v_pk_mul_f32 v[98:99], v[98:99], v[126:127]
    v_pk_mul_f32 v[96:97], v[96:97], v[202:203]
    v_pk_mul_f32 v[98:99], v[98:99], v[202:203]
    v_cvt_pk_bf16_f32 v124, v96, v97
    v_cvt_pk_bf16_f32 v125, v98, v99
    v_mov_b32 v126, v206
    v_mov_b32 v127, v207
    buffer_store_dwordx4 v[124:127], v137, s[20:23], s57 offen sc1
    s_add_u32 s57, s56, 3072
    v_pk_fma_f32 v[48:49], v[196:197], v[188:189], v[48:49] neg_lo:[1,0,0] neg_hi:[1,0,0]
    v_pk_fma_f32 v[76:77], v[196:197], v[192:193], v[76:77] neg_lo:[1,0,0] neg_hi:[1,0,0]
    v_pk_fma_f32 v[50:51], v[196:197], v[190:191], v[50:51] neg_lo:[1,0,0] neg_hi:[1,0,0]
    v_pk_fma_f32 v[78:79], v[196:197], v[194:195], v[78:79] neg_lo:[1,0,0] neg_hi:[1,0,0]
    v_pk_mul_f32 v[48:49], v[48:49], v[76:77]
    v_pk_mul_f32 v[50:51], v[50:51], v[78:79]
    v_pk_mul_f32 v[48:49], v[48:49], v[200:201]
    v_pk_mul_f32 v[50:51], v[50:51], v[200:201]
    v_cvt_pk_bf16_f32 v76, v48, v49
    v_cvt_pk_bf16_f32 v77, v50, v51
    buffer_store_dwordx2 v[76:77], v136, s[20:23], s57 offen offset:0 sc1
    v_pk_fma_f32 v[104:105], v[198:199], v[188:189], v[104:105] neg_lo:[1,0,0] neg_hi:[1,0,0]
    v_pk_fma_f32 v[132:133], v[198:199], v[192:193], v[132:133] neg_lo:[1,0,0] neg_hi:[1,0,0]
    v_pk_fma_f32 v[106:107], v[198:199], v[190:191], v[106:107] neg_lo:[1,0,0] neg_hi:[1,0,0]
    v_pk_fma_f32 v[134:135], v[198:199], v[194:195], v[134:135] neg_lo:[1,0,0] neg_hi:[1,0,0]
    v_pk_mul_f32 v[104:105], v[104:105], v[132:133]
    v_pk_mul_f32 v[106:107], v[106:107], v[134:135]
    v_pk_mul_f32 v[104:105], v[104:105], v[202:203]
    v_pk_mul_f32 v[106:107], v[106:107], v[202:203]
    v_cvt_pk_bf16_f32 v132, v104, v105
    v_cvt_pk_bf16_f32 v133, v106, v107
    buffer_store_dwordx2 v[132:133], v137, s[20:23], s57 offen offset:0 sc1
    s_branch L_k4_kernel_end
L_k4_odd:
    s_add_u32 s57, s56, 0
    v_pk_fma_f32 v[24:25], v[196:197], v[140:141], v[24:25] neg_lo:[1,0,0] neg_hi:[1,0,0]
    v_pk_fma_f32 v[52:53], v[196:197], v[144:145], v[52:53] neg_lo:[1,0,0] neg_hi:[1,0,0]
    v_pk_fma_f32 v[26:27], v[196:197], v[142:143], v[26:27] neg_lo:[1,0,0] neg_hi:[1,0,0]
    v_pk_fma_f32 v[54:55], v[196:197], v[146:147], v[54:55] neg_lo:[1,0,0] neg_hi:[1,0,0]
    v_pk_mul_f32 v[24:25], v[24:25], v[52:53]
    v_pk_mul_f32 v[26:27], v[26:27], v[54:55]
    v_pk_mul_f32 v[24:25], v[24:25], v[200:201]
    v_pk_mul_f32 v[26:27], v[26:27], v[200:201]
    v_cvt_pk_bf16_f32 v52, v24, v25
    v_cvt_pk_bf16_f32 v53, v26, v27
    buffer_store_dwordx2 v[52:53], v136, s[20:23], s57 offen offset:8 sc1
    v_pk_fma_f32 v[80:81], v[198:199], v[140:141], v[80:81] neg_lo:[1,0,0] neg_hi:[1,0,0]
    v_pk_fma_f32 v[108:109], v[198:199], v[144:145], v[108:109] neg_lo:[1,0,0] neg_hi:[1,0,0]
    v_pk_fma_f32 v[82:83], v[198:199], v[142:143], v[82:83] neg_lo:[1,0,0] neg_hi:[1,0,0]
    v_pk_fma_f32 v[110:111], v[198:199], v[146:147], v[110:111] neg_lo:[1,0,0] neg_hi:[1,0,0]
    v_pk_mul_f32 v[80:81], v[80:81], v[108:109]
    v_pk_mul_f32 v[82:83], v[82:83], v[110:111]
    v_pk_mul_f32 v[80:81], v[80:81], v[202:203]
    v_pk_mul_f32 v[82:83], v[82:83], v[202:203]
    v_cvt_pk_bf16_f32 v108, v80, v81
    v_cvt_pk_bf16_f32 v109, v82, v83
    buffer_store_dwordx2 v[108:109], v137, s[20:23], s57 offen offset:8 sc1
    s_add_u32 s57, s56, 1024
    v_pk_fma_f32 v[32:33], v[196:197], v[156:157], v[32:33] neg_lo:[1,0,0] neg_hi:[1,0,0]
    v_pk_fma_f32 v[60:61], v[196:197], v[160:161], v[60:61] neg_lo:[1,0,0] neg_hi:[1,0,0]
    v_pk_fma_f32 v[34:35], v[196:197], v[158:159], v[34:35] neg_lo:[1,0,0] neg_hi:[1,0,0]
    v_pk_fma_f32 v[62:63], v[196:197], v[162:163], v[62:63] neg_lo:[1,0,0] neg_hi:[1,0,0]
    v_pk_mul_f32 v[32:33], v[32:33], v[60:61]
    v_pk_mul_f32 v[34:35], v[34:35], v[62:63]
    v_pk_mul_f32 v[32:33], v[32:33], v[200:201]
    v_pk_mul_f32 v[34:35], v[34:35], v[200:201]
    v_cvt_pk_bf16_f32 v204, v32, v33
    v_cvt_pk_bf16_f32 v205, v34, v35
    v_pk_fma_f32 v[28:29], v[196:197], v[148:149], v[28:29] neg_lo:[1,0,0] neg_hi:[1,0,0]
    v_pk_fma_f32 v[56:57], v[196:197], v[152:153], v[56:57] neg_lo:[1,0,0] neg_hi:[1,0,0]
    v_pk_fma_f32 v[30:31], v[196:197], v[150:151], v[30:31] neg_lo:[1,0,0] neg_hi:[1,0,0]
    v_pk_fma_f32 v[58:59], v[196:197], v[154:155], v[58:59] neg_lo:[1,0,0] neg_hi:[1,0,0]
    v_pk_mul_f32 v[28:29], v[28:29], v[56:57]
    v_pk_mul_f32 v[30:31], v[30:31], v[58:59]
    v_pk_mul_f32 v[28:29], v[28:29], v[200:201]
    v_pk_mul_f32 v[30:31], v[30:31], v[200:201]
    v_cvt_pk_bf16_f32 v56, v28, v29
    v_cvt_pk_bf16_f32 v57, v30, v31
    v_mov_b32 v58, v204
    v_mov_b32 v59, v205
    buffer_store_dwordx4 v[56:59], v136, s[20:23], s57 offen sc1
    v_pk_fma_f32 v[88:89], v[198:199], v[156:157], v[88:89] neg_lo:[1,0,0] neg_hi:[1,0,0]
    v_pk_fma_f32 v[116:117], v[198:199], v[160:161], v[116:117] neg_lo:[1,0,0] neg_hi:[1,0,0]
    v_pk_fma_f32 v[90:91], v[198:199], v[158:159], v[90:91] neg_lo:[1,0,0] neg_hi:[1,0,0]
    v_pk_fma_f32 v[118:119], v[198:199], v[162:163], v[118:119] neg_lo:[1,0,0] neg_hi:[1,0,0]
    v_pk_mul_f32 v[88:89], v[88:89], v[116:117]
    v_pk_mul_f32 v[90:91], v[90:91], v[118:119]
    v_pk_mul_f32 v[88:89], v[88:89], v[202:203]
    v_pk_mul_f32 v[90:91], v[90:91], v[202:203]
    v_cvt_pk_bf16_f32 v206, v88, v89
    v_cvt_pk_bf16_f32 v207, v90, v91
    v_pk_fma_f32 v[84:85], v[198:199], v[148:149], v[84:85] neg_lo:[1,0,0] neg_hi:[1,0,0]
    v_pk_fma_f32 v[112:113], v[198:199], v[152:153], v[112:113] neg_lo:[1,0,0] neg_hi:[1,0,0]
    v_pk_fma_f32 v[86:87], v[198:199], v[150:151], v[86:87] neg_lo:[1,0,0] neg_hi:[1,0,0]
    v_pk_fma_f32 v[114:115], v[198:199], v[154:155], v[114:115] neg_lo:[1,0,0] neg_hi:[1,0,0]
    v_pk_mul_f32 v[84:85], v[84:85], v[112:113]
    v_pk_mul_f32 v[86:87], v[86:87], v[114:115]
    v_pk_mul_f32 v[84:85], v[84:85], v[202:203]
    v_pk_mul_f32 v[86:87], v[86:87], v[202:203]
    v_cvt_pk_bf16_f32 v112, v84, v85
    v_cvt_pk_bf16_f32 v113, v86, v87
    v_mov_b32 v114, v206
    v_mov_b32 v115, v207
    buffer_store_dwordx4 v[112:115], v137, s[20:23], s57 offen sc1
    s_cmp_eq_u32 s51, 15
    s_cbranch_scc1 L_k4_kernel_end
    s_add_u32 s57, s56, 2048
    v_pk_fma_f32 v[40:41], v[196:197], v[172:173], v[40:41] neg_lo:[1,0,0] neg_hi:[1,0,0]
    v_pk_fma_f32 v[68:69], v[196:197], v[176:177], v[68:69] neg_lo:[1,0,0] neg_hi:[1,0,0]
    v_pk_fma_f32 v[42:43], v[196:197], v[174:175], v[42:43] neg_lo:[1,0,0] neg_hi:[1,0,0]
    v_pk_fma_f32 v[70:71], v[196:197], v[178:179], v[70:71] neg_lo:[1,0,0] neg_hi:[1,0,0]
    v_pk_mul_f32 v[40:41], v[40:41], v[68:69]
    v_pk_mul_f32 v[42:43], v[42:43], v[70:71]
    v_pk_mul_f32 v[40:41], v[40:41], v[200:201]
    v_pk_mul_f32 v[42:43], v[42:43], v[200:201]
    v_cvt_pk_bf16_f32 v204, v40, v41
    v_cvt_pk_bf16_f32 v205, v42, v43
    v_pk_fma_f32 v[36:37], v[196:197], v[164:165], v[36:37] neg_lo:[1,0,0] neg_hi:[1,0,0]
    v_pk_fma_f32 v[64:65], v[196:197], v[168:169], v[64:65] neg_lo:[1,0,0] neg_hi:[1,0,0]
    v_pk_fma_f32 v[38:39], v[196:197], v[166:167], v[38:39] neg_lo:[1,0,0] neg_hi:[1,0,0]
    v_pk_fma_f32 v[66:67], v[196:197], v[170:171], v[66:67] neg_lo:[1,0,0] neg_hi:[1,0,0]
    v_pk_mul_f32 v[36:37], v[36:37], v[64:65]
    v_pk_mul_f32 v[38:39], v[38:39], v[66:67]
    v_pk_mul_f32 v[36:37], v[36:37], v[200:201]
    v_pk_mul_f32 v[38:39], v[38:39], v[200:201]
    v_cvt_pk_bf16_f32 v64, v36, v37
    v_cvt_pk_bf16_f32 v65, v38, v39
    v_mov_b32 v66, v204
    v_mov_b32 v67, v205
    buffer_store_dwordx4 v[64:67], v136, s[20:23], s57 offen sc1
    v_pk_fma_f32 v[96:97], v[198:199], v[172:173], v[96:97] neg_lo:[1,0,0] neg_hi:[1,0,0]
    v_pk_fma_f32 v[124:125], v[198:199], v[176:177], v[124:125] neg_lo:[1,0,0] neg_hi:[1,0,0]
    v_pk_fma_f32 v[98:99], v[198:199], v[174:175], v[98:99] neg_lo:[1,0,0] neg_hi:[1,0,0]
    v_pk_fma_f32 v[126:127], v[198:199], v[178:179], v[126:127] neg_lo:[1,0,0] neg_hi:[1,0,0]
    v_pk_mul_f32 v[96:97], v[96:97], v[124:125]
    v_pk_mul_f32 v[98:99], v[98:99], v[126:127]
    v_pk_mul_f32 v[96:97], v[96:97], v[202:203]
    v_pk_mul_f32 v[98:99], v[98:99], v[202:203]
    v_cvt_pk_bf16_f32 v206, v96, v97
    v_cvt_pk_bf16_f32 v207, v98, v99
    v_pk_fma_f32 v[92:93], v[198:199], v[164:165], v[92:93] neg_lo:[1,0,0] neg_hi:[1,0,0]
    v_pk_fma_f32 v[120:121], v[198:199], v[168:169], v[120:121] neg_lo:[1,0,0] neg_hi:[1,0,0]
    v_pk_fma_f32 v[94:95], v[198:199], v[166:167], v[94:95] neg_lo:[1,0,0] neg_hi:[1,0,0]
    v_pk_fma_f32 v[122:123], v[198:199], v[170:171], v[122:123] neg_lo:[1,0,0] neg_hi:[1,0,0]
    v_pk_mul_f32 v[92:93], v[92:93], v[120:121]
    v_pk_mul_f32 v[94:95], v[94:95], v[122:123]
    v_pk_mul_f32 v[92:93], v[92:93], v[202:203]
    v_pk_mul_f32 v[94:95], v[94:95], v[202:203]
    v_cvt_pk_bf16_f32 v120, v92, v93
    v_cvt_pk_bf16_f32 v121, v94, v95
    v_mov_b32 v122, v206
    v_mov_b32 v123, v207
    buffer_store_dwordx4 v[120:123], v137, s[20:23], s57 offen sc1
    s_add_u32 s57, s56, 3072
    v_pk_fma_f32 v[48:49], v[196:197], v[188:189], v[48:49] neg_lo:[1,0,0] neg_hi:[1,0,0]
    v_pk_fma_f32 v[76:77], v[196:197], v[192:193], v[76:77] neg_lo:[1,0,0] neg_hi:[1,0,0]
    v_pk_fma_f32 v[50:51], v[196:197], v[190:191], v[50:51] neg_lo:[1,0,0] neg_hi:[1,0,0]
    v_pk_fma_f32 v[78:79], v[196:197], v[194:195], v[78:79] neg_lo:[1,0,0] neg_hi:[1,0,0]
    v_pk_mul_f32 v[48:49], v[48:49], v[76:77]
    v_pk_mul_f32 v[50:51], v[50:51], v[78:79]
    v_pk_mul_f32 v[48:49], v[48:49], v[200:201]
    v_pk_mul_f32 v[50:51], v[50:51], v[200:201]
    v_cvt_pk_bf16_f32 v204, v48, v49
    v_cvt_pk_bf16_f32 v205, v50, v51
    v_pk_fma_f32 v[44:45], v[196:197], v[180:181], v[44:45] neg_lo:[1,0,0] neg_hi:[1,0,0]
    v_pk_fma_f32 v[72:73], v[196:197], v[184:185], v[72:73] neg_lo:[1,0,0] neg_hi:[1,0,0]
    v_pk_fma_f32 v[46:47], v[196:197], v[182:183], v[46:47] neg_lo:[1,0,0] neg_hi:[1,0,0]
    v_pk_fma_f32 v[74:75], v[196:197], v[186:187], v[74:75] neg_lo:[1,0,0] neg_hi:[1,0,0]
    v_pk_mul_f32 v[44:45], v[44:45], v[72:73]
    v_pk_mul_f32 v[46:47], v[46:47], v[74:75]
    v_pk_mul_f32 v[44:45], v[44:45], v[200:201]
    v_pk_mul_f32 v[46:47], v[46:47], v[200:201]
    v_cvt_pk_bf16_f32 v72, v44, v45
    v_cvt_pk_bf16_f32 v73, v46, v47
    v_mov_b32 v74, v204
    v_mov_b32 v75, v205
    buffer_store_dwordx4 v[72:75], v136, s[20:23], s57 offen sc1
    v_pk_fma_f32 v[104:105], v[198:199], v[188:189], v[104:105] neg_lo:[1,0,0] neg_hi:[1,0,0]
    v_pk_fma_f32 v[132:133], v[198:199], v[192:193], v[132:133] neg_lo:[1,0,0] neg_hi:[1,0,0]
    v_pk_fma_f32 v[106:107], v[198:199], v[190:191], v[106:107] neg_lo:[1,0,0] neg_hi:[1,0,0]
    v_pk_fma_f32 v[134:135], v[198:199], v[194:195], v[134:135] neg_lo:[1,0,0] neg_hi:[1,0,0]
    v_pk_mul_f32 v[104:105], v[104:105], v[132:133]
    v_pk_mul_f32 v[106:107], v[106:107], v[134:135]
    v_pk_mul_f32 v[104:105], v[104:105], v[202:203]
    v_pk_mul_f32 v[106:107], v[106:107], v[202:203]
    v_cvt_pk_bf16_f32 v206, v104, v105
    v_cvt_pk_bf16_f32 v207, v106, v107
    v_pk_fma_f32 v[100:101], v[198:199], v[180:181], v[100:101] neg_lo:[1,0,0] neg_hi:[1,0,0]
    v_pk_fma_f32 v[128:129], v[198:199], v[184:185], v[128:129] neg_lo:[1,0,0] neg_hi:[1,0,0]
    v_pk_fma_f32 v[102:103], v[198:199], v[182:183], v[102:103] neg_lo:[1,0,0] neg_hi:[1,0,0]
    v_pk_fma_f32 v[130:131], v[198:199], v[186:187], v[130:131] neg_lo:[1,0,0] neg_hi:[1,0,0]
    v_pk_mul_f32 v[100:101], v[100:101], v[128:129]
    v_pk_mul_f32 v[102:103], v[102:103], v[130:131]
    v_pk_mul_f32 v[100:101], v[100:101], v[202:203]
    v_pk_mul_f32 v[102:103], v[102:103], v[202:203]
    v_cvt_pk_bf16_f32 v128, v100, v101
    v_cvt_pk_bf16_f32 v129, v102, v103
    v_mov_b32 v130, v206
    v_mov_b32 v131, v207
    buffer_store_dwordx4 v[128:131], v137, s[20:23], s57 offen sc1
    s_branch L_k4_kernel_end
L_k4_kernel_prod:
    s_and_b32 s32, s32, 3
    s_mul_i32 s54, s55, 0
    s_mul_i32 s57, s56, 0
    s_add_u32 s54, s54, s57
    s_sub_u32 s57, s54, 10
    s_cmp_ge_u32 s54, 10
    s_cselect_b32 s54, s57, s54
    s_mov_b32 s45, 0
    s_mov_b32 s37, 0
    s_mov_b32 s38, 4682
    s_mov_b32 s39, 14
    s_mov_b32 s41, 224
    s_mov_b32 s42, s34
    s_cmp_ge_u32 s32, 1
    s_cselect_b32 s37, 64, s37
    s_cmp_ge_u32 s32, 2
    s_cselect_b32 s37, 128, s37
    s_cmp_ge_u32 s32, 3
    s_cselect_b32 s37, 192, s37
    v_add_u32 v29, s37, v1
    v_mul_lo_u32 v30, v29, s38
    v_lshrrev_b32 v30, 16, v30
    v_mul_lo_u32 v31, v30, s39
    v_sub_u32 v29, v29, v31
    v_and_b32 v31, 8, v30
    v_lshlrev_b32 v31, 1, v31
    v_and_b32 v2, 16, v30
    v_lshrrev_b32 v2, 1, v2
    v_or_b32 v31, v31, v2
    v_and_b32 v30, 0xe7, v30
    v_or_b32 v30, v30, v31
    v_mul_lo_u32 v30, v30, s41
    v_lshl_add_u32 v30, v29, 4, v30
    v_add_u32 v2, s42, v30
    s_mov_b32 s37, 256
    s_mov_b32 s38, 4682
    s_mov_b32 s39, 14
    s_mov_b32 s41, 224
    s_mov_b32 s42, s34
    s_cmp_ge_u32 s32, 1
    s_cselect_b32 s37, 320, s37
    s_cmp_ge_u32 s32, 2
    s_cselect_b32 s37, 384, s37
    s_cmp_ge_u32 s32, 3
    s_cselect_b32 s37, 448, s37
    v_add_u32 v29, s37, v1
    v_mul_lo_u32 v30, v29, s38
    v_lshrrev_b32 v30, 16, v30
    v_mul_lo_u32 v31, v30, s39
    v_sub_u32 v29, v29, v31
    v_and_b32 v31, 8, v30
    v_lshlrev_b32 v31, 1, v31
    v_and_b32 v3, 16, v30
    v_lshrrev_b32 v3, 1, v3
    v_or_b32 v31, v31, v3
    v_and_b32 v30, 0xe7, v30
    v_or_b32 v30, v30, v31
    v_mul_lo_u32 v30, v30, s41
    v_lshl_add_u32 v30, v29, 4, v30
    v_add_u32 v3, s42, v30
    s_mov_b32 s37, 512
    s_mov_b32 s38, 4682
    s_mov_b32 s39, 14
    s_mov_b32 s41, 224
    s_mov_b32 s42, s34
    s_cmp_ge_u32 s32, 1
    s_cselect_b32 s37, 576, s37
    s_cmp_ge_u32 s32, 2
    s_cselect_b32 s37, 640, s37
    s_cmp_ge_u32 s32, 3
    s_cselect_b32 s37, 704, s37
    v_add_u32 v29, s37, v1
    v_mul_lo_u32 v30, v29, s38
    v_lshrrev_b32 v30, 16, v30
    v_mul_lo_u32 v31, v30, s39
    v_sub_u32 v29, v29, v31
    v_and_b32 v31, 8, v30
    v_lshlrev_b32 v31, 1, v31
    v_and_b32 v4, 16, v30
    v_lshrrev_b32 v4, 1, v4
    v_or_b32 v31, v31, v4
    v_and_b32 v30, 0xe7, v30
    v_or_b32 v30, v30, v31
    v_mul_lo_u32 v30, v30, s41
    v_lshl_add_u32 v30, v29, 4, v30
    v_add_u32 v4, s42, v30
    s_mov_b32 s37, 0
    s_mov_b32 s38, 4682
    s_mov_b32 s39, 14
    s_mov_b32 s41, 224
    s_mov_b32 s42, s35
    s_cmp_ge_u32 s32, 1
    s_cselect_b32 s37, 64, s37
    s_cmp_ge_u32 s32, 2
    s_cselect_b32 s37, 128, s37
    s_cmp_ge_u32 s32, 3
    s_cselect_b32 s37, 192, s37
    v_add_u32 v29, s37, v1
    v_mul_lo_u32 v30, v29, s38
    v_lshrrev_b32 v30, 16, v30
    v_mul_lo_u32 v31, v30, s39
    v_sub_u32 v29, v29, v31
    v_and_b32 v31, 8, v30
    v_lshlrev_b32 v31, 1, v31
    v_and_b32 v5, 16, v30
    v_lshrrev_b32 v5, 1, v5
    v_or_b32 v31, v31, v5
    v_and_b32 v30, 0xe7, v30
    v_or_b32 v30, v30, v31
    v_mul_lo_u32 v30, v30, s41
    v_lshl_add_u32 v30, v29, 4, v30
    v_add_u32 v5, s42, v30
    s_mov_b32 s37, 256
    s_mov_b32 s38, 4682
    s_mov_b32 s39, 14
    s_mov_b32 s41, 224
    s_mov_b32 s42, s35
    s_cmp_ge_u32 s32, 1
    s_cselect_b32 s37, 320, s37
    s_cmp_ge_u32 s32, 2
    s_cselect_b32 s37, 384, s37
    s_cmp_ge_u32 s32, 3
    s_cselect_b32 s37, 448, s37
    v_add_u32 v29, s37, v1
    v_mul_lo_u32 v30, v29, s38
    v_lshrrev_b32 v30, 16, v30
    v_mul_lo_u32 v31, v30, s39
    v_sub_u32 v29, v29, v31
    v_and_b32 v31, 8, v30
    v_lshlrev_b32 v31, 1, v31
    v_and_b32 v6, 16, v30
    v_lshrrev_b32 v6, 1, v6
    v_or_b32 v31, v31, v6
    v_and_b32 v30, 0xe7, v30
    v_or_b32 v30, v30, v31
    v_mul_lo_u32 v30, v30, s41
    v_lshl_add_u32 v30, v29, 4, v30
    v_add_u32 v6, s42, v30
    s_mov_b32 s37, 512
    s_mov_b32 s38, 4682
    s_mov_b32 s39, 14
    s_mov_b32 s41, 224
    s_mov_b32 s42, s35
    s_cmp_ge_u32 s32, 1
    s_cselect_b32 s37, 576, s37
    s_cmp_ge_u32 s32, 2
    s_cselect_b32 s37, 640, s37
    s_cmp_ge_u32 s32, 3
    s_cselect_b32 s37, 704, s37
    v_add_u32 v29, s37, v1
    v_mul_lo_u32 v30, v29, s38
    v_lshrrev_b32 v30, 16, v30
    v_mul_lo_u32 v31, v30, s39
    v_sub_u32 v29, v29, v31
    v_and_b32 v31, 8, v30
    v_lshlrev_b32 v31, 1, v31
    v_and_b32 v7, 16, v30
    v_lshrrev_b32 v7, 1, v7
    v_or_b32 v31, v31, v7
    v_and_b32 v30, 0xe7, v30
    v_or_b32 v30, v30, v31
    v_mul_lo_u32 v30, v30, s41
    v_lshl_add_u32 v30, v29, 4, v30
    v_add_u32 v7, s42, v30
    s_mov_b32 s37, 768
    s_mov_b32 s38, 4682
    s_mov_b32 s39, 14
    s_mov_b32 s41, 224
    s_mov_b32 s42, s34
    s_cmp_ge_u32 s32, 1
    s_cselect_b32 s37, 832, s37
    s_cmp_ge_u32 s32, 2
    s_cselect_b32 s37, 768, s37
    s_cselect_b32 s42, s35, s42
    s_cmp_ge_u32 s32, 3
    s_cselect_b32 s37, 832, s37
    v_add_u32 v29, s37, v1
    v_mul_lo_u32 v30, v29, s38
    v_lshrrev_b32 v30, 16, v30
    v_mul_lo_u32 v31, v30, s39
    v_sub_u32 v29, v29, v31
    v_and_b32 v31, 8, v30
    v_lshlrev_b32 v31, 1, v31
    v_and_b32 v8, 16, v30
    v_lshrrev_b32 v8, 1, v8
    v_or_b32 v31, v31, v8
    v_and_b32 v30, 0xe7, v30
    v_or_b32 v30, v30, v31
    v_mul_lo_u32 v30, v30, s41
    v_lshl_add_u32 v30, v29, 4, v30
    v_add_u32 v8, s42, v30
    s_mov_b32 s16, s8
    s_mov_b32 s17, s9
    s_mov_b32 s18, s10
    s_mov_b32 s19, s11
    s_mov_b32 s44, 12288
    s_mov_b32 s45, 14336
    s_cmp_ge_u32 s32, 1
    s_cselect_b32 s44, 13312, s44
    s_cmp_ge_u32 s32, 2
    s_cselect_b32 s16, s12, s16
    s_cselect_b32 s17, s13, s17
    s_cselect_b32 s18, s14, s18
    s_cselect_b32 s45, 14336, s45
    s_cselect_b32 s44, 26624, s44
    s_cmp_ge_u32 s32, 3
    s_cselect_b32 s16, s12, s16
    s_cselect_b32 s17, s13, s17
    s_cselect_b32 s18, s14, s18
    s_cselect_b32 s45, 14336, s45
    s_cselect_b32 s44, 27648, s44
    s_lshl_b32 s46, s32, 10
    s_lshl_b32 s47, s54, 7
    s_mul_i32 s48, s54, 14336
    s_mul_i32 s49, s54, 14336
    s_mul_i32 s50, s45, s54
    s_add_u32 s54, s54, 1
    s_cmp_eq_u32 s54, 10
    s_cselect_b32 s54, 0, s54
    s_add_u32 m0, s46, 0
    s_nop 0
    buffer_load_dwordx4 v2, s[8:11], s48 offen lds
    s_add_u32 m0, s46, 4096
    s_nop 0
    buffer_load_dwordx4 v3, s[8:11], s48 offen lds
    s_add_u32 m0, s46, 8192
    s_nop 0
    buffer_load_dwordx4 v4, s[8:11], s48 offen lds
    s_add_u32 m0, s46, 14336
    s_nop 0
    buffer_load_dwordx4 v5, s[12:15], s49 offen lds
    s_add_u32 m0, s46, 18432
    s_nop 0
    buffer_load_dwordx4 v6, s[12:15], s49 offen lds
    s_add_u32 m0, s46, 22528
    s_nop 0
    buffer_load_dwordx4 v7, s[12:15], s49 offen lds
    s_add_u32 m0, s44, 0
    s_nop 0
    buffer_load_dwordx4 v8, s[16:19], s50 offen lds
    s_lshl_b32 s47, s54, 7
    s_mul_i32 s48, s54, 14336
    s_mul_i32 s49, s54, 14336
    s_mul_i32 s50, s45, s54
    s_add_u32 s54, s54, 1
    s_cmp_eq_u32 s54, 10
    s_cselect_b32 s54, 0, s54
    s_add_u32 m0, s46, 28672
    s_nop 0
    buffer_load_dwordx4 v2, s[8:11], s48 offen lds
    s_add_u32 m0, s46, 32768
    s_nop 0
    buffer_load_dwordx4 v3, s[8:11], s48 offen lds
    s_add_u32 m0, s46, 36864
    s_nop 0
    buffer_load_dwordx4 v4, s[8:11], s48 offen lds
    s_add_u32 m0, s46, 43008
    s_nop 0
    buffer_load_dwordx4 v5, s[12:15], s49 offen lds
    s_add_u32 m0, s46, 47104
    s_nop 0
    buffer_load_dwordx4 v6, s[12:15], s49 offen lds
    s_add_u32 m0, s46, 51200
    s_nop 0
    buffer_load_dwordx4 v7, s[12:15], s49 offen lds
    s_add_u32 m0, s44, 28672
    s_nop 0
    buffer_load_dwordx4 v8, s[16:19], s50 offen lds
    s_waitcnt vmcnt(7)
    s_barrier
    s_lshl_b32 s47, s54, 7
    s_mul_i32 s48, s54, 14336
    s_mul_i32 s49, s54, 14336
    s_mul_i32 s50, s45, s54
    s_add_u32 s54, s54, 1
    s_cmp_eq_u32 s54, 10
    s_cselect_b32 s54, 0, s54
    s_add_u32 m0, s46, 57344
    s_nop 0
    buffer_load_dwordx4 v2, s[8:11], s48 offen lds
    s_add_u32 m0, s46, 61440
    s_nop 0
    buffer_load_dwordx4 v3, s[8:11], s48 offen lds
    s_add_u32 m0, s46, 65536
    s_nop 0
    buffer_load_dwordx4 v4, s[8:11], s48 offen lds
    s_add_u32 m0, s46, 71680
    s_nop 0
    buffer_load_dwordx4 v5, s[12:15], s49 offen lds
    s_add_u32 m0, s46, 75776
    s_nop 0
    buffer_load_dwordx4 v6, s[12:15], s49 offen lds
    s_add_u32 m0, s46, 79872
    s_nop 0
    buffer_load_dwordx4 v7, s[12:15], s49 offen lds
    s_add_u32 m0, s44, 57344
    s_nop 0
    buffer_load_dwordx4 v8, s[16:19], s50 offen lds
    s_waitcnt vmcnt(7)
    s_barrier
    s_lshl_b32 s47, s54, 7
    s_mul_i32 s48, s54, 14336
    s_mul_i32 s49, s54, 14336
    s_mul_i32 s50, s45, s54
    s_add_u32 s54, s54, 1
    s_cmp_eq_u32 s54, 10
    s_cselect_b32 s54, 0, s54
    s_add_u32 m0, s46, 86016
    s_nop 0
    buffer_load_dwordx4 v2, s[8:11], s48 offen lds
    s_add_u32 m0, s46, 90112
    s_nop 0
    buffer_load_dwordx4 v3, s[8:11], s48 offen lds
    s_add_u32 m0, s46, 94208
    s_nop 0
    buffer_load_dwordx4 v4, s[8:11], s48 offen lds
    s_add_u32 m0, s46, 100352
    s_nop 0
    buffer_load_dwordx4 v5, s[12:15], s49 offen lds
    s_add_u32 m0, s46, 104448
    s_nop 0
    buffer_load_dwordx4 v6, s[12:15], s49 offen lds
    s_add_u32 m0, s46, 108544
    s_nop 0
    buffer_load_dwordx4 v7, s[12:15], s49 offen lds
    s_add_u32 m0, s44, 86016
    s_nop 0
    buffer_load_dwordx4 v8, s[16:19], s50 offen lds
    s_waitcnt vmcnt(7)
    s_barrier
    s_lshl_b32 s47, s54, 7
    s_mul_i32 s48, s54, 14336
    s_mul_i32 s49, s54, 14336
    s_mul_i32 s50, s45, s54
    s_add_u32 s54, s54, 1
    s_cmp_eq_u32 s54, 10
    s_cselect_b32 s54, 0, s54
    s_add_u32 m0, s46, 114688
    s_nop 0
    buffer_load_dwordx4 v2, s[8:11], s48 offen lds
    s_add_u32 m0, s46, 118784
    s_nop 0
    buffer_load_dwordx4 v3, s[8:11], s48 offen lds
    s_add_u32 m0, s46, 122880
    s_nop 0
    buffer_load_dwordx4 v4, s[8:11], s48 offen lds
    s_add_u32 m0, s46, 129024
    s_nop 0
    buffer_load_dwordx4 v5, s[12:15], s49 offen lds
    s_add_u32 m0, s46, 133120
    s_nop 0
    buffer_load_dwordx4 v6, s[12:15], s49 offen lds
    s_add_u32 m0, s46, 137216
    s_nop 0
    buffer_load_dwordx4 v7, s[12:15], s49 offen lds
    s_add_u32 m0, s44, 114688
    s_nop 0
    buffer_load_dwordx4 v8, s[16:19], s50 offen lds
    s_waitcnt vmcnt(7)
    s_barrier
    s_lshl_b32 s47, s54, 7
    s_mul_i32 s48, s54, 14336
    s_mul_i32 s49, s54, 14336
    s_mul_i32 s50, s45, s54
    s_add_u32 s54, s54, 1
    s_cmp_eq_u32 s54, 10
    s_cselect_b32 s54, 0, s54
    s_add_u32 m0, s46, 0
    s_nop 0
    buffer_load_dwordx4 v2, s[8:11], s48 offen lds
    s_add_u32 m0, s46, 4096
    s_nop 0
    buffer_load_dwordx4 v3, s[8:11], s48 offen lds
    s_add_u32 m0, s46, 8192
    s_nop 0
    buffer_load_dwordx4 v4, s[8:11], s48 offen lds
    s_add_u32 m0, s46, 14336
    s_nop 0
    buffer_load_dwordx4 v5, s[12:15], s49 offen lds
    s_add_u32 m0, s46, 18432
    s_nop 0
    buffer_load_dwordx4 v6, s[12:15], s49 offen lds
    s_add_u32 m0, s46, 22528
    s_nop 0
    buffer_load_dwordx4 v7, s[12:15], s49 offen lds
    s_add_u32 m0, s44, 0
    s_nop 0
    buffer_load_dwordx4 v8, s[16:19], s50 offen lds
    s_waitcnt vmcnt(7)
    s_barrier
    s_lshl_b32 s47, s54, 7
    s_mul_i32 s48, s54, 14336
    s_mul_i32 s49, s54, 14336
    s_mul_i32 s50, s45, s54
    s_add_u32 s54, s54, 1
    s_cmp_eq_u32 s54, 10
    s_cselect_b32 s54, 0, s54
    s_add_u32 m0, s46, 28672
    s_nop 0
    buffer_load_dwordx4 v2, s[8:11], s48 offen lds
    s_add_u32 m0, s46, 32768
    s_nop 0
    buffer_load_dwordx4 v3, s[8:11], s48 offen lds
    s_add_u32 m0, s46, 36864
    s_nop 0
    buffer_load_dwordx4 v4, s[8:11], s48 offen lds
    s_add_u32 m0, s46, 43008
    s_nop 0
    buffer_load_dwordx4 v5, s[12:15], s49 offen lds
    s_add_u32 m0, s46, 47104
    s_nop 0
    buffer_load_dwordx4 v6, s[12:15], s49 offen lds
    s_add_u32 m0, s46, 51200
    s_nop 0
    buffer_load_dwordx4 v7, s[12:15], s49 offen lds
    s_add_u32 m0, s44, 28672
    s_nop 0
    buffer_load_dwordx4 v8, s[16:19], s50 offen lds
    s_waitcnt vmcnt(7)
    s_barrier
    s_lshl_b32 s47, s54, 7
    s_mul_i32 s48, s54, 14336
    s_mul_i32 s49, s54, 14336
    s_mul_i32 s50, s45, s54
    s_add_u32 s54, s54, 1
    s_cmp_eq_u32 s54, 10
    s_cselect_b32 s54, 0, s54
    s_add_u32 m0, s46, 57344
    s_nop 0
    buffer_load_dwordx4 v2, s[8:11], s48 offen lds
    s_add_u32 m0, s46, 61440
    s_nop 0
    buffer_load_dwordx4 v3, s[8:11], s48 offen lds
    s_add_u32 m0, s46, 65536
    s_nop 0
    buffer_load_dwordx4 v4, s[8:11], s48 offen lds
    s_add_u32 m0, s46, 71680
    s_nop 0
    buffer_load_dwordx4 v5, s[12:15], s49 offen lds
    s_add_u32 m0, s46, 75776
    s_nop 0
    buffer_load_dwordx4 v6, s[12:15], s49 offen lds
    s_add_u32 m0, s46, 79872
    s_nop 0
    buffer_load_dwordx4 v7, s[12:15], s49 offen lds
    s_add_u32 m0, s44, 57344
    s_nop 0
    buffer_load_dwordx4 v8, s[16:19], s50 offen lds
    s_waitcnt vmcnt(7)
    s_barrier
    s_lshl_b32 s47, s54, 7
    s_mul_i32 s48, s54, 14336
    s_mul_i32 s49, s54, 14336
    s_mul_i32 s50, s45, s54
    s_add_u32 s54, s54, 1
    s_cmp_eq_u32 s54, 10
    s_cselect_b32 s54, 0, s54
    s_add_u32 m0, s46, 86016
    s_nop 0
    buffer_load_dwordx4 v2, s[8:11], s48 offen lds
    s_add_u32 m0, s46, 90112
    s_nop 0
    buffer_load_dwordx4 v3, s[8:11], s48 offen lds
    s_add_u32 m0, s46, 94208
    s_nop 0
    buffer_load_dwordx4 v4, s[8:11], s48 offen lds
    s_add_u32 m0, s46, 100352
    s_nop 0
    buffer_load_dwordx4 v5, s[12:15], s49 offen lds
    s_add_u32 m0, s46, 104448
    s_nop 0
    buffer_load_dwordx4 v6, s[12:15], s49 offen lds
    s_add_u32 m0, s46, 108544
    s_nop 0
    buffer_load_dwordx4 v7, s[12:15], s49 offen lds
    s_add_u32 m0, s44, 86016
    s_nop 0
    buffer_load_dwordx4 v8, s[16:19], s50 offen lds
    s_waitcnt vmcnt(7)
    s_barrier
    s_lshl_b32 s47, s54, 7
    s_mul_i32 s48, s54, 14336
    s_mul_i32 s49, s54, 14336
    s_mul_i32 s50, s45, s54
    s_add_u32 s54, s54, 1
    s_cmp_eq_u32 s54, 10
    s_cselect_b32 s54, 0, s54
    s_add_u32 m0, s46, 114688
    s_nop 0
    buffer_load_dwordx4 v2, s[8:11], s48 offen lds
    s_add_u32 m0, s46, 118784
    s_nop 0
    buffer_load_dwordx4 v3, s[8:11], s48 offen lds
    s_add_u32 m0, s46, 122880
    s_nop 0
    buffer_load_dwordx4 v4, s[8:11], s48 offen lds
    s_add_u32 m0, s46, 129024
    s_nop 0
    buffer_load_dwordx4 v5, s[12:15], s49 offen lds
    s_add_u32 m0, s46, 133120
    s_nop 0
    buffer_load_dwordx4 v6, s[12:15], s49 offen lds
    s_add_u32 m0, s46, 137216
    s_nop 0
    buffer_load_dwordx4 v7, s[12:15], s49 offen lds
    s_add_u32 m0, s44, 114688
    s_nop 0
    buffer_load_dwordx4 v8, s[16:19], s50 offen lds
    s_waitcnt vmcnt(7)
    s_barrier
    s_waitcnt vmcnt(0)
    s_barrier
    s_branch L_k4_kernel_end
L_k4_kernel_end:
    s_endpgm
.section .rodata,"a"
.p2align 6
.amdhsa_kernel k4_kernel
  .amdhsa_next_free_vgpr 256
  .amdhsa_next_free_sgpr 102
  .amdhsa_accum_offset 256
  .amdhsa_group_segment_fixed_size 0
  .amdhsa_kernarg_size 96
  .amdhsa_user_sgpr_count 2
  .amdhsa_user_sgpr_kernarg_segment_ptr 1
  .amdhsa_system_sgpr_workgroup_id_x 1
.end_amdhsa_kernel
.text

.globl k5_kernel
.p2align 8
.type k5_kernel,@function
k5_kernel:
    s_cmp_ge_u32 s2, 256
    s_cbranch_scc1 L_k5_kernel_end
    s_load_dwordx16 s[64:79], s[0:1], 0
    s_load_dwordx8 s[80:87], s[0:1], 64
    v_and_b32 v1, 63, v0
    v_lshrrev_b32 v2, 6, v0
    s_nop 0
    v_readfirstlane_b32 s32, v2
    s_nop 3
    s_mov_b32 s53, s32
    s_waitcnt lgkmcnt(0)
    s_and_b32 s36, s2, 7
    s_lshr_b32 s37, s2, 3
    s_and_b32 s38, s37, 3
    s_lshl_b32 s36, s36, 2
    s_add_u32 s36, s36, s38
    s_lshl_b32 s33, s36, 6
    s_lshr_b32 s51, s37, 2
    s_mov_b32 s52, s36
    s_mov_b32 s55, s51
    s_mov_b32 s56, s38
    s_add_u32 s4, s86, 0xb00000
    s_addc_u32 s5, s87, 0
    s_mov_b32 s6, 0x6c0000
    s_mov_b32 s7, 0x20000
    s_add_u32 s8, s86, 0x1300000
    s_addc_u32 s9, s87, 0
    s_mov_b32 s10, 0x21c000
    s_mov_b32 s11, 0x20000
    s_mov_b32 s20, s82
    s_mov_b32 s21, s83
    s_mov_b32 s22, 0x280000
    s_mov_b32 s23, 0x20000
    s_add_u32 s24, s86, 0x700000
    s_addc_u32 s25, s87, 0
    s_mov_b32 s26, 0x280000
    s_mov_b32 s27, 0x20000
    s_mul_i32 s34, s51, 276480
    s_cmp_ge_u32 s32, 4
    s_cbranch_scc1 L_k5_kernel_prod
    s_lshr_b32 s36, s33, 4
    s_mul_i32 s37, s32, 1
    s_add_u32 s36, s36, s37
    s_mul_i32 s36, s36, 55296
    v_lshlrev_b32 v22, 4, v1
    v_add_u32 v2, s36, v22
    v_add_u32 v3, 55296, v2
    v_lshrrev_b32 v22, 5, v1
    v_lshlrev_b32 v22, 4, v22
    v_bfe_u32 v23, v1, 4, 1
    v_lshl_add_u32 v22, v23, 2, v22
    v_bfe_u32 v23, v1, 2, 2
    v_add_u32 v22, v22, v23
    v_mul_u32_u24 v23, 160, v22
    v_and_b32 v24, 3, v1
    v_lshl_add_u32 v8, v24, 3, v23
    v_add_u32 v9, 65536, v8
    v_add_u32 v10, 131072, v8
    v_and_b32 v46, 15, v1
    s_lshl_b32 s36, s32, 4
    s_add_u32 s36, s36, s33
    v_add_u32 v46, s36, v46
    v_lshrrev_b32 v48, 4, v1
    v_mul_u32_u24 v47, 1280, v46
    v_lshl_add_u32 v47, v48, 3, v47
    s_mul_i32 s37, s51, 160
    v_add_u32 v47, s37, v47
    s_lshr_b32 s36, s36, 4
    s_mul_i32 s36, s36, 20480
    v_lshl_add_u32 v49, v1, 4, s36
    s_mul_i32 s36, s51, 5
    s_add_u32 s37, s36, 0
    s_lshr_b32 s38, s37, 1
    s_lshl_b32 s38, s38, 10
    s_and_b32 s37, s37, 1
    s_lshl_b32 s37, s37, 3
    s_add_u32 s56, s38, s37
    s_add_u32 s37, s36, 1
    s_lshr_b32 s38, s37, 1
    s_lshl_b32 s38, s38, 10
    s_and_b32 s37, s37, 1
    s_lshl_b32 s37, s37, 3
    s_add_u32 s57, s38, s37
    s_add_u32 s37, s36, 2
    s_lshr_b32 s38, s37, 1
    s_lshl_b32 s38, s38, 10
    s_and_b32 s37, s37, 1
    s_lshl_b32 s37, s37, 3
    s_add_u32 s58, s38, s37
    s_add_u32 s37, s36, 3
    s_lshr_b32 s38, s37, 1
    s_lshl_b32 s38, s38, 10
    s_and_b32 s37, s37, 1
    s_lshl_b32 s37, s37, 3
    s_add_u32 s59, s38, s37
    s_add_u32 s37, s36, 4
    s_lshr_b32 s38, s37, 1
    s_lshl_b32 s38, s38, 10
    s_and_b32 s37, s37, 1
    s_lshl_b32 s37, s37, 3
    s_add_u32 s60, s38, s37
    buffer_load_dwordx2 v[36:37], v49, s[24:27], s56 offen
    buffer_load_dwordx2 v[38:39], v49, s[24:27], s57 offen
    buffer_load_dwordx2 v[40:41], v49, s[24:27], s58 offen
    buffer_load_dwordx2 v[42:43], v49, s[24:27], s59 offen
    buffer_load_dwordx2 v[44:45], v49, s[24:27], s60 offen
    s_mov_b32 s47, 0
    buffer_load_dwordx4 v[92:95], v2, s[4:7], s47 offen
    s_mov_b32 s47, 1024
    buffer_load_dwordx4 v[96:99], v2, s[4:7], s47 offen
    s_mov_b32 s47, 2048
    buffer_load_dwordx4 v[100:103], v2, s[4:7], s47 offen
    s_mov_b32 s47, 3072
    buffer_load_dwordx4 v[104:107], v2, s[4:7], s47 offen
    s_mov_b32 s47, 4096
    buffer_load_dwordx4 v[108:111], v2, s[4:7], s47 offen
    s_mov_b32 s47, 5120
    buffer_load_dwordx4 v[112:115], v2, s[4:7], s47 offen
    s_mov_b32 s47, 6144
    buffer_load_dwordx4 v[116:119], v2, s[4:7], s47 offen
    s_mov_b32 s47, 7168
    buffer_load_dwordx4 v[120:123], v2, s[4:7], s47 offen
    s_mov_b32 s47, 8192
    buffer_load_dwordx4 v[124:127], v2, s[4:7], s47 offen
    s_mov_b32 s47, 9216
    buffer_load_dwordx4 v[128:131], v2, s[4:7], s47 offen
    s_mov_b32 s47, 10240
    buffer_load_dwordx4 v[132:135], v2, s[4:7], s47 offen
    s_mov_b32 s47, 11264
    buffer_load_dwordx4 v[136:139], v2, s[4:7], s47 offen
    s_barrier
    ds_read_b64_tr_b16 v[52:53], v8 offset:0
    ds_read_b64_tr_b16 v[54:55], v8 offset:1280
    ds_read_b64_tr_b16 v[56:57], v8 offset:32
    ds_read_b64_tr_b16 v[58:59], v8 offset:1312
    ds_read_b64_tr_b16 v[60:61], v8 offset:64
    ds_read_b64_tr_b16 v[62:63], v8 offset:1344
    ds_read_b64_tr_b16 v[64:65], v8 offset:96
    ds_read_b64_tr_b16 v[66:67], v8 offset:1376
    ds_read_b64_tr_b16 v[68:69], v8 offset:128
    ds_read_b64_tr_b16 v[70:71], v8 offset:1408
    ds_read_b64_tr_b16 v[72:73], v8 offset:5120
    ds_read_b64_tr_b16 v[74:75], v8 offset:6400
    ds_read_b64_tr_b16 v[76:77], v8 offset:5152
    ds_read_b64_tr_b16 v[78:79], v8 offset:6432
    ds_read_b64_tr_b16 v[80:81], v8 offset:5184
    ds_read_b64_tr_b16 v[82:83], v8 offset:6464
    ds_read_b64_tr_b16 v[84:85], v8 offset:5216
    ds_read_b64_tr_b16 v[86:87], v8 offset:6496
    ds_read_b64_tr_b16 v[88:89], v8 offset:5248
    ds_read_b64_tr_b16 v[90:91], v8 offset:6528
    s_waitcnt vmcnt(11)
    s_mov_b32 s47, 12288
    buffer_load_dwordx4 v[140:143], v2, s[4:7], s47 offen
    s_waitcnt lgkmcnt(15)
    v_mfma_f32_16x16x32_bf16 v[16:19], v[52:55], v[92:95], 0
    s_barrier
    ds_read_b64_tr_b16 v[52:53], v8 offset:10240
    ds_read_b64_tr_b16 v[54:55], v8 offset:11520
    v_mfma_f32_16x16x32_bf16 v[20:23], v[56:59], v[92:95], 0
    ds_read_b64_tr_b16 v[56:57], v8 offset:10272
    ds_read_b64_tr_b16 v[58:59], v8 offset:11552
    s_waitcnt lgkmcnt(15)
    v_mfma_f32_16x16x32_bf16 v[24:27], v[60:63], v[92:95], 0
    ds_read_b64_tr_b16 v[60:61], v8 offset:10304
    ds_read_b64_tr_b16 v[62:63], v8 offset:11584
    v_mfma_f32_16x16x32_bf16 v[28:31], v[64:67], v[92:95], 0
    ds_read_b64_tr_b16 v[64:65], v8 offset:10336
    ds_read_b64_tr_b16 v[66:67], v8 offset:11616
    s_waitcnt lgkmcnt(15)
    v_mfma_f32_16x16x32_bf16 v[32:35], v[68:71], v[92:95], 0
    ds_read_b64_tr_b16 v[68:69], v8 offset:10368
    ds_read_b64_tr_b16 v[70:71], v8 offset:11648
    s_waitcnt vmcnt(11)
    s_mov_b32 s47, 13312
    buffer_load_dwordx4 v[92:95], v2, s[4:7], s47 offen
    v_mfma_f32_16x16x32_bf16 v[16:19], v[72:75], v[96:99], v[16:19]
    ds_read_b64_tr_b16 v[72:73], v8 offset:15360
    ds_read_b64_tr_b16 v[74:75], v8 offset:16640
    s_waitcnt lgkmcnt(15)
    v_mfma_f32_16x16x32_bf16 v[20:23], v[76:79], v[96:99], v[20:23]
    ds_read_b64_tr_b16 v[76:77], v8 offset:15392
    ds_read_b64_tr_b16 v[78:79], v8 offset:16672
    v_mfma_f32_16x16x32_bf16 v[24:27], v[80:83], v[96:99], v[24:27]
    ds_read_b64_tr_b16 v[80:81], v8 offset:15424
    ds_read_b64_tr_b16 v[82:83], v8 offset:16704
    s_waitcnt lgkmcnt(15)
    v_mfma_f32_16x16x32_bf16 v[28:31], v[84:87], v[96:99], v[28:31]
    ds_read_b64_tr_b16 v[84:85], v8 offset:15456
    ds_read_b64_tr_b16 v[86:87], v8 offset:16736
    v_mfma_f32_16x16x32_bf16 v[32:35], v[88:91], v[96:99], v[32:35]
    ds_read_b64_tr_b16 v[88:89], v8 offset:15488
    ds_read_b64_tr_b16 v[90:91], v8 offset:16768
    s_waitcnt vmcnt(11)
    s_mov_b32 s47, 14336
    buffer_load_dwordx4 v[96:99], v2, s[4:7], s47 offen
    s_waitcnt lgkmcnt(15)
    v_mfma_f32_16x16x32_bf16 v[16:19], v[52:55], v[100:103], v[16:19]
    s_barrier
    ds_read_b64_tr_b16 v[52:53], v8 offset:20480
    ds_read_b64_tr_b16 v[54:55], v8 offset:21760
    v_mfma_f32_16x16x32_bf16 v[20:23], v[56:59], v[100:103], v[20:23]
    ds_read_b64_tr_b16 v[56:57], v8 offset:20512
    ds_read_b64_tr_b16 v[58:59], v8 offset:21792
    s_waitcnt lgkmcnt(15)
    v_mfma_f32_16x16x32_bf16 v[24:27], v[60:63], v[100:103], v[24:27]
    ds_read_b64_tr_b16 v[60:61], v8 offset:20544
    ds_read_b64_tr_b16 v[62:63], v8 offset:21824
    v_mfma_f32_16x16x32_bf16 v[28:31], v[64:67], v[100:103], v[28:31]
    ds_read_b64_tr_b16 v[64:65], v8 offset:20576
    ds_read_b64_tr_b16 v[66:67], v8 offset:21856
    s_waitcnt lgkmcnt(15)
    v_mfma_f32_16x16x32_bf16 v[32:35], v[68:71], v[100:103], v[32:35]
    ds_read_b64_tr_b16 v[68:69], v8 offset:20608
    ds_read_b64_tr_b16 v[70:71], v8 offset:21888
    s_waitcnt vmcnt(11)
    s_mov_b32 s47, 15360
    buffer_load_dwordx4 v[100:103], v2, s[4:7], s47 offen
    v_mfma_f32_16x16x32_bf16 v[16:19], v[72:75], v[104:107], v[16:19]
    ds_read_b64_tr_b16 v[72:73], v8 offset:25600
    ds_read_b64_tr_b16 v[74:75], v8 offset:26880
    s_waitcnt lgkmcnt(15)
    v_mfma_f32_16x16x32_bf16 v[20:23], v[76:79], v[104:107], v[20:23]
    ds_read_b64_tr_b16 v[76:77], v8 offset:25632
    ds_read_b64_tr_b16 v[78:79], v8 offset:26912
    v_mfma_f32_16x16x32_bf16 v[24:27], v[80:83], v[104:107], v[24:27]
    ds_read_b64_tr_b16 v[80:81], v8 offset:25664
    ds_read_b64_tr_b16 v[82:83], v8 offset:26944
    s_waitcnt lgkmcnt(15)
    v_mfma_f32_16x16x32_bf16 v[28:31], v[84:87], v[104:107], v[28:31]
    ds_read_b64_tr_b16 v[84:85], v8 offset:25696
    ds_read_b64_tr_b16 v[86:87], v8 offset:26976
    v_mfma_f32_16x16x32_bf16 v[32:35], v[88:91], v[104:107], v[32:35]
    ds_read_b64_tr_b16 v[88:89], v8 offset:25728
    ds_read_b64_tr_b16 v[90:91], v8 offset:27008
    s_waitcnt vmcnt(11)
    s_mov_b32 s47, 16384
    buffer_load_dwordx4 v[104:107], v2, s[4:7], s47 offen
    s_waitcnt lgkmcnt(15)
    v_mfma_f32_16x16x32_bf16 v[16:19], v[52:55], v[108:111], v[16:19]
    s_barrier
    ds_read_b64_tr_b16 v[52:53], v8 offset:30720
    ds_read_b64_tr_b16 v[54:55], v8 offset:32000
    v_mfma_f32_16x16x32_bf16 v[20:23], v[56:59], v[108:111], v[20:23]
    ds_read_b64_tr_b16 v[56:57], v8 offset:30752
    ds_read_b64_tr_b16 v[58:59], v8 offset:32032
    s_waitcnt lgkmcnt(15)
    v_mfma_f32_16x16x32_bf16 v[24:27], v[60:63], v[108:111], v[24:27]
    ds_read_b64_tr_b16 v[60:61], v8 offset:30784
    ds_read_b64_tr_b16 v[62:63], v8 offset:32064
    v_mfma_f32_16x16x32_bf16 v[28:31], v[64:67], v[108:111], v[28:31]
    ds_read_b64_tr_b16 v[64:65], v8 offset:30816
    ds_read_b64_tr_b16 v[66:67], v8 offset:32096
    s_waitcnt lgkmcnt(15)
    v_mfma_f32_16x16x32_bf16 v[32:35], v[68:71], v[108:111], v[32:35]
    ds_read_b64_tr_b16 v[68:69], v8 offset:30848
    ds_read_b64_tr_b16 v[70:71], v8 offset:32128
    s_waitcnt vmcnt(11)
    s_mov_b32 s47, 17408
    buffer_load_dwordx4 v[108:111], v2, s[4:7], s47 offen
    v_mfma_f32_16x16x32_bf16 v[16:19], v[72:75], v[112:115], v[16:19]
    ds_read_b64_tr_b16 v[72:73], v8 offset:35840
    ds_read_b64_tr_b16 v[74:75], v8 offset:37120
    s_waitcnt lgkmcnt(15)
    v_mfma_f32_16x16x32_bf16 v[20:23], v[76:79], v[112:115], v[20:23]
    ds_read_b64_tr_b16 v[76:77], v8 offset:35872
    ds_read_b64_tr_b16 v[78:79], v8 offset:37152
    v_mfma_f32_16x16x32_bf16 v[24:27], v[80:83], v[112:115], v[24:27]
    ds_read_b64_tr_b16 v[80:81], v8 offset:35904
    ds_read_b64_tr_b16 v[82:83], v8 offset:37184
    s_waitcnt lgkmcnt(15)
    v_mfma_f32_16x16x32_bf16 v[28:31], v[84:87], v[112:115], v[28:31]
    ds_read_b64_tr_b16 v[84:85], v8 offset:35936
    ds_read_b64_tr_b16 v[86:87], v8 offset:37216
    v_mfma_f32_16x16x32_bf16 v[32:35], v[88:91], v[112:115], v[32:35]
    ds_read_b64_tr_b16 v[88:89], v8 offset:35968
    ds_read_b64_tr_b16 v[90:91], v8 offset:37248
    s_waitcnt vmcnt(11)
    s_mov_b32 s47, 18432
    buffer_load_dwordx4 v[112:115], v2, s[4:7], s47 offen
    s_waitcnt lgkmcnt(15)
    v_mfma_f32_16x16x32_bf16 v[16:19], v[52:55], v[116:119], v[16:19]
    s_barrier
    ds_read_b64_tr_b16 v[52:53], v8 offset:40960
    ds_read_b64_tr_b16 v[54:55], v8 offset:42240
    v_mfma_f32_16x16x32_bf16 v[20:23], v[56:59], v[116:119], v[20:23]
    ds_read_b64_tr_b16 v[56:57], v8 offset:40992
    ds_read_b64_tr_b16 v[58:59], v8 offset:42272
    s_waitcnt lgkmcnt(15)
    v_mfma_f32_16x16x32_bf16 v[24:27], v[60:63], v[116:119], v[24:27]
    ds_read_b64_tr_b16 v[60:61], v8 offset:41024
    ds_read_b64_tr_b16 v[62:63], v8 offset:42304
    v_mfma_f32_16x16x32_bf16 v[28:31], v[64:67], v[116:119], v[28:31]
    ds_read_b64_tr_b16 v[64:65], v8 offset:41056
    ds_read_b64_tr_b16 v[66:67], v8 offset:42336
    s_waitcnt lgkmcnt(15)
    v_mfma_f32_16x16x32_bf16 v[32:35], v[68:71], v[116:119], v[32:35]
    ds_read_b64_tr_b16 v[68:69], v8 offset:41088
    ds_read_b64_tr_b16 v[70:71], v8 offset:42368
    s_waitcnt vmcnt(11)
    s_mov_b32 s47, 19456
    buffer_load_dwordx4 v[116:119], v2, s[4:7], s47 offen
    v_mfma_f32_16x16x32_bf16 v[16:19], v[72:75], v[120:123], v[16:19]
    ds_read_b64_tr_b16 v[72:73], v8 offset:46080
    ds_read_b64_tr_b16 v[74:75], v8 offset:47360
    s_waitcnt lgkmcnt(15)
    v_mfma_f32_16x16x32_bf16 v[20:23], v[76:79], v[120:123], v[20:23]
    ds_read_b64_tr_b16 v[76:77], v8 offset:46112
    ds_read_b64_tr_b16 v[78:79], v8 offset:47392
    v_mfma_f32_16x16x32_bf16 v[24:27], v[80:83], v[120:123], v[24:27]
    ds_read_b64_tr_b16 v[80:81], v8 offset:46144
    ds_read_b64_tr_b16 v[82:83], v8 offset:47424
    s_waitcnt lgkmcnt(15)
    v_mfma_f32_16x16x32_bf16 v[28:31], v[84:87], v[120:123], v[28:31]
    ds_read_b64_tr_b16 v[84:85], v8 offset:46176
    ds_read_b64_tr_b16 v[86:87], v8 offset:47456
    v_mfma_f32_16x16x32_bf16 v[32:35], v[88:91], v[120:123], v[32:35]
    ds_read_b64_tr_b16 v[88:89], v8 offset:46208
    ds_read_b64_tr_b16 v[90:91], v8 offset:47488
    s_waitcnt vmcnt(11)
    s_mov_b32 s47, 20480
    buffer_load_dwordx4 v[120:123], v2, s[4:7], s47 offen
    s_waitcnt lgkmcnt(15)
    v_mfma_f32_16x16x32_bf16 v[16:19], v[52:55], v[124:127], v[16:19]
    s_barrier
    ds_read_b64_tr_b16 v[52:53], v8 offset:51200
    ds_read_b64_tr_b16 v[54:55], v8 offset:52480
    v_mfma_f32_16x16x32_bf16 v[20:23], v[56:59], v[124:127], v[20:23]
    ds_read_b64_tr_b16 v[56:57], v8 offset:51232
    ds_read_b64_tr_b16 v[58:59], v8 offset:52512
    s_waitcnt lgkmcnt(15)
    v_mfma_f32_16x16x32_bf16 v[24:27], v[60:63], v[124:127], v[24:27]
    ds_read_b64_tr_b16 v[60:61], v8 offset:51264
    ds_read_b64_tr_b16 v[62:63], v8 offset:52544
    v_mfma_f32_16x16x32_bf16 v[28:31], v[64:67], v[124:127], v[28:31]
    ds_read_b64_tr_b16 v[64:65], v8 offset:51296
    ds_read_b64_tr_b16 v[66:67], v8 offset:52576
    s_waitcnt lgkmcnt(15)
    v_mfma_f32_16x16x32_bf16 v[32:35], v[68:71], v[124:127], v[32:35]
    ds_read_b64_tr_b16 v[68:69], v8 offset:51328
    ds_read_b64_tr_b16 v[70:71], v8 offset:52608
    s_waitcnt vmcnt(11)
    s_mov_b32 s47, 21504
    buffer_load_dwordx4 v[124:127], v2, s[4:7], s47 offen
    v_mfma_f32_16x16x32_bf16 v[16:19], v[72:75], v[128:131], v[16:19]
    ds_read_b64_tr_b16 v[72:73], v8 offset:56320
    ds_read_b64_tr_b16 v[74:75], v8 offset:57600
    s_waitcnt lgkmcnt(15)
    v_mfma_f32_16x16x32_bf16 v[20:23], v[76:79], v[128:131], v[20:23]
    ds_read_b64_tr_b16 v[76:77], v8 offset:56352
    ds_read_b64_tr_b16 v[78:79], v8 offset:57632
    v_mfma_f32_16x16x32_bf16 v[24:27], v[80:83], v[128:131], v[24:27]
    ds_read_b64_tr_b16 v[80:81], v8 offset:56384
    ds_read_b64_tr_b16 v[82:83], v8 offset:57664
    s_waitcnt lgkmcnt(15)
    v_mfma_f32_16x16x32_bf16 v[28:31], v[84:87], v[128:131], v[28:31]
    ds_read_b64_tr_b16 v[84:85], v8 offset:56416
    ds_read_b64_tr_b16 v[86:87], v8 offset:57696
    v_mfma_f32_16x16x32_bf16 v[32:35], v[88:91], v[128:131], v[32:35]
    ds_read_b64_tr_b16 v[88:89], v8 offset:56448
    ds_read_b64_tr_b16 v[90:91], v8 offset:57728
    s_waitcnt vmcnt(11)
    s_mov_b32 s47, 22528
    buffer_load_dwordx4 v[128:131], v2, s[4:7], s47 offen
    s_waitcnt lgkmcnt(15)
    v_mfma_f32_16x16x32_bf16 v[16:19], v[52:55], v[132:135], v[16:19]
    s_barrier
    ds_read_b64_tr_b16 v[52:53], v8 offset:61440
    ds_read_b64_tr_b16 v[54:55], v8 offset:62720
    v_mfma_f32_16x16x32_bf16 v[20:23], v[56:59], v[132:135], v[20:23]
    ds_read_b64_tr_b16 v[56:57], v8 offset:61472
    ds_read_b64_tr_b16 v[58:59], v8 offset:62752
    s_waitcnt lgkmcnt(15)
    v_mfma_f32_16x16x32_bf16 v[24:27], v[60:63], v[132:135], v[24:27]
    ds_read_b64_tr_b16 v[60:61], v8 offset:61504
    ds_read_b64_tr_b16 v[62:63], v8 offset:62784
    v_mfma_f32_16x16x32_bf16 v[28:31], v[64:67], v[132:135], v[28:31]
    ds_read_b64_tr_b16 v[64:65], v8 offset:61536
    ds_read_b64_tr_b16 v[66:67], v8 offset:62816
    s_waitcnt lgkmcnt(15)
    v_mfma_f32_16x16x32_bf16 v[32:35], v[68:71], v[132:135], v[32:35]
    ds_read_b64_tr_b16 v[68:69], v8 offset:61568
    ds_read_b64_tr_b16 v[70:71], v8 offset:62848
    s_waitcnt vmcnt(11)
    s_mov_b32 s47, 23552
    buffer_load_dwordx4 v[132:135], v2, s[4:7], s47 offen
    v_mfma_f32_16x16x32_bf16 v[16:19], v[72:75], v[136:139], v[16:19]
    ds_read_b64_tr_b16 v[72:73], v9 offset:1024
    ds_read_b64_tr_b16 v[74:75], v9 offset:2304
    s_waitcnt lgkmcnt(15)
    v_mfma_f32_16x16x32_bf16 v[20:23], v[76:79], v[136:139], v[20:23]
    ds_read_b64_tr_b16 v[76:77], v9 offset:1056
    ds_read_b64_tr_b16 v[78:79], v9 offset:2336
    v_mfma_f32_16x16x32_bf16 v[24:27], v[80:83], v[136:139], v[24:27]
    ds_read_b64_tr_b16 v[80:81], v9 offset:1088
    ds_read_b64_tr_b16 v[82:83], v9 offset:2368
    s_waitcnt lgkmcnt(15)
    v_mfma_f32_16x16x32_bf16 v[28:31], v[84:87], v[136:139], v[28:31]
    ds_read_b64_tr_b16 v[84:85], v9 offset:1120
    ds_read_b64_tr_b16 v[86:87], v9 offset:2400
    v_mfma_f32_16x16x32_bf16 v[32:35], v[88:91], v[136:139], v[32:35]
    ds_read_b64_tr_b16 v[88:89], v9 offset:1152
    ds_read_b64_tr_b16 v[90:91], v9 offset:2432
    s_waitcnt vmcnt(11)
    s_mov_b32 s47, 24576
    buffer_load_dwordx4 v[136:139], v2, s[4:7], s47 offen
    s_waitcnt lgkmcnt(15)
    v_mfma_f32_16x16x32_bf16 v[16:19], v[52:55], v[140:143], v[16:19]
    s_barrier
    ds_read_b64_tr_b16 v[52:53], v9 offset:6144
    ds_read_b64_tr_b16 v[54:55], v9 offset:7424
    v_mfma_f32_16x16x32_bf16 v[20:23], v[56:59], v[140:143], v[20:23]
    ds_read_b64_tr_b16 v[56:57], v9 offset:6176
    ds_read_b64_tr_b16 v[58:59], v9 offset:7456
    s_waitcnt lgkmcnt(15)
    v_mfma_f32_16x16x32_bf16 v[24:27], v[60:63], v[140:143], v[24:27]
    ds_read_b64_tr_b16 v[60:61], v9 offset:6208
    ds_read_b64_tr_b16 v[62:63], v9 offset:7488
    v_mfma_f32_16x16x32_bf16 v[28:31], v[64:67], v[140:143], v[28:31]
    ds_read_b64_tr_b16 v[64:65], v9 offset:6240
    ds_read_b64_tr_b16 v[66:67], v9 offset:7520
    s_waitcnt lgkmcnt(15)
    v_mfma_f32_16x16x32_bf16 v[32:35], v[68:71], v[140:143], v[32:35]
    ds_read_b64_tr_b16 v[68:69], v9 offset:6272
    ds_read_b64_tr_b16 v[70:71], v9 offset:7552
    s_waitcnt vmcnt(11)
    s_mov_b32 s47, 25600
    buffer_load_dwordx4 v[140:143], v2, s[4:7], s47 offen
    v_mfma_f32_16x16x32_bf16 v[16:19], v[72:75], v[92:95], v[16:19]
    ds_read_b64_tr_b16 v[72:73], v9 offset:11264
    ds_read_b64_tr_b16 v[74:75], v9 offset:12544
    s_waitcnt lgkmcnt(15)
    v_mfma_f32_16x16x32_bf16 v[20:23], v[76:79], v[92:95], v[20:23]
    ds_read_b64_tr_b16 v[76:77], v9 offset:11296
    ds_read_b64_tr_b16 v[78:79], v9 offset:12576
    v_mfma_f32_16x16x32_bf16 v[24:27], v[80:83], v[92:95], v[24:27]
    ds_read_b64_tr_b16 v[80:81], v9 offset:11328
    ds_read_b64_tr_b16 v[82:83], v9 offset:12608
    s_waitcnt lgkmcnt(15)
    v_mfma_f32_16x16x32_bf16 v[28:31], v[84:87], v[92:95], v[28:31]
    ds_read_b64_tr_b16 v[84:85], v9 offset:11360
    ds_read_b64_tr_b16 v[86:87], v9 offset:12640
    v_mfma_f32_16x16x32_bf16 v[32:35], v[88:91], v[92:95], v[32:35]
    ds_read_b64_tr_b16 v[88:89], v9 offset:11392
    ds_read_b64_tr_b16 v[90:91], v9 offset:12672
    s_waitcnt vmcnt(11)
    s_mov_b32 s47, 26624
    buffer_load_dwordx4 v[92:95], v2, s[4:7], s47 offen
    s_waitcnt lgkmcnt(15)
    v_mfma_f32_16x16x32_bf16 v[16:19], v[52:55], v[96:99], v[16:19]
    s_barrier
    ds_read_b64_tr_b16 v[52:53], v9 offset:16384
    ds_read_b64_tr_b16 v[54:55], v9 offset:17664
    v_mfma_f32_16x16x32_bf16 v[20:23], v[56:59], v[96:99], v[20:23]
    ds_read_b64_tr_b16 v[56:57], v9 offset:16416
    ds_read_b64_tr_b16 v[58:59], v9 offset:17696
    s_waitcnt lgkmcnt(15)
    v_mfma_f32_16x16x32_bf16 v[24:27], v[60:63], v[96:99], v[24:27]
    ds_read_b64_tr_b16 v[60:61], v9 offset:16448
    ds_read_b64_tr_b16 v[62:63], v9 offset:17728
    v_mfma_f32_16x16x32_bf16 v[28:31], v[64:67], v[96:99], v[28:31]
    ds_read_b64_tr_b16 v[64:65], v9 offset:16480
    ds_read_b64_tr_b16 v[66:67], v9 offset:17760
    s_waitcnt lgkmcnt(15)
    v_mfma_f32_16x16x32_bf16 v[32:35], v[68:71], v[96:99], v[32:35]
    ds_read_b64_tr_b16 v[68:69], v9 offset:16512
    ds_read_b64_tr_b16 v[70:71], v9 offset:17792
    s_waitcnt vmcnt(11)
    s_mov_b32 s47, 27648
    buffer_load_dwordx4 v[96:99], v2, s[4:7], s47 offen
    v_mfma_f32_16x16x32_bf16 v[16:19], v[72:75], v[100:103], v[16:19]
    ds_read_b64_tr_b16 v[72:73], v9 offset:21504
    ds_read_b64_tr_b16 v[74:75], v9 offset:22784
    s_waitcnt lgkmcnt(15)
    v_mfma_f32_16x16x32_bf16 v[20:23], v[76:79], v[100:103], v[20:23]
    ds_read_b64_tr_b16 v[76:77], v9 offset:21536
    ds_read_b64_tr_b16 v[78:79], v9 offset:22816
    v_mfma_f32_16x16x32_bf16 v[24:27], v[80:83], v[100:103], v[24:27]
    ds_read_b64_tr_b16 v[80:81], v9 offset:21568
    ds_read_b64_tr_b16 v[82:83], v9 offset:22848
    s_waitcnt lgkmcnt(15)
    v_mfma_f32_16x16x32_bf16 v[28:31], v[84:87], v[100:103], v[28:31]
    ds_read_b64_tr_b16 v[84:85], v9 offset:21600
    ds_read_b64_tr_b16 v[86:87], v9 offset:22880
    v_mfma_f32_16x16x32_bf16 v[32:35], v[88:91], v[100:103], v[32:35]
    ds_read_b64_tr_b16 v[88:89], v9 offset:21632
    ds_read_b64_tr_b16 v[90:91], v9 offset:22912
    s_waitcnt vmcnt(11)
    s_mov_b32 s47, 28672
    buffer_load_dwordx4 v[100:103], v2, s[4:7], s47 offen
    s_waitcnt lgkmcnt(15)
    v_mfma_f32_16x16x32_bf16 v[16:19], v[52:55], v[104:107], v[16:19]
    s_barrier
    ds_read_b64_tr_b16 v[52:53], v9 offset:26624
    ds_read_b64_tr_b16 v[54:55], v9 offset:27904
    v_mfma_f32_16x16x32_bf16 v[20:23], v[56:59], v[104:107], v[20:23]
    ds_read_b64_tr_b16 v[56:57], v9 offset:26656
    ds_read_b64_tr_b16 v[58:59], v9 offset:27936
    s_waitcnt lgkmcnt(15)
    v_mfma_f32_16x16x32_bf16 v[24:27], v[60:63], v[104:107], v[24:27]
    ds_read_b64_tr_b16 v[60:61], v9 offset:26688
    ds_read_b64_tr_b16 v[62:63], v9 offset:27968
    v_mfma_f32_16x16x32_bf16 v[28:31], v[64:67], v[104:107], v[28:31]
    ds_read_b64_tr_b16 v[64:65], v9 offset:26720
    ds_read_b64_tr_b16 v[66:67], v9 offset:28000
    s_waitcnt lgkmcnt(15)
    v_mfma_f32_16x16x32_bf16 v[32:35], v[68:71], v[104:107], v[32:35]
    ds_read_b64_tr_b16 v[68:69], v9 offset:26752
    ds_read_b64_tr_b16 v[70:71], v9 offset:28032
    s_waitcnt vmcnt(11)
    s_mov_b32 s47, 29696
    buffer_load_dwordx4 v[104:107], v2, s[4:7], s47 offen
    v_mfma_f32_16x16x32_bf16 v[16:19], v[72:75], v[108:111], v[16:19]
    ds_read_b64_tr_b16 v[72:73], v9 offset:31744
    ds_read_b64_tr_b16 v[74:75], v9 offset:33024
    s_waitcnt lgkmcnt(15)
    v_mfma_f32_16x16x32_bf16 v[20:23], v[76:79], v[108:111], v[20:23]
    ds_read_b64_tr_b16 v[76:77], v9 offset:31776
    ds_read_b64_tr_b16 v[78:79], v9 offset:33056
    v_mfma_f32_16x16x32_bf16 v[24:27], v[80:83], v[108:111], v[24:27]
    ds_read_b64_tr_b16 v[80:81], v9 offset:31808
    ds_read_b64_tr_b16 v[82:83], v9 offset:33088
    s_waitcnt lgkmcnt(15)
    v_mfma_f32_16x16x32_bf16 v[28:31], v[84:87], v[108:111], v[28:31]
    ds_read_b64_tr_b16 v[84:85], v9 offset:31840
    ds_read_b64_tr_b16 v[86:87], v9 offset:33120
    v_mfma_f32_16x16x32_bf16 v[32:35], v[88:91], v[108:111], v[32:35]
    ds_read_b64_tr_b16 v[88:89], v9 offset:31872
    ds_read_b64_tr_b16 v[90:91], v9 offset:33152
    s_waitcnt vmcnt(11)
    s_mov_b32 s47, 30720
    buffer_load_dwordx4 v[108:111], v2, s[4:7], s47 offen
    s_waitcnt lgkmcnt(15)
    v_mfma_f32_16x16x32_bf16 v[16:19], v[52:55], v[112:115], v[16:19]
    s_barrier
    ds_read_b64_tr_b16 v[52:53], v9 offset:36864
    ds_read_b64_tr_b16 v[54:55], v9 offset:38144
    v_mfma_f32_16x16x32_bf16 v[20:23], v[56:59], v[112:115], v[20:23]
    ds_read_b64_tr_b16 v[56:57], v9 offset:36896
    ds_read_b64_tr_b16 v[58:59], v9 offset:38176
    s_waitcnt lgkmcnt(15)
    v_mfma_f32_16x16x32_bf16 v[24:27], v[60:63], v[112:115], v[24:27]
    ds_read_b64_tr_b16 v[60:61], v9 offset:36928
    ds_read_b64_tr_b16 v[62:63], v9 offset:38208
    v_mfma_f32_16x16x32_bf16 v[28:31], v[64:67], v[112:115], v[28:31]
    ds_read_b64_tr_b16 v[64:65], v9 offset:36960
    ds_read_b64_tr_b16 v[66:67], v9 offset:38240
    s_waitcnt lgkmcnt(15)
    v_mfma_f32_16x16x32_bf16 v[32:35], v[68:71], v[112:115], v[32:35]
    ds_read_b64_tr_b16 v[68:69], v9 offset:36992
    ds_read_b64_tr_b16 v[70:71], v9 offset:38272
    s_waitcnt vmcnt(11)
    s_mov_b32 s47, 31744
    buffer_load_dwordx4 v[112:115], v2, s[4:7], s47 offen
    v_mfma_f32_16x16x32_bf16 v[16:19], v[72:75], v[116:119], v[16:19]
    ds_read_b64_tr_b16 v[72:73], v9 offset:41984
    ds_read_b64_tr_b16 v[74:75], v9 offset:43264
    s_waitcnt lgkmcnt(15)
    v_mfma_f32_16x16x32_bf16 v[20:23], v[76:79], v[116:119], v[20:23]
    ds_read_b64_tr_b16 v[76:77], v9 offset:42016
    ds_read_b64_tr_b16 v[78:79], v9 offset:43296
    v_mfma_f32_16x16x32_bf16 v[24:27], v[80:83], v[116:119], v[24:27]
    ds_read_b64_tr_b16 v[80:81], v9 offset:42048
    ds_read_b64_tr_b16 v[82:83], v9 offset:43328
    s_waitcnt lgkmcnt(15)
    v_mfma_f32_16x16x32_bf16 v[28:31], v[84:87], v[116:119], v[28:31]
    ds_read_b64_tr_b16 v[84:85], v9 offset:42080
    ds_read_b64_tr_b16 v[86:87], v9 offset:43360
    v_mfma_f32_16x16x32_bf16 v[32:35], v[88:91], v[116:119], v[32:35]
    ds_read_b64_tr_b16 v[88:89], v9 offset:42112
    ds_read_b64_tr_b16 v[90:91], v9 offset:43392
    s_waitcnt vmcnt(11)
    s_mov_b32 s47, 32768
    buffer_load_dwordx4 v[116:119], v2, s[4:7], s47 offen
    s_waitcnt lgkmcnt(15)
    v_mfma_f32_16x16x32_bf16 v[16:19], v[52:55], v[120:123], v[16:19]
    s_barrier
    ds_read_b64_tr_b16 v[52:53], v9 offset:47104
    ds_read_b64_tr_b16 v[54:55], v9 offset:48384
    v_mfma_f32_16x16x32_bf16 v[20:23], v[56:59], v[120:123], v[20:23]
    ds_read_b64_tr_b16 v[56:57], v9 offset:47136
    ds_read_b64_tr_b16 v[58:59], v9 offset:48416
    s_waitcnt lgkmcnt(15)
    v_mfma_f32_16x16x32_bf16 v[24:27], v[60:63], v[120:123], v[24:27]
    ds_read_b64_tr_b16 v[60:61], v9 offset:47168
    ds_read_b64_tr_b16 v[62:63], v9 offset:48448
    v_mfma_f32_16x16x32_bf16 v[28:31], v[64:67], v[120:123], v[28:31]
    ds_read_b64_tr_b16 v[64:65], v9 offset:47200
    ds_read_b64_tr_b16 v[66:67], v9 offset:48480
    s_waitcnt lgkmcnt(15)
    v_mfma_f32_16x16x32_bf16 v[32:35], v[68:71], v[120:123], v[32:35]
    ds_read_b64_tr_b16 v[68:69], v9 offset:47232
    ds_read_b64_tr_b16 v[70:71], v9 offset:48512
    s_waitcnt vmcnt(11)
    s_mov_b32 s47, 33792
    buffer_load_dwordx4 v[120:123], v2, s[4:7], s47 offen
    v_mfma_f32_16x16x32_bf16 v[16:19], v[72:75], v[124:127], v[16:19]
    ds_read_b64_tr_b16 v[72:73], v9 offset:52224
    ds_read_b64_tr_b16 v[74:75], v9 offset:53504
    s_waitcnt lgkmcnt(15)
    v_mfma_f32_16x16x32_bf16 v[20:23], v[76:79], v[124:127], v[20:23]
    ds_read_b64_tr_b16 v[76:77], v9 offset:52256
    ds_read_b64_tr_b16 v[78:79], v9 offset:53536
    v_mfma_f32_16x16x32_bf16 v[24:27], v[80:83], v[124:127], v[24:27]
    ds_read_b64_tr_b16 v[80:81], v9 offset:52288
    ds_read_b64_tr_b16 v[82:83], v9 offset:53568
    s_waitcnt lgkmcnt(15)
    v_mfma_f32_16x16x32_bf16 v[28:31], v[84:87], v[124:127], v[28:31]
    ds_read_b64_tr_b16 v[84:85], v9 offset:52320
    ds_read_b64_tr_b16 v[86:87], v9 offset:53600
    v_mfma_f32_16x16x32_bf16 v[32:35], v[88:91], v[124:127], v[32:35]
    ds_read_b64_tr_b16 v[88:89], v9 offset:52352
    ds_read_b64_tr_b16 v[90:91], v9 offset:53632
    s_waitcnt vmcnt(11)
    s_mov_b32 s47, 34816
    buffer_load_dwordx4 v[124:127], v2, s[4:7], s47 offen
    s_waitcnt lgkmcnt(15)
    v_mfma_f32_16x16x32_bf16 v[16:19], v[52:55], v[128:131], v[16:19]
    s_barrier
    ds_read_b64_tr_b16 v[52:53], v8 offset:0
    ds_read_b64_tr_b16 v[54:55], v8 offset:1280
    v_mfma_f32_16x16x32_bf16 v[20:23], v[56:59], v[128:131], v[20:23]
    ds_read_b64_tr_b16 v[56:57], v8 offset:32
    ds_read_b64_tr_b16 v[58:59], v8 offset:1312
    s_waitcnt lgkmcnt(15)
    v_mfma_f32_16x16x32_bf16 v[24:27], v[60:63], v[128:131], v[24:27]
    ds_read_b64_tr_b16 v[60:61], v8 offset:64
    ds_read_b64_tr_b16 v[62:63], v8 offset:1344
    v_mfma_f32_16x16x32_bf16 v[28:31], v[64:67], v[128:131], v[28:31]
    ds_read_b64_tr_b16 v[64:65], v8 offset:96
    ds_read_b64_tr_b16 v[66:67], v8 offset:1376
    s_waitcnt lgkmcnt(15)
    v_mfma_f32_16x16x32_bf16 v[32:35], v[68:71], v[128:131], v[32:35]
    ds_read_b64_tr_b16 v[68:69], v8 offset:128
    ds_read_b64_tr_b16 v[70:71], v8 offset:1408
    s_waitcnt vmcnt(11)
    s_mov_b32 s47, 35840
    buffer_load_dwordx4 v[128:131], v2, s[4:7], s47 offen
    v_mfma_f32_16x16x32_bf16 v[16:19], v[72:75], v[132:135], v[16:19]
    ds_read_b64_tr_b16 v[72:73], v8 offset:5120
    ds_read_b64_tr_b16 v[74:75], v8 offset:6400
    s_waitcnt lgkmcnt(15)
    v_mfma_f32_16x16x32_bf16 v[20:23], v[76:79], v[132:135], v[20:23]
    ds_read_b64_tr_b16 v[76:77], v8 offset:5152
    ds_read_b64_tr_b16 v[78:79], v8 offset:6432
    v_mfma_f32_16x16x32_bf16 v[24:27], v[80:83], v[132:135], v[24:27]
    ds_read_b64_tr_b16 v[80:81], v8 offset:5184
    ds_read_b64_tr_b16 v[82:83], v8 offset:6464
    s_waitcnt lgkmcnt(15)
    v_mfma_f32_16x16x32_bf16 v[28:31], v[84:87], v[132:135], v[28:31]
    ds_read_b64_tr_b16 v[84:85], v8 offset:5216
    ds_read_b64_tr_b16 v[86:87], v8 offset:6496
    v_mfma_f32_16x16x32_bf16 v[32:35], v[88:91], v[132:135], v[32:35]
    ds_read_b64_tr_b16 v[88:89], v8 offset:5248
    ds_read_b64_tr_b16 v[90:91], v8 offset:6528
    s_waitcnt vmcnt(11)
    s_mov_b32 s47, 36864
    buffer_load_dwordx4 v[132:135], v2, s[4:7], s47 offen
    s_waitcnt lgkmcnt(15)
    v_mfma_f32_16x16x32_bf16 v[16:19], v[52:55], v[136:139], v[16:19]
    s_barrier
    ds_read_b64_tr_b16 v[52:53], v8 offset:10240
    ds_read_b64_tr_b16 v[54:55], v8 offset:11520
    v_mfma_f32_16x16x32_bf16 v[20:23], v[56:59], v[136:139], v[20:23]
    ds_read_b64_tr_b16 v[56:57], v8 offset:10272
    ds_read_b64_tr_b16 v[58:59], v8 offset:11552
    s_waitcnt lgkmcnt(15)
    v_mfma_f32_16x16x32_bf16 v[24:27], v[60:63], v[136:139], v[24:27]
    ds_read_b64_tr_b16 v[60:61], v8 offset:10304
    ds_read_b64_tr_b16 v[62:63], v8 offset:11584
    v_mfma_f32_16x16x32_bf16 v[28:31], v[64:67], v[136:139], v[28:31]
    ds_read_b64_tr_b16 v[64:65], v8 offset:10336
    ds_read_b64_tr_b16 v[66:67], v8 offset:11616
    s_waitcnt lgkmcnt(15)
    v_mfma_f32_16x16x32_bf16 v[32:35], v[68:71], v[136:139], v[32:35]
    ds_read_b64_tr_b16 v[68:69], v8 offset:10368
    ds_read_b64_tr_b16 v[70:71], v8 offset:11648
    s_waitcnt vmcnt(11)
    s_mov_b32 s47, 37888
    buffer_load_dwordx4 v[136:139], v2, s[4:7], s47 offen
    v_mfma_f32_16x16x32_bf16 v[16:19], v[72:75], v[140:143], v[16:19]
    ds_read_b64_tr_b16 v[72:73], v8 offset:15360
    ds_read_b64_tr_b16 v[74:75], v8 offset:16640
    s_waitcnt lgkmcnt(15)
    v_mfma_f32_16x16x32_bf16 v[20:23], v[76:79], v[140:143], v[20:23]
    ds_read_b64_tr_b16 v[76:77], v8 offset:15392
    ds_read_b64_tr_b16 v[78:79], v8 offset:16672
    v_mfma_f32_16x16x32_bf16 v[24:27], v[80:83], v[140:143], v[24:27]
    ds_read_b64_tr_b16 v[80:81], v8 offset:15424
    ds_read_b64_tr_b16 v[82:83], v8 offset:16704
    s_waitcnt lgkmcnt(15)
    v_mfma_f32_16x16x32_bf16 v[28:31], v[84:87], v[140:143], v[28:31]
    ds_read_b64_tr_b16 v[84:85], v8 offset:15456
    ds_read_b64_tr_b16 v[86:87], v8 offset:16736
    v_mfma_f32_16x16x32_bf16 v[32:35], v[88:91], v[140:143], v[32:35]
    ds_read_b64_tr_b16 v[88:89], v8 offset:15488
    ds_read_b64_tr_b16 v[90:91], v8 offset:16768
    s_waitcnt vmcnt(11)
    s_mov_b32 s47, 38912
    buffer_load_dwordx4 v[140:143], v2, s[4:7], s47 offen
    s_waitcnt lgkmcnt(15)
    v_mfma_f32_16x16x32_bf16 v[16:19], v[52:55], v[92:95], v[16:19]
    s_barrier
    ds_read_b64_tr_b16 v[52:53], v8 offset:20480
    ds_read_b64_tr_b16 v[54:55], v8 offset:21760
    v_mfma_f32_16x16x32_bf16 v[20:23], v[56:59], v[92:95], v[20:23]
    ds_read_b64_tr_b16 v[56:57], v8 offset:20512
    ds_read_b64_tr_b16 v[58:59], v8 offset:21792
    s_waitcnt lgkmcnt(15)
    v_mfma_f32_16x16x32_bf16 v[24:27], v[60:63], v[92:95], v[24:27]
    ds_read_b64_tr_b16 v[60:61], v8 offset:20544
    ds_read_b64_tr_b16 v[62:63], v8 offset:21824
    v_mfma_f32_16x16x32_bf16 v[28:31], v[64:67], v[92:95], v[28:31]
    ds_read_b64_tr_b16 v[64:65], v8 offset:20576
    ds_read_b64_tr_b16 v[66:67], v8 offset:21856
    s_waitcnt lgkmcnt(15)
    v_mfma_f32_16x16x32_bf16 v[32:35], v[68:71], v[92:95], v[32:35]
    ds_read_b64_tr_b16 v[68:69], v8 offset:20608
    ds_read_b64_tr_b16 v[70:71], v8 offset:21888
    s_waitcnt vmcnt(11)
    s_mov_b32 s47, 39936
    buffer_load_dwordx4 v[92:95], v2, s[4:7], s47 offen
    v_mfma_f32_16x16x32_bf16 v[16:19], v[72:75], v[96:99], v[16:19]
    ds_read_b64_tr_b16 v[72:73], v8 offset:25600
    ds_read_b64_tr_b16 v[74:75], v8 offset:26880
    s_waitcnt lgkmcnt(15)
    v_mfma_f32_16x16x32_bf16 v[20:23], v[76:79], v[96:99], v[20:23]
    ds_read_b64_tr_b16 v[76:77], v8 offset:25632
    ds_read_b64_tr_b16 v[78:79], v8 offset:26912
    v_mfma_f32_16x16x32_bf16 v[24:27], v[80:83], v[96:99], v[24:27]
    ds_read_b64_tr_b16 v[80:81], v8 offset:25664
    ds_read_b64_tr_b16 v[82:83], v8 offset:26944
    s_waitcnt lgkmcnt(15)
    v_mfma_f32_16x16x32_bf16 v[28:31], v[84:87], v[96:99], v[28:31]
    ds_read_b64_tr_b16 v[84:85], v8 offset:25696
    ds_read_b64_tr_b16 v[86:87], v8 offset:26976
    v_mfma_f32_16x16x32_bf16 v[32:35], v[88:91], v[96:99], v[32:35]
    ds_read_b64_tr_b16 v[88:89], v8 offset:25728
    ds_read_b64_tr_b16 v[90:91], v8 offset:27008
    s_waitcnt vmcnt(11)
    s_mov_b32 s47, 40960
    buffer_load_dwordx4 v[96:99], v2, s[4:7], s47 offen
    s_waitcnt lgkmcnt(15)
    v_mfma_f32_16x16x32_bf16 v[16:19], v[52:55], v[100:103], v[16:19]
    s_barrier
    ds_read_b64_tr_b16 v[52:53], v8 offset:30720
    ds_read_b64_tr_b16 v[54:55], v8 offset:32000
    v_mfma_f32_16x16x32_bf16 v[20:23], v[56:59], v[100:103], v[20:23]
    ds_read_b64_tr_b16 v[56:57], v8 offset:30752
    ds_read_b64_tr_b16 v[58:59], v8 offset:32032
    s_waitcnt lgkmcnt(15)
    v_mfma_f32_16x16x32_bf16 v[24:27], v[60:63], v[100:103], v[24:27]
    ds_read_b64_tr_b16 v[60:61], v8 offset:30784
    ds_read_b64_tr_b16 v[62:63], v8 offset:32064
    v_mfma_f32_16x16x32_bf16 v[28:31], v[64:67], v[100:103], v[28:31]
    ds_read_b64_tr_b16 v[64:65], v8 offset:30816
    ds_read_b64_tr_b16 v[66:67], v8 offset:32096
    s_waitcnt lgkmcnt(15)
    v_mfma_f32_16x16x32_bf16 v[32:35], v[68:71], v[100:103], v[32:35]
    ds_read_b64_tr_b16 v[68:69], v8 offset:30848
    ds_read_b64_tr_b16 v[70:71], v8 offset:32128
    s_waitcnt vmcnt(11)
    s_mov_b32 s47, 41984
    buffer_load_dwordx4 v[100:103], v2, s[4:7], s47 offen
    v_mfma_f32_16x16x32_bf16 v[16:19], v[72:75], v[104:107], v[16:19]
    ds_read_b64_tr_b16 v[72:73], v8 offset:35840
    ds_read_b64_tr_b16 v[74:75], v8 offset:37120
    s_waitcnt lgkmcnt(15)
    v_mfma_f32_16x16x32_bf16 v[20:23], v[76:79], v[104:107], v[20:23]
    ds_read_b64_tr_b16 v[76:77], v8 offset:35872
    ds_read_b64_tr_b16 v[78:79], v8 offset:37152
    v_mfma_f32_16x16x32_bf16 v[24:27], v[80:83], v[104:107], v[24:27]
    ds_read_b64_tr_b16 v[80:81], v8 offset:35904
    ds_read_b64_tr_b16 v[82:83], v8 offset:37184
    s_waitcnt lgkmcnt(15)
    v_mfma_f32_16x16x32_bf16 v[28:31], v[84:87], v[104:107], v[28:31]
    ds_read_b64_tr_b16 v[84:85], v8 offset:35936
    ds_read_b64_tr_b16 v[86:87], v8 offset:37216
    v_mfma_f32_16x16x32_bf16 v[32:35], v[88:91], v[104:107], v[32:35]
    ds_read_b64_tr_b16 v[88:89], v8 offset:35968
    ds_read_b64_tr_b16 v[90:91], v8 offset:37248
    s_waitcnt vmcnt(11)
    s_mov_b32 s47, 43008
    buffer_load_dwordx4 v[104:107], v2, s[4:7], s47 offen
    s_waitcnt lgkmcnt(15)
    v_mfma_f32_16x16x32_bf16 v[16:19], v[52:55], v[108:111], v[16:19]
    s_barrier
    ds_read_b64_tr_b16 v[52:53], v8 offset:40960
    ds_read_b64_tr_b16 v[54:55], v8 offset:42240
    v_mfma_f32_16x16x32_bf16 v[20:23], v[56:59], v[108:111], v[20:23]
    ds_read_b64_tr_b16 v[56:57], v8 offset:40992
    ds_read_b64_tr_b16 v[58:59], v8 offset:42272
    s_waitcnt lgkmcnt(15)
    v_mfma_f32_16x16x32_bf16 v[24:27], v[60:63], v[108:111], v[24:27]
    ds_read_b64_tr_b16 v[60:61], v8 offset:41024
    ds_read_b64_tr_b16 v[62:63], v8 offset:42304
    v_mfma_f32_16x16x32_bf16 v[28:31], v[64:67], v[108:111], v[28:31]
    ds_read_b64_tr_b16 v[64:65], v8 offset:41056
    ds_read_b64_tr_b16 v[66:67], v8 offset:42336
    s_waitcnt lgkmcnt(15)
    v_mfma_f32_16x16x32_bf16 v[32:35], v[68:71], v[108:111], v[32:35]
    ds_read_b64_tr_b16 v[68:69], v8 offset:41088
    ds_read_b64_tr_b16 v[70:71], v8 offset:42368
    s_waitcnt vmcnt(11)
    s_mov_b32 s47, 44032
    buffer_load_dwordx4 v[108:111], v2, s[4:7], s47 offen
    v_mfma_f32_16x16x32_bf16 v[16:19], v[72:75], v[112:115], v[16:19]
    ds_read_b64_tr_b16 v[72:73], v8 offset:46080
    ds_read_b64_tr_b16 v[74:75], v8 offset:47360
    s_waitcnt lgkmcnt(15)
    v_mfma_f32_16x16x32_bf16 v[20:23], v[76:79], v[112:115], v[20:23]
    ds_read_b64_tr_b16 v[76:77], v8 offset:46112
    ds_read_b64_tr_b16 v[78:79], v8 offset:47392
    v_mfma_f32_16x16x32_bf16 v[24:27], v[80:83], v[112:115], v[24:27]
    ds_read_b64_tr_b16 v[80:81], v8 offset:46144
    ds_read_b64_tr_b16 v[82:83], v8 offset:47424
    s_waitcnt lgkmcnt(15)
    v_mfma_f32_16x16x32_bf16 v[28:31], v[84:87], v[112:115], v[28:31]
    ds_read_b64_tr_b16 v[84:85], v8 offset:46176
    ds_read_b64_tr_b16 v[86:87], v8 offset:47456
    v_mfma_f32_16x16x32_bf16 v[32:35], v[88:91], v[112:115], v[32:35]
    ds_read_b64_tr_b16 v[88:89], v8 offset:46208
    ds_read_b64_tr_b16 v[90:91], v8 offset:47488
    s_waitcnt vmcnt(11)
    s_mov_b32 s47, 45056
    buffer_load_dwordx4 v[112:115], v2, s[4:7], s47 offen
    s_waitcnt lgkmcnt(15)
    v_mfma_f32_16x16x32_bf16 v[16:19], v[52:55], v[116:119], v[16:19]
    s_barrier
    ds_read_b64_tr_b16 v[52:53], v8 offset:51200
    ds_read_b64_tr_b16 v[54:55], v8 offset:52480
    v_mfma_f32_16x16x32_bf16 v[20:23], v[56:59], v[116:119], v[20:23]
    ds_read_b64_tr_b16 v[56:57], v8 offset:51232
    ds_read_b64_tr_b16 v[58:59], v8 offset:52512
    s_waitcnt lgkmcnt(15)
    v_mfma_f32_16x16x32_bf16 v[24:27], v[60:63], v[116:119], v[24:27]
    ds_read_b64_tr_b16 v[60:61], v8 offset:51264
    ds_read_b64_tr_b16 v[62:63], v8 offset:52544
    v_mfma_f32_16x16x32_bf16 v[28:31], v[64:67], v[116:119], v[28:31]
    ds_read_b64_tr_b16 v[64:65], v8 offset:51296
    ds_read_b64_tr_b16 v[66:67], v8 offset:52576
    s_waitcnt lgkmcnt(15)
    v_mfma_f32_16x16x32_bf16 v[32:35], v[68:71], v[116:119], v[32:35]
    ds_read_b64_tr_b16 v[68:69], v8 offset:51328
    ds_read_b64_tr_b16 v[70:71], v8 offset:52608
    s_waitcnt vmcnt(11)
    s_mov_b32 s47, 46080
    buffer_load_dwordx4 v[116:119], v2, s[4:7], s47 offen
    v_mfma_f32_16x16x32_bf16 v[16:19], v[72:75], v[120:123], v[16:19]
    ds_read_b64_tr_b16 v[72:73], v8 offset:56320
    ds_read_b64_tr_b16 v[74:75], v8 offset:57600
    s_waitcnt lgkmcnt(15)
    v_mfma_f32_16x16x32_bf16 v[20:23], v[76:79], v[120:123], v[20:23]
    ds_read_b64_tr_b16 v[76:77], v8 offset:56352
    ds_read_b64_tr_b16 v[78:79], v8 offset:57632
    v_mfma_f32_16x16x32_bf16 v[24:27], v[80:83], v[120:123], v[24:27]
    ds_read_b64_tr_b16 v[80:81], v8 offset:56384
    ds_read_b64_tr_b16 v[82:83], v8 offset:57664
    s_waitcnt lgkmcnt(15)
    v_mfma_f32_16x16x32_bf16 v[28:31], v[84:87], v[120:123], v[28:31]
    ds_read_b64_tr_b16 v[84:85], v8 offset:56416
    ds_read_b64_tr_b16 v[86:87], v8 offset:57696
    v_mfma_f32_16x16x32_bf16 v[32:35], v[88:91], v[120:123], v[32:35]
    ds_read_b64_tr_b16 v[88:89], v8 offset:56448
    ds_read_b64_tr_b16 v[90:91], v8 offset:57728
    s_waitcnt vmcnt(11)
    s_mov_b32 s47, 47104
    buffer_load_dwordx4 v[120:123], v2, s[4:7], s47 offen
    s_waitcnt lgkmcnt(15)
    v_mfma_f32_16x16x32_bf16 v[16:19], v[52:55], v[124:127], v[16:19]
    s_barrier
    ds_read_b64_tr_b16 v[52:53], v8 offset:61440
    ds_read_b64_tr_b16 v[54:55], v8 offset:62720
    v_mfma_f32_16x16x32_bf16 v[20:23], v[56:59], v[124:127], v[20:23]
    ds_read_b64_tr_b16 v[56:57], v8 offset:61472
    ds_read_b64_tr_b16 v[58:59], v8 offset:62752
    s_waitcnt lgkmcnt(15)
    v_mfma_f32_16x16x32_bf16 v[24:27], v[60:63], v[124:127], v[24:27]
    ds_read_b64_tr_b16 v[60:61], v8 offset:61504
    ds_read_b64_tr_b16 v[62:63], v8 offset:62784
    v_mfma_f32_16x16x32_bf16 v[28:31], v[64:67], v[124:127], v[28:31]
    ds_read_b64_tr_b16 v[64:65], v8 offset:61536
    ds_read_b64_tr_b16 v[66:67], v8 offset:62816
    s_waitcnt lgkmcnt(15)
    v_mfma_f32_16x16x32_bf16 v[32:35], v[68:71], v[124:127], v[32:35]
    ds_read_b64_tr_b16 v[68:69], v8 offset:61568
    ds_read_b64_tr_b16 v[70:71], v8 offset:62848
    s_waitcnt vmcnt(11)
    s_mov_b32 s47, 48128
    buffer_load_dwordx4 v[124:127], v2, s[4:7], s47 offen
    v_mfma_f32_16x16x32_bf16 v[16:19], v[72:75], v[128:131], v[16:19]
    ds_read_b64_tr_b16 v[72:73], v9 offset:1024
    ds_read_b64_tr_b16 v[74:75], v9 offset:2304
    s_waitcnt lgkmcnt(15)
    v_mfma_f32_16x16x32_bf16 v[20:23], v[76:79], v[128:131], v[20:23]
    ds_read_b64_tr_b16 v[76:77], v9 offset:1056
    ds_read_b64_tr_b16 v[78:79], v9 offset:2336
    v_mfma_f32_16x16x32_bf16 v[24:27], v[80:83], v[128:131], v[24:27]
    ds_read_b64_tr_b16 v[80:81], v9 offset:1088
    ds_read_b64_tr_b16 v[82:83], v9 offset:2368
    s_waitcnt lgkmcnt(15)
    v_mfma_f32_16x16x32_bf16 v[28:31], v[84:87], v[128:131], v[28:31]
    ds_read_b64_tr_b16 v[84:85], v9 offset:1120
    ds_read_b64_tr_b16 v[86:87], v9 offset:2400
    v_mfma_f32_16x16x32_bf16 v[32:35], v[88:91], v[128:131], v[32:35]
    ds_read_b64_tr_b16 v[88:89], v9 offset:1152
    ds_read_b64_tr_b16 v[90:91], v9 offset:2432
    s_waitcnt vmcnt(11)
    s_mov_b32 s47, 49152
    buffer_load_dwordx4 v[128:131], v2, s[4:7], s47 offen
    s_waitcnt lgkmcnt(15)
    v_mfma_f32_16x16x32_bf16 v[16:19], v[52:55], v[132:135], v[16:19]
    s_barrier
    ds_read_b64_tr_b16 v[52:53], v9 offset:6144
    ds_read_b64_tr_b16 v[54:55], v9 offset:7424
    v_mfma_f32_16x16x32_bf16 v[20:23], v[56:59], v[132:135], v[20:23]
    ds_read_b64_tr_b16 v[56:57], v9 offset:6176
    ds_read_b64_tr_b16 v[58:59], v9 offset:7456
    s_waitcnt lgkmcnt(15)
    v_mfma_f32_16x16x32_bf16 v[24:27], v[60:63], v[132:135], v[24:27]
    ds_read_b64_tr_b16 v[60:61], v9 offset:6208
    ds_read_b64_tr_b16 v[62:63], v9 offset:7488
    v_mfma_f32_16x16x32_bf16 v[28:31], v[64:67], v[132:135], v[28:31]
    ds_read_b64_tr_b16 v[64:65], v9 offset:6240
    ds_read_b64_tr_b16 v[66:67], v9 offset:7520
    s_waitcnt lgkmcnt(15)
    v_mfma_f32_16x16x32_bf16 v[32:35], v[68:71], v[132:135], v[32:35]
    ds_read_b64_tr_b16 v[68:69], v9 offset:6272
    ds_read_b64_tr_b16 v[70:71], v9 offset:7552
    s_waitcnt vmcnt(11)
    s_mov_b32 s47, 50176
    buffer_load_dwordx4 v[132:135], v2, s[4:7], s47 offen
    v_mfma_f32_16x16x32_bf16 v[16:19], v[72:75], v[136:139], v[16:19]
    ds_read_b64_tr_b16 v[72:73], v9 offset:11264
    ds_read_b64_tr_b16 v[74:75], v9 offset:12544
    s_waitcnt lgkmcnt(15)
    v_mfma_f32_16x16x32_bf16 v[20:23], v[76:79], v[136:139], v[20:23]
    ds_read_b64_tr_b16 v[76:77], v9 offset:11296
    ds_read_b64_tr_b16 v[78:79], v9 offset:12576
    v_mfma_f32_16x16x32_bf16 v[24:27], v[80:83], v[136:139], v[24:27]
    ds_read_b64_tr_b16 v[80:81], v9 offset:11328
    ds_read_b64_tr_b16 v[82:83], v9 offset:12608
    s_waitcnt lgkmcnt(15)
    v_mfma_f32_16x16x32_bf16 v[28:31], v[84:87], v[136:139], v[28:31]
    ds_read_b64_tr_b16 v[84:85], v9 offset:11360
    ds_read_b64_tr_b16 v[86:87], v9 offset:12640
    v_mfma_f32_16x16x32_bf16 v[32:35], v[88:91], v[136:139], v[32:35]
    ds_read_b64_tr_b16 v[88:89], v9 offset:11392
    ds_read_b64_tr_b16 v[90:91], v9 offset:12672
    s_waitcnt vmcnt(11)
    s_mov_b32 s47, 51200
    buffer_load_dwordx4 v[136:139], v2, s[4:7], s47 offen
    s_waitcnt lgkmcnt(15)
    v_mfma_f32_16x16x32_bf16 v[16:19], v[52:55], v[140:143], v[16:19]
    s_barrier
    ds_read_b64_tr_b16 v[52:53], v9 offset:16384
    ds_read_b64_tr_b16 v[54:55], v9 offset:17664
    v_mfma_f32_16x16x32_bf16 v[20:23], v[56:59], v[140:143], v[20:23]
    ds_read_b64_tr_b16 v[56:57], v9 offset:16416
    ds_read_b64_tr_b16 v[58:59], v9 offset:17696
    s_waitcnt lgkmcnt(15)
    v_mfma_f32_16x16x32_bf16 v[24:27], v[60:63], v[140:143], v[24:27]
    ds_read_b64_tr_b16 v[60:61], v9 offset:16448
    ds_read_b64_tr_b16 v[62:63], v9 offset:17728
    v_mfma_f32_16x16x32_bf16 v[28:31], v[64:67], v[140:143], v[28:31]
    ds_read_b64_tr_b16 v[64:65], v9 offset:16480
    ds_read_b64_tr_b16 v[66:67], v9 offset:17760
    s_waitcnt lgkmcnt(15)
    v_mfma_f32_16x16x32_bf16 v[32:35], v[68:71], v[140:143], v[32:35]
    ds_read_b64_tr_b16 v[68:69], v9 offset:16512
    ds_read_b64_tr_b16 v[70:71], v9 offset:17792
    s_waitcnt vmcnt(11)
    s_mov_b32 s47, 52224
    buffer_load_dwordx4 v[140:143], v2, s[4:7], s47 offen
    v_mfma_f32_16x16x32_bf16 v[16:19], v[72:75], v[92:95], v[16:19]
    ds_read_b64_tr_b16 v[72:73], v9 offset:21504
    ds_read_b64_tr_b16 v[74:75], v9 offset:22784
    s_waitcnt lgkmcnt(15)
    v_mfma_f32_16x16x32_bf16 v[20:23], v[76:79], v[92:95], v[20:23]
    ds_read_b64_tr_b16 v[76:77], v9 offset:21536
    ds_read_b64_tr_b16 v[78:79], v9 offset:22816
    v_mfma_f32_16x16x32_bf16 v[24:27], v[80:83], v[92:95], v[24:27]
    ds_read_b64_tr_b16 v[80:81], v9 offset:21568
    ds_read_b64_tr_b16 v[82:83], v9 offset:22848
    s_waitcnt lgkmcnt(15)
    v_mfma_f32_16x16x32_bf16 v[28:31], v[84:87], v[92:95], v[28:31]
    ds_read_b64_tr_b16 v[84:85], v9 offset:21600
    ds_read_b64_tr_b16 v[86:87], v9 offset:22880
    v_mfma_f32_16x16x32_bf16 v[32:35], v[88:91], v[92:95], v[32:35]
    ds_read_b64_tr_b16 v[88:89], v9 offset:21632
    ds_read_b64_tr_b16 v[90:91], v9 offset:22912
    s_waitcnt vmcnt(11)
    s_mov_b32 s47, 53248
    buffer_load_dwordx4 v[92:95], v2, s[4:7], s47 offen
    s_waitcnt lgkmcnt(15)
    v_mfma_f32_16x16x32_bf16 v[16:19], v[52:55], v[96:99], v[16:19]
    s_barrier
    ds_read_b64_tr_b16 v[52:53], v9 offset:26624
    ds_read_b64_tr_b16 v[54:55], v9 offset:27904
    v_mfma_f32_16x16x32_bf16 v[20:23], v[56:59], v[96:99], v[20:23]
    ds_read_b64_tr_b16 v[56:57], v9 offset:26656
    ds_read_b64_tr_b16 v[58:59], v9 offset:27936
    s_waitcnt lgkmcnt(15)
    v_mfma_f32_16x16x32_bf16 v[24:27], v[60:63], v[96:99], v[24:27]
    ds_read_b64_tr_b16 v[60:61], v9 offset:26688
    ds_read_b64_tr_b16 v[62:63], v9 offset:27968
    v_mfma_f32_16x16x32_bf16 v[28:31], v[64:67], v[96:99], v[28:31]
    ds_read_b64_tr_b16 v[64:65], v9 offset:26720
    ds_read_b64_tr_b16 v[66:67], v9 offset:28000
    s_waitcnt lgkmcnt(15)
    v_mfma_f32_16x16x32_bf16 v[32:35], v[68:71], v[96:99], v[32:35]
    ds_read_b64_tr_b16 v[68:69], v9 offset:26752
    ds_read_b64_tr_b16 v[70:71], v9 offset:28032
    s_waitcnt vmcnt(11)
    s_mov_b32 s47, 54272
    buffer_load_dwordx4 v[96:99], v2, s[4:7], s47 offen
    v_mfma_f32_16x16x32_bf16 v[16:19], v[72:75], v[100:103], v[16:19]
    ds_read_b64_tr_b16 v[72:73], v9 offset:31744
    ds_read_b64_tr_b16 v[74:75], v9 offset:33024
    s_waitcnt lgkmcnt(15)
    v_mfma_f32_16x16x32_bf16 v[20:23], v[76:79], v[100:103], v[20:23]
    ds_read_b64_tr_b16 v[76:77], v9 offset:31776
    ds_read_b64_tr_b16 v[78:79], v9 offset:33056
    v_mfma_f32_16x16x32_bf16 v[24:27], v[80:83], v[100:103], v[24:27]
    ds_read_b64_tr_b16 v[80:81], v9 offset:31808
    ds_read_b64_tr_b16 v[82:83], v9 offset:33088
    s_waitcnt lgkmcnt(15)
    v_mfma_f32_16x16x32_bf16 v[28:31], v[84:87], v[100:103], v[28:31]
    ds_read_b64_tr_b16 v[84:85], v9 offset:31840
    ds_read_b64_tr_b16 v[86:87], v9 offset:33120
    v_mfma_f32_16x16x32_bf16 v[32:35], v[88:91], v[100:103], v[32:35]
    ds_read_b64_tr_b16 v[88:89], v9 offset:31872
    ds_read_b64_tr_b16 v[90:91], v9 offset:33152
    s_waitcnt vmcnt(11)
    s_waitcnt lgkmcnt(15)
    v_mfma_f32_16x16x32_bf16 v[16:19], v[52:55], v[104:107], v[16:19]
    s_barrier
    ds_read_b64_tr_b16 v[52:53], v9 offset:36864
    ds_read_b64_tr_b16 v[54:55], v9 offset:38144
    v_mfma_f32_16x16x32_bf16 v[20:23], v[56:59], v[104:107], v[20:23]
    ds_read_b64_tr_b16 v[56:57], v9 offset:36896
    ds_read_b64_tr_b16 v[58:59], v9 offset:38176
    s_waitcnt lgkmcnt(15)
    v_mfma_f32_16x16x32_bf16 v[24:27], v[60:63], v[104:107], v[24:27]
    ds_read_b64_tr_b16 v[60:61], v9 offset:36928
    ds_read_b64_tr_b16 v[62:63], v9 offset:38208
    v_mfma_f32_16x16x32_bf16 v[28:31], v[64:67], v[104:107], v[28:31]
    ds_read_b64_tr_b16 v[64:65], v9 offset:36960
    ds_read_b64_tr_b16 v[66:67], v9 offset:38240
    s_waitcnt lgkmcnt(15)
    v_mfma_f32_16x16x32_bf16 v[32:35], v[68:71], v[104:107], v[32:35]
    ds_read_b64_tr_b16 v[68:69], v9 offset:36992
    ds_read_b64_tr_b16 v[70:71], v9 offset:38272
    s_waitcnt vmcnt(10)
    v_mfma_f32_16x16x32_bf16 v[16:19], v[72:75], v[108:111], v[16:19]
    ds_read_b64_tr_b16 v[72:73], v9 offset:41984
    ds_read_b64_tr_b16 v[74:75], v9 offset:43264
    s_waitcnt lgkmcnt(15)
    v_mfma_f32_16x16x32_bf16 v[20:23], v[76:79], v[108:111], v[20:23]
    ds_read_b64_tr_b16 v[76:77], v9 offset:42016
    ds_read_b64_tr_b16 v[78:79], v9 offset:43296
    v_mfma_f32_16x16x32_bf16 v[24:27], v[80:83], v[108:111], v[24:27]
    ds_read_b64_tr_b16 v[80:81], v9 offset:42048
    ds_read_b64_tr_b16 v[82:83], v9 offset:43328
    s_waitcnt lgkmcnt(15)
    v_mfma_f32_16x16x32_bf16 v[28:31], v[84:87], v[108:111], v[28:31]
    ds_read_b64_tr_b16 v[84:85], v9 offset:42080
    ds_read_b64_tr_b16 v[86:87], v9 offset:43360
    v_mfma_f32_16x16x32_bf16 v[32:35], v[88:91], v[108:111], v[32:35]
    ds_read_b64_tr_b16 v[88:89], v9 offset:42112
    ds_read_b64_tr_b16 v[90:91], v9 offset:43392
    s_waitcnt vmcnt(9)
    s_waitcnt lgkmcnt(15)
    v_mfma_f32_16x16x32_bf16 v[16:19], v[52:55], v[112:115], v[16:19]
    s_barrier
    ds_read_b64_tr_b16 v[52:53], v9 offset:47104
    ds_read_b64_tr_b16 v[54:55], v9 offset:48384
    v_mfma_f32_16x16x32_bf16 v[20:23], v[56:59], v[112:115], v[20:23]
    ds_read_b64_tr_b16 v[56:57], v9 offset:47136
    ds_read_b64_tr_b16 v[58:59], v9 offset:48416
    s_waitcnt lgkmcnt(15)
    v_mfma_f32_16x16x32_bf16 v[24:27], v[60:63], v[112:115], v[24:27]
    ds_read_b64_tr_b16 v[60:61], v9 offset:47168
    ds_read_b64_tr_b16 v[62:63], v9 offset:48448
    v_mfma_f32_16x16x32_bf16 v[28:31], v[64:67], v[112:115], v[28:31]
    ds_read_b64_tr_b16 v[64:65], v9 offset:47200
    ds_read_b64_tr_b16 v[66:67], v9 offset:48480
    s_waitcnt lgkmcnt(15)
    v_mfma_f32_16x16x32_bf16 v[32:35], v[68:71], v[112:115], v[32:35]
    ds_read_b64_tr_b16 v[68:69], v9 offset:47232
    ds_read_b64_tr_b16 v[70:71], v9 offset:48512
    s_waitcnt vmcnt(8)
    v_mfma_f32_16x16x32_bf16 v[16:19], v[72:75], v[116:119], v[16:19]
    ds_read_b64_tr_b16 v[72:73], v9 offset:52224
    ds_read_b64_tr_b16 v[74:75], v9 offset:53504
    s_waitcnt lgkmcnt(15)
    v_mfma_f32_16x16x32_bf16 v[20:23], v[76:79], v[116:119], v[20:23]
    ds_read_b64_tr_b16 v[76:77], v9 offset:52256
    ds_read_b64_tr_b16 v[78:79], v9 offset:53536
    v_mfma_f32_16x16x32_bf16 v[24:27], v[80:83], v[116:119], v[24:27]
    ds_read_b64_tr_b16 v[80:81], v9 offset:52288
    ds_read_b64_tr_b16 v[82:83], v9 offset:53568
    s_waitcnt lgkmcnt(15)
    v_mfma_f32_16x16x32_bf16 v[28:31], v[84:87], v[116:119], v[28:31]
    ds_read_b64_tr_b16 v[84:85], v9 offset:52320
    ds_read_b64_tr_b16 v[86:87], v9 offset:53600
    v_mfma_f32_16x16x32_bf16 v[32:35], v[88:91], v[116:119], v[32:35]
    ds_read_b64_tr_b16 v[88:89], v9 offset:52352
    ds_read_b64_tr_b16 v[90:91], v9 offset:53632
    s_waitcnt vmcnt(7)
    s_waitcnt lgkmcnt(15)
    v_mfma_f32_16x16x32_bf16 v[16:19], v[52:55], v[120:123], v[16:19]
    s_barrier
    ds_read_b64_tr_b16 v[52:53], v8 offset:0
    ds_read_b64_tr_b16 v[54:55], v8 offset:1280
    v_mfma_f32_16x16x32_bf16 v[20:23], v[56:59], v[120:123], v[20:23]
    ds_read_b64_tr_b16 v[56:57], v8 offset:32
    ds_read_b64_tr_b16 v[58:59], v8 offset:1312
    s_waitcnt lgkmcnt(15)
    v_mfma_f32_16x16x32_bf16 v[24:27], v[60:63], v[120:123], v[24:27]
    ds_read_b64_tr_b16 v[60:61], v8 offset:64
    ds_read_b64_tr_b16 v[62:63], v8 offset:1344
    v_mfma_f32_16x16x32_bf16 v[28:31], v[64:67], v[120:123], v[28:31]
    ds_read_b64_tr_b16 v[64:65], v8 offset:96
    ds_read_b64_tr_b16 v[66:67], v8 offset:1376
    s_waitcnt lgkmcnt(15)
    v_mfma_f32_16x16x32_bf16 v[32:35], v[68:71], v[120:123], v[32:35]
    ds_read_b64_tr_b16 v[68:69], v8 offset:128
    ds_read_b64_tr_b16 v[70:71], v8 offset:1408
    s_waitcnt vmcnt(6)
    v_mfma_f32_16x16x32_bf16 v[16:19], v[72:75], v[124:127], v[16:19]
    ds_read_b64_tr_b16 v[72:73], v8 offset:5120
    ds_read_b64_tr_b16 v[74:75], v8 offset:6400
    s_waitcnt lgkmcnt(15)
    v_mfma_f32_16x16x32_bf16 v[20:23], v[76:79], v[124:127], v[20:23]
    ds_read_b64_tr_b16 v[76:77], v8 offset:5152
    ds_read_b64_tr_b16 v[78:79], v8 offset:6432
    v_mfma_f32_16x16x32_bf16 v[24:27], v[80:83], v[124:127], v[24:27]
    ds_read_b64_tr_b16 v[80:81], v8 offset:5184
    ds_read_b64_tr_b16 v[82:83], v8 offset:6464
    s_waitcnt lgkmcnt(15)
    v_mfma_f32_16x16x32_bf16 v[28:31], v[84:87], v[124:127], v[28:31]
    ds_read_b64_tr_b16 v[84:85], v8 offset:5216
    ds_read_b64_tr_b16 v[86:87], v8 offset:6496
    v_mfma_f32_16x16x32_bf16 v[32:35], v[88:91], v[124:127], v[32:35]
    ds_read_b64_tr_b16 v[88:89], v8 offset:5248
    ds_read_b64_tr_b16 v[90:91], v8 offset:6528
    s_waitcnt vmcnt(5)
    s_waitcnt lgkmcnt(15)
    v_mfma_f32_16x16x32_bf16 v[16:19], v[52:55], v[128:131], v[16:19]
    s_barrier
    ds_read_b64_tr_b16 v[52:53], v8 offset:10240
    ds_read_b64_tr_b16 v[54:55], v8 offset:11520
    v_mfma_f32_16x16x32_bf16 v[20:23], v[56:59], v[128:131], v[20:23]
    ds_read_b64_tr_b16 v[56:57], v8 offset:10272
    ds_read_b64_tr_b16 v[58:59], v8 offset:11552
    s_waitcnt lgkmcnt(15)
    v_mfma_f32_16x16x32_bf16 v[24:27], v[60:63], v[128:131], v[24:27]
    ds_read_b64_tr_b16 v[60:61], v8 offset:10304
    ds_read_b64_tr_b16 v[62:63], v8 offset:11584
    v_mfma_f32_16x16x32_bf16 v[28:31], v[64:67], v[128:131], v[28:31]
    ds_read_b64_tr_b16 v[64:65], v8 offset:10336
    ds_read_b64_tr_b16 v[66:67], v8 offset:11616
    s_waitcnt lgkmcnt(15)
    v_mfma_f32_16x16x32_bf16 v[32:35], v[68:71], v[128:131], v[32:35]
    ds_read_b64_tr_b16 v[68:69], v8 offset:10368
    ds_read_b64_tr_b16 v[70:71], v8 offset:11648
    s_waitcnt vmcnt(4)
    v_mfma_f32_16x16x32_bf16 v[16:19], v[72:75], v[132:135], v[16:19]
    ds_read_b64_tr_b16 v[72:73], v8 offset:15360
    ds_read_b64_tr_b16 v[74:75], v8 offset:16640
    s_waitcnt lgkmcnt(15)
    v_mfma_f32_16x16x32_bf16 v[20:23], v[76:79], v[132:135], v[20:23]
    ds_read_b64_tr_b16 v[76:77], v8 offset:15392
    ds_read_b64_tr_b16 v[78:79], v8 offset:16672
    v_mfma_f32_16x16x32_bf16 v[24:27], v[80:83], v[132:135], v[24:27]
    ds_read_b64_tr_b16 v[80:81], v8 offset:15424
    ds_read_b64_tr_b16 v[82:83], v8 offset:16704
    s_waitcnt lgkmcnt(15)
    v_mfma_f32_16x16x32_bf16 v[28:31], v[84:87], v[132:135], v[28:31]
    ds_read_b64_tr_b16 v[84:85], v8 offset:15456
    ds_read_b64_tr_b16 v[86:87], v8 offset:16736
    v_mfma_f32_16x16x32_bf16 v[32:35], v[88:91], v[132:135], v[32:35]
    ds_read_b64_tr_b16 v[88:89], v8 offset:15488
    ds_read_b64_tr_b16 v[90:91], v8 offset:16768
    s_waitcnt vmcnt(3)
    s_waitcnt lgkmcnt(15)
    v_mfma_f32_16x16x32_bf16 v[16:19], v[52:55], v[136:139], v[16:19]
    s_barrier
    ds_read_b64_tr_b16 v[52:53], v8 offset:20480
    ds_read_b64_tr_b16 v[54:55], v8 offset:21760
    v_mfma_f32_16x16x32_bf16 v[20:23], v[56:59], v[136:139], v[20:23]
    ds_read_b64_tr_b16 v[56:57], v8 offset:20512
    ds_read_b64_tr_b16 v[58:59], v8 offset:21792
    s_waitcnt lgkmcnt(15)
    v_mfma_f32_16x16x32_bf16 v[24:27], v[60:63], v[136:139], v[24:27]
    ds_read_b64_tr_b16 v[60:61], v8 offset:20544
    ds_read_b64_tr_b16 v[62:63], v8 offset:21824
    v_mfma_f32_16x16x32_bf16 v[28:31], v[64:67], v[136:139], v[28:31]
    ds_read_b64_tr_b16 v[64:65], v8 offset:20576
    ds_read_b64_tr_b16 v[66:67], v8 offset:21856
    s_waitcnt lgkmcnt(15)
    v_mfma_f32_16x16x32_bf16 v[32:35], v[68:71], v[136:139], v[32:35]
    ds_read_b64_tr_b16 v[68:69], v8 offset:20608
    ds_read_b64_tr_b16 v[70:71], v8 offset:21888
    s_waitcnt vmcnt(2)
    v_mfma_f32_16x16x32_bf16 v[16:19], v[72:75], v[140:143], v[16:19]
    ds_read_b64_tr_b16 v[72:73], v8 offset:25600
    ds_read_b64_tr_b16 v[74:75], v8 offset:26880
    s_waitcnt lgkmcnt(15)
    v_mfma_f32_16x16x32_bf16 v[20:23], v[76:79], v[140:143], v[20:23]
    ds_read_b64_tr_b16 v[76:77], v8 offset:25632
    ds_read_b64_tr_b16 v[78:79], v8 offset:26912
    v_mfma_f32_16x16x32_bf16 v[24:27], v[80:83], v[140:143], v[24:27]
    ds_read_b64_tr_b16 v[80:81], v8 offset:25664
    ds_read_b64_tr_b16 v[82:83], v8 offset:26944
    s_waitcnt lgkmcnt(15)
    v_mfma_f32_16x16x32_bf16 v[28:31], v[84:87], v[140:143], v[28:31]
    ds_read_b64_tr_b16 v[84:85], v8 offset:25696
    ds_read_b64_tr_b16 v[86:87], v8 offset:26976
    v_mfma_f32_16x16x32_bf16 v[32:35], v[88:91], v[140:143], v[32:35]
    ds_read_b64_tr_b16 v[88:89], v8 offset:25728
    ds_read_b64_tr_b16 v[90:91], v8 offset:27008
    s_waitcnt vmcnt(1)
    s_waitcnt lgkmcnt(15)
    v_mfma_f32_16x16x32_bf16 v[16:19], v[52:55], v[92:95], v[16:19]
    v_mfma_f32_16x16x32_bf16 v[20:23], v[56:59], v[92:95], v[20:23]
    s_waitcnt lgkmcnt(14)
    v_mfma_f32_16x16x32_bf16 v[24:27], v[60:63], v[92:95], v[24:27]
    s_waitcnt lgkmcnt(12)
    v_mfma_f32_16x16x32_bf16 v[28:31], v[64:67], v[92:95], v[28:31]
    s_waitcnt lgkmcnt(10)
    v_mfma_f32_16x16x32_bf16 v[32:35], v[68:71], v[92:95], v[32:35]
    s_waitcnt vmcnt(0)
    s_waitcnt lgkmcnt(8)
    v_mfma_f32_16x16x32_bf16 v[16:19], v[72:75], v[96:99], v[16:19]
    s_waitcnt lgkmcnt(6)
    v_mfma_f32_16x16x32_bf16 v[20:23], v[76:79], v[96:99], v[20:23]
    s_waitcnt lgkmcnt(4)
    v_mfma_f32_16x16x32_bf16 v[24:27], v[80:83], v[96:99], v[24:27]
    s_waitcnt lgkmcnt(2)
    v_mfma_f32_16x16x32_bf16 v[28:31], v[84:87], v[96:99], v[28:31]
    s_waitcnt lgkmcnt(0)
    v_mfma_f32_16x16x32_bf16 v[32:35], v[88:91], v[96:99], v[32:35]
    s_nop 7
    s_waitcnt vmcnt(0)
    v_lshlrev_b32 v144, 16, v36
    v_and_b32 v145, 0xffff0000, v36
    v_add_f32 v16, v16, v144
    v_add_f32 v17, v17, v145
    v_cvt_pk_bf16_f32 v36, v16, v17
    v_lshlrev_b32 v144, 16, v37
    v_and_b32 v145, 0xffff0000, v37
    v_add_f32 v18, v18, v144
    v_add_f32 v19, v19, v145
    v_cvt_pk_bf16_f32 v37, v18, v19
    buffer_store_dwordx2 v[36:37], v47, s[20:23], 0 offen offset:0
    v_lshlrev_b32 v144, 16, v38
    v_and_b32 v145, 0xffff0000, v38
    v_add_f32 v20, v20, v144
    v_add_f32 v21, v21, v145
    v_cvt_pk_bf16_f32 v38, v20, v21
    v_lshlrev_b32 v144, 16, v39
    v_and_b32 v145, 0xffff0000, v39
    v_add_f32 v22, v22, v144
    v_add_f32 v23, v23, v145
    v_cvt_pk_bf16_f32 v39, v22, v23
    buffer_store_dwordx2 v[38:39], v47, s[20:23], 0 offen offset:32
    v_lshlrev_b32 v144, 16, v40
    v_and_b32 v145, 0xffff0000, v40
    v_add_f32 v24, v24, v144
    v_add_f32 v25, v25, v145
    v_cvt_pk_bf16_f32 v40, v24, v25
    v_lshlrev_b32 v144, 16, v41
    v_and_b32 v145, 0xffff0000, v41
    v_add_f32 v26, v26, v144
    v_add_f32 v27, v27, v145
    v_cvt_pk_bf16_f32 v41, v26, v27
    buffer_store_dwordx2 v[40:41], v47, s[20:23], 0 offen offset:64
    v_lshlrev_b32 v144, 16, v42
    v_and_b32 v145, 0xffff0000, v42
    v_add_f32 v28, v28, v144
    v_add_f32 v29, v29, v145
    v_cvt_pk_bf16_f32 v42, v28, v29
    v_lshlrev_b32 v144, 16, v43
    v_and_b32 v145, 0xffff0000, v43
    v_add_f32 v30, v30, v144
    v_add_f32 v31, v31, v145
    v_cvt_pk_bf16_f32 v43, v30, v31
    buffer_store_dwordx2 v[42:43], v47, s[20:23], 0 offen offset:96
    v_lshlrev_b32 v144, 16, v44
    v_and_b32 v145, 0xffff0000, v44
    v_add_f32 v32, v32, v144
    v_add_f32 v33, v33, v145
    v_cvt_pk_bf16_f32 v44, v32, v33
    v_lshlrev_b32 v144, 16, v45
    v_and_b32 v145, 0xffff0000, v45
    v_add_f32 v34, v34, v144
    v_add_f32 v35, v35, v145
    v_cvt_pk_bf16_f32 v45, v34, v35
    buffer_store_dwordx2 v[44:45], v47, s[20:23], 0 offen offset:128
    s_branch L_k5_kernel_end
L_k5_kernel_prod:
    s_and_b32 s32, s32, 3
    s_mul_i32 s54, s55, 0
    s_mul_i32 s57, s56, 0
    s_add_u32 s54, s54, s57
    s_sub_u32 s57, s54, 27
    s_cmp_ge_u32 s54, 27
    s_cselect_b32 s54, s57, s54
    s_mov_b32 s45, 0
    s_mov_b32 s37, 0
    s_mov_b32 s38, 6554
    s_mov_b32 s39, 10
    s_mov_b32 s41, 160
    s_mov_b32 s42, s34
    s_cmp_ge_u32 s32, 1
    s_cselect_b32 s37, 64, s37
    s_cmp_ge_u32 s32, 2
    s_cselect_b32 s37, 128, s37
    s_cmp_ge_u32 s32, 3
    s_cselect_b32 s37, 192, s37
    v_add_u32 v25, s37, v1
    v_mul_lo_u32 v26, v25, s38
    v_lshrrev_b32 v26, 16, v26
    v_mul_lo_u32 v27, v26, s39
    v_sub_u32 v25, v25, v27
    v_and_b32 v27, 8, v26
    v_lshlrev_b32 v27, 1, v27
    v_and_b32 v2, 16, v26
    v_lshrrev_b32 v2, 1, v2
    v_or_b32 v27, v27, v2
    v_and_b32 v26, 0xe7, v26
    v_or_b32 v26, v26, v27
    v_mul_lo_u32 v26, v26, s41
    v_lshl_add_u32 v26, v25, 4, v26
    v_add_u32 v2, s42, v26
    s_mov_b32 s37, 256
    s_mov_b32 s38, 6554
    s_mov_b32 s39, 10
    s_mov_b32 s41, 160
    s_mov_b32 s42, s34
    s_cmp_ge_u32 s32, 1
    s_cselect_b32 s37, 320, s37
    s_cmp_ge_u32 s32, 2
    s_cselect_b32 s37, 384, s37
    s_cmp_ge_u32 s32, 3
    s_cselect_b32 s37, 448, s37
    v_add_u32 v25, s37, v1
    v_mul_lo_u32 v26, v25, s38
    v_lshrrev_b32 v26, 16, v26
    v_mul_lo_u32 v27, v26, s39
    v_sub_u32 v25, v25, v27
    v_and_b32 v27, 8, v26
    v_lshlrev_b32 v27, 1, v27
    v_and_b32 v3, 16, v26
    v_lshrrev_b32 v3, 1, v3
    v_or_b32 v27, v27, v3
    v_and_b32 v26, 0xe7, v26
    v_or_b32 v26, v26, v27
    v_mul_lo_u32 v26, v26, s41
    v_lshl_add_u32 v26, v25, 4, v26
    v_add_u32 v3, s42, v26
    s_mov_b32 s37, 512
    s_mov_b32 s38, 6554
    s_mov_b32 s39, 10
    s_mov_b32 s41, 160
    s_mov_b32 s42, s34
    s_cmp_ge_u32 s32, 1
    s_cselect_b32 s37, 576, s37
    v_add_u32 v25, s37, v1
    v_mul_lo_u32 v26, v25, s38
    v_lshrrev_b32 v26, 16, v26
    v_mul_lo_u32 v27, v26, s39
    v_sub_u32 v25, v25, v27
    v_and_b32 v27, 8, v26
    v_lshlrev_b32 v27, 1, v27
    v_and_b32 v4, 16, v26
    v_lshrrev_b32 v4, 1, v4
    v_or_b32 v27, v27, v4
    v_and_b32 v26, 0xe7, v26
    v_or_b32 v26, v26, v27
    v_mul_lo_u32 v26, v26, s41
    v_lshl_add_u32 v26, v25, 4, v26
    v_add_u32 v4, s42, v26
    s_mov_b32 s16, s8
    s_mov_b32 s17, s9
    s_mov_b32 s18, s10
    s_mov_b32 s19, s11
    s_mov_b32 s44, 8192
    s_mov_b32 s45, 10240
    s_cmp_ge_u32 s32, 1
    s_cselect_b32 s44, 9216, s44
    s_lshl_b32 s46, s32, 10
    s_cmp_ge_u32 s32, 2
    s_cbranch_scc1 L_k5_kernel_prod1
    s_lshl_b32 s47, s54, 7
    s_mul_i32 s48, s54, 10240
    s_mul_i32 s50, s45, s54
    s_add_u32 s54, s54, 1
    s_cmp_eq_u32 s54, 27
    s_cselect_b32 s54, 0, s54
    s_add_u32 m0, s46, 0
    s_nop 0
    buffer_load_dwordx4 v2, s[8:11], s48 offen lds
    s_add_u32 m0, s46, 4096
    s_nop 0
    buffer_load_dwordx4 v3, s[8:11], s48 offen lds
    s_add_u32 m0, s44, 0
    s_nop 0
    buffer_load_dwordx4 v4, s[16:19], s50 offen lds
    s_lshl_b32 s47, s54, 7
    s_mul_i32 s48, s54, 10240
    s_mul_i32 s50, s45, s54
    s_add_u32 s54, s54, 1
    s_cmp_eq_u32 s54, 27
    s_cselect_b32 s54, 0, s54
    s_add_u32 m0, s46, 10240
    s_nop 0
    buffer_load_dwordx4 v2, s[8:11], s48 offen lds
    s_add_u32 m0, s46, 14336
    s_nop 0
    buffer_load_dwordx4 v3, s[8:11], s48 offen lds
    s_add_u32 m0, s44, 10240
    s_nop 0
    buffer_load_dwordx4 v4, s[16:19], s50 offen lds
    s_lshl_b32 s47, s54, 7
    s_mul_i32 s48, s54, 10240
    s_mul_i32 s50, s45, s54
    s_add_u32 s54, s54, 1
    s_cmp_eq_u32 s54, 27
    s_cselect_b32 s54, 0, s54
    s_add_u32 m0, s46, 20480
    s_nop 0
    buffer_load_dwordx4 v2, s[8:11], s48 offen lds
    s_add_u32 m0, s46, 24576
    s_nop 0
    buffer_load_dwordx4 v3, s[8:11], s48 offen lds
    s_add_u32 m0, s44, 20480
    s_nop 0
    buffer_load_dwordx4 v4, s[16:19], s50 offen lds
    s_lshl_b32 s47, s54, 7
    s_mul_i32 s48, s54, 10240
    s_mul_i32 s50, s45, s54
    s_add_u32 s54, s54, 1
    s_cmp_eq_u32 s54, 27
    s_cselect_b32 s54, 0, s54
    s_add_u32 m0, s46, 30720
    s_nop 0
    buffer_load_dwordx4 v2, s[8:11], s48 offen lds
    s_add_u32 m0, s46, 34816
    s_nop 0
    buffer_load_dwordx4 v3, s[8:11], s48 offen lds
    s_add_u32 m0, s44, 30720
    s_nop 0
    buffer_load_dwordx4 v4, s[16:19], s50 offen lds
    s_lshl_b32 s47, s54, 7
    s_mul_i32 s48, s54, 10240
    s_mul_i32 s50, s45, s54
    s_add_u32 s54, s54, 1
    s_cmp_eq_u32 s54, 27
    s_cselect_b32 s54, 0, s54
    s_add_u32 m0, s46, 40960
    s_nop 0
    buffer_load_dwordx4 v2, s[8:11], s48 offen lds
    s_add_u32 m0, s46, 45056
    s_nop 0
    buffer_load_dwordx4 v3, s[8:11], s48 offen lds
    s_add_u32 m0, s44, 40960
    s_nop 0
    buffer_load_dwordx4 v4, s[16:19], s50 offen lds
    s_lshl_b32 s47, s54, 7
    s_mul_i32 s48, s54, 10240
    s_mul_i32 s50, s45, s54
    s_add_u32 s54, s54, 1
    s_cmp_eq_u32 s54, 27
    s_cselect_b32 s54, 0, s54
    s_add_u32 m0, s46, 51200
    s_nop 0
    buffer_load_dwordx4 v2, s[8:11], s48 offen lds
    s_add_u32 m0, s46, 55296
    s_nop 0
    buffer_load_dwordx4 v3, s[8:11], s48 offen lds
    s_add_u32 m0, s44, 51200
    s_nop 0
    buffer_load_dwordx4 v4, s[16:19], s50 offen lds
    s_waitcnt vmcnt(15)
    s_barrier
    s_lshl_b32 s47, s54, 7
    s_mul_i32 s48, s54, 10240
    s_mul_i32 s50, s45, s54
    s_add_u32 s54, s54, 1
    s_cmp_eq_u32 s54, 27
    s_cselect_b32 s54, 0, s54
    s_add_u32 m0, s46, 61440
    s_nop 0
    buffer_load_dwordx4 v2, s[8:11], s48 offen lds
    s_add_u32 m0, s46, 65536
    s_nop 0
    buffer_load_dwordx4 v3, s[8:11], s48 offen lds
    s_add_u32 m0, s44, 61440
    s_nop 0
    buffer_load_dwordx4 v4, s[16:19], s50 offen lds
    s_waitcnt vmcnt(15)
    s_barrier
    s_lshl_b32 s47, s54, 7
    s_mul_i32 s48, s54, 10240
    s_mul_i32 s50, s45, s54
    s_add_u32 s54, s54, 1
    s_cmp_eq_u32 s54, 27
    s_cselect_b32 s54, 0, s54
    s_add_u32 m0, s46, 71680
    s_nop 0
    buffer_load_dwordx4 v2, s[8:11], s48 offen lds
    s_add_u32 m0, s46, 75776
    s_nop 0
    buffer_load_dwordx4 v3, s[8:11], s48 offen lds
    s_add_u32 m0, s44, 71680
    s_nop 0
    buffer_load_dwordx4 v4, s[16:19], s50 offen lds
    s_waitcnt vmcnt(15)
    s_barrier
    s_lshl_b32 s47, s54, 7
    s_mul_i32 s48, s54, 10240
    s_mul_i32 s50, s45, s54
    s_add_u32 s54, s54, 1
    s_cmp_eq_u32 s54, 27
    s_cselect_b32 s54, 0, s54
    s_add_u32 m0, s46, 81920
    s_nop 0
    buffer_load_dwordx4 v2, s[8:11], s48 offen lds
    s_add_u32 m0, s46, 86016
    s_nop 0
    buffer_load_dwordx4 v3, s[8:11], s48 offen lds
    s_add_u32 m0, s44, 81920
    s_nop 0
    buffer_load_dwordx4 v4, s[16:19], s50 offen lds
    s_waitcnt vmcnt(15)
    s_barrier
    s_lshl_b32 s47, s54, 7
    s_mul_i32 s48, s54, 10240
    s_mul_i32 s50, s45, s54
    s_add_u32 s54, s54, 1
    s_cmp_eq_u32 s54, 27
    s_cselect_b32 s54, 0, s54
    s_add_u32 m0, s46, 92160
    s_nop 0
    buffer_load_dwordx4 v2, s[8:11], s48 offen lds
    s_add_u32 m0, s46, 96256
    s_nop 0
    buffer_load_dwordx4 v3, s[8:11], s48 offen lds
    s_add_u32 m0, s44, 92160
    s_nop 0
    buffer_load_dwordx4 v4, s[16:19], s50 offen lds
    s_waitcnt vmcnt(15)
    s_barrier
    s_lshl_b32 s47, s54, 7
    s_mul_i32 s48, s54, 10240
    s_mul_i32 s50, s45, s54
    s_add_u32 s54, s54, 1
    s_cmp_eq_u32 s54, 27
    s_cselect_b32 s54, 0, s54
    s_add_u32 m0, s46, 102400
    s_nop 0
    buffer_load_dwordx4 v2, s[8:11], s48 offen lds
    s_add_u32 m0, s46, 106496
    s_nop 0
    buffer_load_dwordx4 v3, s[8:11], s48 offen lds
    s_add_u32 m0, s44, 102400
    s_nop 0
    buffer_load_dwordx4 v4, s[16:19], s50 offen lds
    s_waitcnt vmcnt(15)
    s_barrier
    s_lshl_b32 s47, s54, 7
    s_mul_i32 s48, s54, 10240
    s_mul_i32 s50, s45, s54
    s_add_u32 s54, s54, 1
    s_cmp_eq_u32 s54, 27
    s_cselect_b32 s54, 0, s54
    s_add_u32 m0, s46, 112640
    s_nop 0
    buffer_load_dwordx4 v2, s[8:11], s48 offen lds
    s_add_u32 m0, s46, 116736
    s_nop 0
    buffer_load_dwordx4 v3, s[8:11], s48 offen lds
    s_add_u32 m0, s44, 112640
    s_nop 0
    buffer_load_dwordx4 v4, s[16:19], s50 offen lds
    s_waitcnt vmcnt(15)
    s_barrier
    s_lshl_b32 s47, s54, 7
    s_mul_i32 s48, s54, 10240
    s_mul_i32 s50, s45, s54
    s_add_u32 s54, s54, 1
    s_cmp_eq_u32 s54, 27
    s_cselect_b32 s54, 0, s54
    s_add_u32 m0, s46, 0
    s_nop 0
    buffer_load_dwordx4 v2, s[8:11], s48 offen lds
    s_add_u32 m0, s46, 4096
    s_nop 0
    buffer_load_dwordx4 v3, s[8:11], s48 offen lds
    s_add_u32 m0, s44, 0
    s_nop 0
    buffer_load_dwordx4 v4, s[16:19], s50 offen lds
    s_waitcnt vmcnt(15)
    s_barrier
    s_lshl_b32 s47, s54, 7
    s_mul_i32 s48, s54, 10240
    s_mul_i32 s50, s45, s54
    s_add_u32 s54, s54, 1
    s_cmp_eq_u32 s54, 27
    s_cselect_b32 s54, 0, s54
    s_add_u32 m0, s46, 10240
    s_nop 0
    buffer_load_dwordx4 v2, s[8:11], s48 offen lds
    s_add_u32 m0, s46, 14336
    s_nop 0
    buffer_load_dwordx4 v3, s[8:11], s48 offen lds
    s_add_u32 m0, s44, 10240
    s_nop 0
    buffer_load_dwordx4 v4, s[16:19], s50 offen lds
    s_waitcnt vmcnt(15)
    s_barrier
    s_lshl_b32 s47, s54, 7
    s_mul_i32 s48, s54, 10240
    s_mul_i32 s50, s45, s54
    s_add_u32 s54, s54, 1
    s_cmp_eq_u32 s54, 27
    s_cselect_b32 s54, 0, s54
    s_add_u32 m0, s46, 20480
    s_nop 0
    buffer_load_dwordx4 v2, s[8:11], s48 offen lds
    s_add_u32 m0, s46, 24576
    s_nop 0
    buffer_load_dwordx4 v3, s[8:11], s48 offen lds
    s_add_u32 m0, s44, 20480
    s_nop 0
    buffer_load_dwordx4 v4, s[16:19], s50 offen lds
    s_waitcnt vmcnt(15)
    s_barrier
    s_lshl_b32 s47, s54, 7
    s_mul_i32 s48, s54, 10240
    s_mul_i32 s50, s45, s54
    s_add_u32 s54, s54, 1
    s_cmp_eq_u32 s54, 27
    s_cselect_b32 s54, 0, s54
    s_add_u32 m0, s46, 30720
    s_nop 0
    buffer_load_dwordx4 v2, s[8:11], s48 offen lds
    s_add_u32 m0, s46, 34816
    s_nop 0
    buffer_load_dwordx4 v3, s[8:11], s48 offen lds
    s_add_u32 m0, s44, 30720
    s_nop 0
    buffer_load_dwordx4 v4, s[16:19], s50 offen lds
    s_waitcnt vmcnt(15)
    s_barrier
    s_lshl_b32 s47, s54, 7
    s_mul_i32 s48, s54, 10240
    s_mul_i32 s50, s45, s54
    s_add_u32 s54, s54, 1
    s_cmp_eq_u32 s54, 27
    s_cselect_b32 s54, 0, s54
    s_add_u32 m0, s46, 40960
    s_nop 0
    buffer_load_dwordx4 v2, s[8:11], s48 offen lds
    s_add_u32 m0, s46, 45056
    s_nop 0
    buffer_load_dwordx4 v3, s[8:11], s48 offen lds
    s_add_u32 m0, s44, 40960
    s_nop 0
    buffer_load_dwordx4 v4, s[16:19], s50 offen lds
    s_waitcnt vmcnt(15)
    s_barrier
    s_lshl_b32 s47, s54, 7
    s_mul_i32 s48, s54, 10240
    s_mul_i32 s50, s45, s54
    s_add_u32 s54, s54, 1
    s_cmp_eq_u32 s54, 27
    s_cselect_b32 s54, 0, s54
    s_add_u32 m0, s46, 51200
    s_nop 0
    buffer_load_dwordx4 v2, s[8:11], s48 offen lds
    s_add_u32 m0, s46, 55296
    s_nop 0
    buffer_load_dwordx4 v3, s[8:11], s48 offen lds
    s_add_u32 m0, s44, 51200
    s_nop 0
    buffer_load_dwordx4 v4, s[16:19], s50 offen lds
    s_waitcnt vmcnt(15)
    s_barrier
    s_lshl_b32 s47, s54, 7
    s_mul_i32 s48, s54, 10240
    s_mul_i32 s50, s45, s54
    s_add_u32 s54, s54, 1
    s_cmp_eq_u32 s54, 27
    s_cselect_b32 s54, 0, s54
    s_add_u32 m0, s46, 61440
    s_nop 0
    buffer_load_dwordx4 v2, s[8:11], s48 offen lds
    s_add_u32 m0, s46, 65536
    s_nop 0
    buffer_load_dwordx4 v3, s[8:11], s48 offen lds
    s_add_u32 m0, s44, 61440
    s_nop 0
    buffer_load_dwordx4 v4, s[16:19], s50 offen lds
    s_waitcnt vmcnt(15)
    s_barrier
    s_lshl_b32 s47, s54, 7
    s_mul_i32 s48, s54, 10240
    s_mul_i32 s50, s45, s54
    s_add_u32 s54, s54, 1
    s_cmp_eq_u32 s54, 27
    s_cselect_b32 s54, 0, s54
    s_add_u32 m0, s46, 71680
    s_nop 0
    buffer_load_dwordx4 v2, s[8:11], s48 offen lds
    s_add_u32 m0, s46, 75776
    s_nop 0
    buffer_load_dwordx4 v3, s[8:11], s48 offen lds
    s_add_u32 m0, s44, 71680
    s_nop 0
    buffer_load_dwordx4 v4, s[16:19], s50 offen lds
    s_waitcnt vmcnt(15)
    s_barrier
    s_lshl_b32 s47, s54, 7
    s_mul_i32 s48, s54, 10240
    s_mul_i32 s50, s45, s54
    s_add_u32 s54, s54, 1
    s_cmp_eq_u32 s54, 27
    s_cselect_b32 s54, 0, s54
    s_add_u32 m0, s46, 81920
    s_nop 0
    buffer_load_dwordx4 v2, s[8:11], s48 offen lds
    s_add_u32 m0, s46, 86016
    s_nop 0
    buffer_load_dwordx4 v3, s[8:11], s48 offen lds
    s_add_u32 m0, s44, 81920
    s_nop 0
    buffer_load_dwordx4 v4, s[16:19], s50 offen lds
    s_waitcnt vmcnt(15)
    s_barrier
    s_lshl_b32 s47, s54, 7
    s_mul_i32 s48, s54, 10240
    s_mul_i32 s50, s45, s54
    s_add_u32 s54, s54, 1
    s_cmp_eq_u32 s54, 27
    s_cselect_b32 s54, 0, s54
    s_add_u32 m0, s46, 92160
    s_nop 0
    buffer_load_dwordx4 v2, s[8:11], s48 offen lds
    s_add_u32 m0, s46, 96256
    s_nop 0
    buffer_load_dwordx4 v3, s[8:11], s48 offen lds
    s_add_u32 m0, s44, 92160
    s_nop 0
    buffer_load_dwordx4 v4, s[16:19], s50 offen lds
    s_waitcnt vmcnt(15)
    s_barrier
    s_lshl_b32 s47, s54, 7
    s_mul_i32 s48, s54, 10240
    s_mul_i32 s50, s45, s54
    s_add_u32 s54, s54, 1
    s_cmp_eq_u32 s54, 27
    s_cselect_b32 s54, 0, s54
    s_add_u32 m0, s46, 102400
    s_nop 0
    buffer_load_dwordx4 v2, s[8:11], s48 offen lds
    s_add_u32 m0, s46, 106496
    s_nop 0
    buffer_load_dwordx4 v3, s[8:11], s48 offen lds
    s_add_u32 m0, s44, 102400
    s_nop 0
    buffer_load_dwordx4 v4, s[16:19], s50 offen lds
    s_waitcnt vmcnt(15)
    s_barrier
    s_lshl_b32 s47, s54, 7
    s_mul_i32 s48, s54, 10240
    s_mul_i32 s50, s45, s54
    s_add_u32 s54, s54, 1
    s_cmp_eq_u32 s54, 27
    s_cselect_b32 s54, 0, s54
    s_add_u32 m0, s46, 112640
    s_nop 0
    buffer_load_dwordx4 v2, s[8:11], s48 offen lds
    s_add_u32 m0, s46, 116736
    s_nop 0
    buffer_load_dwordx4 v3, s[8:11], s48 offen lds
    s_add_u32 m0, s44, 112640
    s_nop 0
    buffer_load_dwordx4 v4, s[16:19], s50 offen lds
    s_waitcnt vmcnt(15)
    s_barrier
    s_lshl_b32 s47, s54, 7
    s_mul_i32 s48, s54, 10240
    s_mul_i32 s50, s45, s54
    s_add_u32 s54, s54, 1
    s_cmp_eq_u32 s54, 27
    s_cselect_b32 s54, 0, s54
    s_add_u32 m0, s46, 0
    s_nop 0
    buffer_load_dwordx4 v2, s[8:11], s48 offen lds
    s_add_u32 m0, s46, 4096
    s_nop 0
    buffer_load_dwordx4 v3, s[8:11], s48 offen lds
    s_add_u32 m0, s44, 0
    s_nop 0
    buffer_load_dwordx4 v4, s[16:19], s50 offen lds
    s_waitcnt vmcnt(15)
    s_barrier
    s_lshl_b32 s47, s54, 7
    s_mul_i32 s48, s54, 10240
    s_mul_i32 s50, s45, s54
    s_add_u32 s54, s54, 1
    s_cmp_eq_u32 s54, 27
    s_cselect_b32 s54, 0, s54
    s_add_u32 m0, s46, 10240
    s_nop 0
    buffer_load_dwordx4 v2, s[8:11], s48 offen lds
    s_add_u32 m0, s46, 14336
    s_nop 0
    buffer_load_dwordx4 v3, s[8:11], s48 offen lds
    s_add_u32 m0, s44, 10240
    s_nop 0
    buffer_load_dwordx4 v4, s[16:19], s50 offen lds
    s_waitcnt vmcnt(15)
    s_barrier
    s_lshl_b32 s47, s54, 7
    s_mul_i32 s48, s54, 10240
    s_mul_i32 s50, s45, s54
    s_add_u32 s54, s54, 1
    s_cmp_eq_u32 s54, 27
    s_cselect_b32 s54, 0, s54
    s_add_u32 m0, s46, 20480
    s_nop 0
    buffer_load_dwordx4 v2, s[8:11], s48 offen lds
    s_add_u32 m0, s46, 24576
    s_nop 0
    buffer_load_dwordx4 v3, s[8:11], s48 offen lds
    s_add_u32 m0, s44, 20480
    s_nop 0
    buffer_load_dwordx4 v4, s[16:19], s50 offen lds
    s_waitcnt vmcnt(15)
    s_barrier
    s_waitcnt vmcnt(12)
    s_barrier
    s_waitcnt vmcnt(9)
    s_barrier
    s_waitcnt vmcnt(6)
    s_barrier
    s_waitcnt vmcnt(3)
    s_barrier
    s_waitcnt vmcnt(0)
    s_barrier
    s_branch L_k5_kernel_end
L_k5_kernel_prod1:
    s_lshl_b32 s47, s54, 7
    s_mul_i32 s48, s54, 10240
    s_mul_i32 s50, s45, s54
    s_add_u32 s54, s54, 1
    s_cmp_eq_u32 s54, 27
    s_cselect_b32 s54, 0, s54
    s_add_u32 m0, s46, 0
    s_nop 0
    buffer_load_dwordx4 v2, s[8:11], s48 offen lds
    s_add_u32 m0, s46, 4096
    s_nop 0
    buffer_load_dwordx4 v3, s[8:11], s48 offen lds
    s_lshl_b32 s47, s54, 7
    s_mul_i32 s48, s54, 10240
    s_mul_i32 s50, s45, s54
    s_add_u32 s54, s54, 1
    s_cmp_eq_u32 s54, 27
    s_cselect_b32 s54, 0, s54
    s_add_u32 m0, s46, 10240
    s_nop 0
    buffer_load_dwordx4 v2, s[8:11], s48 offen lds
    s_add_u32 m0, s46, 14336
    s_nop 0
    buffer_load_dwordx4 v3, s[8:11], s48 offen lds
    s_lshl_b32 s47, s54, 7
    s_mul_i32 s48, s54, 10240
    s_mul_i32 s50, s45, s54
    s_add_u32 s54, s54, 1
    s_cmp_eq_u32 s54, 27
    s_cselect_b32 s54, 0, s54
    s_add_u32 m0, s46, 20480
    s_nop 0
    buffer_load_dwordx4 v2, s[8:11], s48 offen lds
    s_add_u32 m0, s46, 24576
    s_nop 0
    buffer_load_dwordx4 v3, s[8:11], s48 offen lds
    s_lshl_b32 s47, s54, 7
    s_mul_i32 s48, s54, 10240
    s_mul_i32 s50, s45, s54
    s_add_u32 s54, s54, 1
    s_cmp_eq_u32 s54, 27
    s_cselect_b32 s54, 0, s54
    s_add_u32 m0, s46, 30720
    s_nop 0
    buffer_load_dwordx4 v2, s[8:11], s48 offen lds
    s_add_u32 m0, s46, 34816
    s_nop 0
    buffer_load_dwordx4 v3, s[8:11], s48 offen lds
    s_lshl_b32 s47, s54, 7
    s_mul_i32 s48, s54, 10240
    s_mul_i32 s50, s45, s54
    s_add_u32 s54, s54, 1
    s_cmp_eq_u32 s54, 27
    s_cselect_b32 s54, 0, s54
    s_add_u32 m0, s46, 40960
    s_nop 0
    buffer_load_dwordx4 v2, s[8:11], s48 offen lds
    s_add_u32 m0, s46, 45056
    s_nop 0
    buffer_load_dwordx4 v3, s[8:11], s48 offen lds
    s_lshl_b32 s47, s54, 7
    s_mul_i32 s48, s54, 10240
    s_mul_i32 s50, s45, s54
    s_add_u32 s54, s54, 1
    s_cmp_eq_u32 s54, 27
    s_cselect_b32 s54, 0, s54
    s_add_u32 m0, s46, 51200
    s_nop 0
    buffer_load_dwordx4 v2, s[8:11], s48 offen lds
    s_add_u32 m0, s46, 55296
    s_nop 0
    buffer_load_dwordx4 v3, s[8:11], s48 offen lds
    s_waitcnt vmcnt(10)
    s_barrier
    s_lshl_b32 s47, s54, 7
    s_mul_i32 s48, s54, 10240
    s_mul_i32 s50, s45, s54
    s_add_u32 s54, s54, 1
    s_cmp_eq_u32 s54, 27
    s_cselect_b32 s54, 0, s54
    s_add_u32 m0, s46, 61440
    s_nop 0
    buffer_load_dwordx4 v2, s[8:11], s48 offen lds
    s_add_u32 m0, s46, 65536
    s_nop 0
    buffer_load_dwordx4 v3, s[8:11], s48 offen lds
    s_waitcnt vmcnt(10)
    s_barrier
    s_lshl_b32 s47, s54, 7
    s_mul_i32 s48, s54, 10240
    s_mul_i32 s50, s45, s54
    s_add_u32 s54, s54, 1
    s_cmp_eq_u32 s54, 27
    s_cselect_b32 s54, 0, s54
    s_add_u32 m0, s46, 71680
    s_nop 0
    buffer_load_dwordx4 v2, s[8:11], s48 offen lds
    s_add_u32 m0, s46, 75776
    s_nop 0
    buffer_load_dwordx4 v3, s[8:11], s48 offen lds
    s_waitcnt vmcnt(10)
    s_barrier
    s_lshl_b32 s47, s54, 7
    s_mul_i32 s48, s54, 10240
    s_mul_i32 s50, s45, s54
    s_add_u32 s54, s54, 1
    s_cmp_eq_u32 s54, 27
    s_cselect_b32 s54, 0, s54
    s_add_u32 m0, s46, 81920
    s_nop 0
    buffer_load_dwordx4 v2, s[8:11], s48 offen lds
    s_add_u32 m0, s46, 86016
    s_nop 0
    buffer_load_dwordx4 v3, s[8:11], s48 offen lds
    s_waitcnt vmcnt(10)
    s_barrier
    s_lshl_b32 s47, s54, 7
    s_mul_i32 s48, s54, 10240
    s_mul_i32 s50, s45, s54
    s_add_u32 s54, s54, 1
    s_cmp_eq_u32 s54, 27
    s_cselect_b32 s54, 0, s54
    s_add_u32 m0, s46, 92160
    s_nop 0
    buffer_load_dwordx4 v2, s[8:11], s48 offen lds
    s_add_u32 m0, s46, 96256
    s_nop 0
    buffer_load_dwordx4 v3, s[8:11], s48 offen lds
    s_waitcnt vmcnt(10)
    s_barrier
    s_lshl_b32 s47, s54, 7
    s_mul_i32 s48, s54, 10240
    s_mul_i32 s50, s45, s54
    s_add_u32 s54, s54, 1
    s_cmp_eq_u32 s54, 27
    s_cselect_b32 s54, 0, s54
    s_add_u32 m0, s46, 102400
    s_nop 0
    buffer_load_dwordx4 v2, s[8:11], s48 offen lds
    s_add_u32 m0, s46, 106496
    s_nop 0
    buffer_load_dwordx4 v3, s[8:11], s48 offen lds
    s_waitcnt vmcnt(10)
    s_barrier
    s_lshl_b32 s47, s54, 7
    s_mul_i32 s48, s54, 10240
    s_mul_i32 s50, s45, s54
    s_add_u32 s54, s54, 1
    s_cmp_eq_u32 s54, 27
    s_cselect_b32 s54, 0, s54
    s_add_u32 m0, s46, 112640
    s_nop 0
    buffer_load_dwordx4 v2, s[8:11], s48 offen lds
    s_add_u32 m0, s46, 116736
    s_nop 0
    buffer_load_dwordx4 v3, s[8:11], s48 offen lds
    s_waitcnt vmcnt(10)
    s_barrier
    s_lshl_b32 s47, s54, 7
    s_mul_i32 s48, s54, 10240
    s_mul_i32 s50, s45, s54
    s_add_u32 s54, s54, 1
    s_cmp_eq_u32 s54, 27
    s_cselect_b32 s54, 0, s54
    s_add_u32 m0, s46, 0
    s_nop 0
    buffer_load_dwordx4 v2, s[8:11], s48 offen lds
    s_add_u32 m0, s46, 4096
    s_nop 0
    buffer_load_dwordx4 v3, s[8:11], s48 offen lds
    s_waitcnt vmcnt(10)
    s_barrier
    s_lshl_b32 s47, s54, 7
    s_mul_i32 s48, s54, 10240
    s_mul_i32 s50, s45, s54
    s_add_u32 s54, s54, 1
    s_cmp_eq_u32 s54, 27
    s_cselect_b32 s54, 0, s54
    s_add_u32 m0, s46, 10240
    s_nop 0
    buffer_load_dwordx4 v2, s[8:11], s48 offen lds
    s_add_u32 m0, s46, 14336
    s_nop 0
    buffer_load_dwordx4 v3, s[8:11], s48 offen lds
    s_waitcnt vmcnt(10)
    s_barrier
    s_lshl_b32 s47, s54, 7
    s_mul_i32 s48, s54, 10240
    s_mul_i32 s50, s45, s54
    s_add_u32 s54, s54, 1
    s_cmp_eq_u32 s54, 27
    s_cselect_b32 s54, 0, s54
    s_add_u32 m0, s46, 20480
    s_nop 0
    buffer_load_dwordx4 v2, s[8:11], s48 offen lds
    s_add_u32 m0, s46, 24576
    s_nop 0
    buffer_load_dwordx4 v3, s[8:11], s48 offen lds
    s_waitcnt vmcnt(10)
    s_barrier
    s_lshl_b32 s47, s54, 7
    s_mul_i32 s48, s54, 10240
    s_mul_i32 s50, s45, s54
    s_add_u32 s54, s54, 1
    s_cmp_eq_u32 s54, 27
    s_cselect_b32 s54, 0, s54
    s_add_u32 m0, s46, 30720
    s_nop 0
    buffer_load_dwordx4 v2, s[8:11], s48 offen lds
    s_add_u32 m0, s46, 34816
    s_nop 0
    buffer_load_dwordx4 v3, s[8:11], s48 offen lds
    s_waitcnt vmcnt(10)
    s_barrier
    s_lshl_b32 s47, s54, 7
    s_mul_i32 s48, s54, 10240
    s_mul_i32 s50, s45, s54
    s_add_u32 s54, s54, 1
    s_cmp_eq_u32 s54, 27
    s_cselect_b32 s54, 0, s54
    s_add_u32 m0, s46, 40960
    s_nop 0
    buffer_load_dwordx4 v2, s[8:11], s48 offen lds
    s_add_u32 m0, s46, 45056
    s_nop 0
    buffer_load_dwordx4 v3, s[8:11], s48 offen lds
    s_waitcnt vmcnt(10)
    s_barrier
    s_lshl_b32 s47, s54, 7
    s_mul_i32 s48, s54, 10240
    s_mul_i32 s50, s45, s54
    s_add_u32 s54, s54, 1
    s_cmp_eq_u32 s54, 27
    s_cselect_b32 s54, 0, s54
    s_add_u32 m0, s46, 51200
    s_nop 0
    buffer_load_dwordx4 v2, s[8:11], s48 offen lds
    s_add_u32 m0, s46, 55296
    s_nop 0
    buffer_load_dwordx4 v3, s[8:11], s48 offen lds
    s_waitcnt vmcnt(10)
    s_barrier
    s_lshl_b32 s47, s54, 7
    s_mul_i32 s48, s54, 10240
    s_mul_i32 s50, s45, s54
    s_add_u32 s54, s54, 1
    s_cmp_eq_u32 s54, 27
    s_cselect_b32 s54, 0, s54
    s_add_u32 m0, s46, 61440
    s_nop 0
    buffer_load_dwordx4 v2, s[8:11], s48 offen lds
    s_add_u32 m0, s46, 65536
    s_nop 0
    buffer_load_dwordx4 v3, s[8:11], s48 offen lds
    s_waitcnt vmcnt(10)
    s_barrier
    s_lshl_b32 s47, s54, 7
    s_mul_i32 s48, s54, 10240
    s_mul_i32 s50, s45, s54
    s_add_u32 s54, s54, 1
    s_cmp_eq_u32 s54, 27
    s_cselect_b32 s54, 0, s54
    s_add_u32 m0, s46, 71680
    s_nop 0
    buffer_load_dwordx4 v2, s[8:11], s48 offen lds
    s_add_u32 m0, s46, 75776
    s_nop 0
    buffer_load_dwordx4 v3, s[8:11], s48 offen lds
    s_waitcnt vmcnt(10)
    s_barrier
    s_lshl_b32 s47, s54, 7
    s_mul_i32 s48, s54, 10240
    s_mul_i32 s50, s45, s54
    s_add_u32 s54, s54, 1
    s_cmp_eq_u32 s54, 27
    s_cselect_b32 s54, 0, s54
    s_add_u32 m0, s46, 81920
    s_nop 0
    buffer_load_dwordx4 v2, s[8:11], s48 offen lds
    s_add_u32 m0, s46, 86016
    s_nop 0
    buffer_load_dwordx4 v3, s[8:11], s48 offen lds
    s_waitcnt vmcnt(10)
    s_barrier
    s_lshl_b32 s47, s54, 7
    s_mul_i32 s48, s54, 10240
    s_mul_i32 s50, s45, s54
    s_add_u32 s54, s54, 1
    s_cmp_eq_u32 s54, 27
    s_cselect_b32 s54, 0, s54
    s_add_u32 m0, s46, 92160
    s_nop 0
    buffer_load_dwordx4 v2, s[8:11], s48 offen lds
    s_add_u32 m0, s46, 96256
    s_nop 0
    buffer_load_dwordx4 v3, s[8:11], s48 offen lds
    s_waitcnt vmcnt(10)
    s_barrier
    s_lshl_b32 s47, s54, 7
    s_mul_i32 s48, s54, 10240
    s_mul_i32 s50, s45, s54
    s_add_u32 s54, s54, 1
    s_cmp_eq_u32 s54, 27
    s_cselect_b32 s54, 0, s54
    s_add_u32 m0, s46, 102400
    s_nop 0
    buffer_load_dwordx4 v2, s[8:11], s48 offen lds
    s_add_u32 m0, s46, 106496
    s_nop 0
    buffer_load_dwordx4 v3, s[8:11], s48 offen lds
    s_waitcnt vmcnt(10)
    s_barrier
    s_lshl_b32 s47, s54, 7
    s_mul_i32 s48, s54, 10240
    s_mul_i32 s50, s45, s54
    s_add_u32 s54, s54, 1
    s_cmp_eq_u32 s54, 27
    s_cselect_b32 s54, 0, s54
    s_add_u32 m0, s46, 112640
    s_nop 0
    buffer_load_dwordx4 v2, s[8:11], s48 offen lds
    s_add_u32 m0, s46, 116736
    s_nop 0
    buffer_load_dwordx4 v3, s[8:11], s48 offen lds
    s_waitcnt vmcnt(10)
    s_barrier
    s_lshl_b32 s47, s54, 7
    s_mul_i32 s48, s54, 10240
    s_mul_i32 s50, s45, s54
    s_add_u32 s54, s54, 1
    s_cmp_eq_u32 s54, 27
    s_cselect_b32 s54, 0, s54
    s_add_u32 m0, s46, 0
    s_nop 0
    buffer_load_dwordx4 v2, s[8:11], s48 offen lds
    s_add_u32 m0, s46, 4096
    s_nop 0
    buffer_load_dwordx4 v3, s[8:11], s48 offen lds
    s_waitcnt vmcnt(10)
    s_barrier
    s_lshl_b32 s47, s54, 7
    s_mul_i32 s48, s54, 10240
    s_mul_i32 s50, s45, s54
    s_add_u32 s54, s54, 1
    s_cmp_eq_u32 s54, 27
    s_cselect_b32 s54, 0, s54
    s_add_u32 m0, s46, 10240
    s_nop 0
    buffer_load_dwordx4 v2, s[8:11], s48 offen lds
    s_add_u32 m0, s46, 14336
    s_nop 0
    buffer_load_dwordx4 v3, s[8:11], s48 offen lds
    s_waitcnt vmcnt(10)
    s_barrier
    s_lshl_b32 s47, s54, 7
    s_mul_i32 s48, s54, 10240
    s_mul_i32 s50, s45, s54
    s_add_u32 s54, s54, 1
    s_cmp_eq_u32 s54, 27
    s_cselect_b32 s54, 0, s54
    s_add_u32 m0, s46, 20480
    s_nop 0
    buffer_load_dwordx4 v2, s[8:11], s48 offen lds
    s_add_u32 m0, s46, 24576
    s_nop 0
    buffer_load_dwordx4 v3, s[8:11], s48 offen lds
    s_waitcnt vmcnt(10)
    s_barrier
    s_waitcnt vmcnt(8)
    s_barrier
    s_waitcnt vmcnt(6)
    s_barrier
    s_waitcnt vmcnt(4)
    s_barrier
    s_waitcnt vmcnt(2)
    s_barrier
    s_waitcnt vmcnt(0)
    s_barrier
    s_branch L_k5_kernel_end
L_k5_kernel_end:
    s_endpgm
.section .rodata,"a"
.p2align 6
.amdhsa_kernel k5_kernel
  .amdhsa_next_free_vgpr 152
  .amdhsa_next_free_sgpr 102
  .amdhsa_accum_offset 152
  .amdhsa_group_segment_fixed_size 0
  .amdhsa_kernarg_size 96
  .amdhsa_user_sgpr_count 2
  .amdhsa_user_sgpr_kernarg_segment_ptr 1
  .amdhsa_system_sgpr_workgroup_id_x 1
.end_amdhsa_kernel
.text
```
